```python
import torch

def _softmax(x, axis=-1):
    return torch.softmax(x, dim=axis)
def _gelu(x):
    return torch.nn.functional.gelu(x, approximate="tanh")
def _silu(x):
    return torch.nn.functional.silu(x)
def _sigmoid(x):
    return torch.sigmoid(x)
def _layernorm(x, axis=-1, eps=1e-5):
    m = x.mean(dim=axis, keepdim=True)
    v = x.var(dim=axis, keepdim=True, unbiased=False)
    return (x - m) / torch.sqrt(v + eps)
def _scatter_add(tgt, idx, src, axis=0):
    return tgt.clone().index_add_(axis, idx, src)
def _segment_sum(src, seg, n):
    out = torch.zeros((n,) + src.shape[1:], dtype=src.dtype)
    return out.index_add_(0, seg, src)
def _pad(x, pw):
    flat = tuple(v for pair in reversed(pw) for v in pair)
    return torch.nn.functional.pad(x, flat)

kernel_name = 'standalone__seq2seq_rnn_t_joint__speech'

def setup_inputs():

    _w = (lambda a: (lambda t: t.to(torch.bfloat16) if t.is_floating_point() else t)(torch.as_tensor(a)))
    B, T, D, K = 2, 4000, 512, 15
    U = 8
    sc = (1.0 / (K * D)) ** 0.5
    sd = (1.0 / D) ** 0.5
    return {
        "x": _w((lambda *s: torch.randn(*s, dtype=torch.bfloat16) * 0.4)(B, T, D) * 0.5),
        "w1": _w((lambda *s: torch.randn(*s, dtype=torch.bfloat16) * 3.2)(K, D, D) * sc),
        "w2": _w((lambda *s: torch.randn(*s, dtype=torch.bfloat16) * 3.2)(K, D, D) * sc),
        "g": _w((lambda *s: torch.randn(*s, dtype=torch.bfloat16) * 3.2)(B, U, D) * 0.5),
        "w_f": _w((lambda *s: torch.randn(*s, dtype=torch.bfloat16) * 3.2)(D, D) * sd),
        "w_g": _w((lambda *s: torch.randn(*s, dtype=torch.bfloat16) * 3.2)(D, D) * sd),
        "w_o": _w((lambda *s: torch.randn(*s, dtype=torch.bfloat16) * 3.2)(D, D) * sd),
    }

def reference(x, w1, w2, g, w_f, w_g, w_o):
    B, T, D = x.shape
    K = w1.shape[0]
    pad = K // 2
    xp = _pad(x, ((0,0),(pad,pad),(0,0)))
    h = torch.zeros_like(x)
    for i in range(K):
        h = h + torch.einsum("btc,cd->btd", xp[:, i:i+T, :], w1[i])
    h = _gelu(h)[:, ::2, :]
    T1 = h.shape[1]
    hp = _pad(h, ((0,0),(pad,pad),(0,0)))
    f = torch.zeros_like(h)
    for i in range(K):
        f = f + torch.einsum("btc,cd->btd", hp[:, i:i+T1, :], w2[i])
    f = _gelu(f)[:, ::2, :]
    fe = torch.einsum("btd,de->bte", f, w_f)
    ge = torch.einsum("bud,de->bue", g, w_g)
    j = torch.tanh(fe[:, :, None, :] + ge[:, None, :, :])
    return torch.einsum("btud,dv->btuv", j, w_o)
```

```asm
; @launch kernel=conv1_kernel grid=(256,1,1) block=(320,1,1) lds=163840
; @launch kernel=conv2_kernel grid=(256,1,1) block=(320,1,1) lds=163840
; @launch kernel=joint_kernel grid=(256,1,1) block=(256,1,1) lds=99584
.amdgcn_target "amdgcn-amd-amdhsa--gfx950"
.text
.globl conv1_kernel
.p2align 8
.type conv1_kernel,@function
conv1_kernel:
    s_cmp_ge_u32 s2, 256
    s_cbranch_scc1 conv1_kernel_end
    s_getpc_b64 s[56:57]
conv1_kernel_pc:
    s_mov_b32 s58, conv2_kernel-conv1_kernel_pc
    s_mov_b32 s59, 0x20000
    v_lshlrev_b32 v5, 7, v0
    buffer_load_dword v33, v5, s[56:59], 0 offen
    s_load_dwordx4 s[4:7], s[0:1], 0
    s_load_dwordx2 s[20:21], s[0:1], 72
    v_lshrrev_b32 v1, 6, v0
    v_and_b32 v2, 63, v0
    s_and_b32 s41, s2, 7
    s_lshr_b32 s42, s2, 3
    v_readfirstlane_b32 s28, v1
    s_and_b32 s43, s41, 1
    s_lshl_b32 s43, s43, 2
    s_and_b32 s44, s42, 3
    s_add_u32 s43, s43, s44
    s_lshr_b32 s45, s41, 1
    s_lshl_b32 s45, s45, 3
    s_lshr_b32 s46, s42, 2
    s_add_u32 s45, s45, s46
    s_lshr_b32 s40, s45, 4
    s_and_b32 s45, s45, 15
    s_mul_i32 s38, s45, 125
    s_lshl_b32 s39, s43, 7
    s_mov_b32 s37, 1073741824
    s_waitcnt lgkmcnt(0)
    s_cmp_eq_u32 s28, 4
    s_cbranch_scc1 conv1_kernel_helper
    s_mul_i32 s46, s40, 4096000
    s_add_u32 s8, s4, s46
    s_addc_u32 s9, s5, 0
    s_mov_b32 s10, 4096000
    s_mov_b32 s11, 0x20000
    s_mov_b32 s12, s6
    s_mov_b32 s13, s7
    s_mov_b32 s14, 7864320
    s_mov_b32 s15, 0x20000
    s_mul_i32 s46, s40, 2048000
    s_add_u32 s46, s46, 0
    s_add_u32 s16, s20, s46
    s_addc_u32 s17, s21, 0
    s_mov_b32 s18, 2048000
    s_mov_b32 s19, 0x20000
    s_lshl_b32 s46, s38, 11
    s_lshl_b32 s47, s28, 13
    s_add_u32 s46, s46, s47
    s_sub_u32 s31, s46, 8192
    s_cmp_eq_u32 s46, 0
    s_cselect_b32 s32, 0, s31
    s_cselect_b32 s48, 1, 0
    s_lshl_b32 s33, s28, 10
    v_lshrrev_b32 v3, 4, v2
    v_and_b32 v20, 15, v2
    v_lshlrev_b32 v21, 11, v3
    v_add_u32 v21, 1024, v21
    s_lshr_b32 s49, s28, 1
    s_add_u32 s50, s49, 0
    s_and_b32 s50, s50, 7
    s_lshl_b32 s50, s50, 1
    v_xor_b32 v22, s50, v20
    v_lshl_add_u32 v4, v22, 4, v21
    s_add_u32 s50, s49, 2
    s_and_b32 s50, s50, 7
    s_lshl_b32 s50, s50, 1
    v_xor_b32 v22, s50, v20
    v_lshl_add_u32 v5, v22, 4, v21
    s_add_u32 s50, s49, 4
    s_and_b32 s50, s50, 7
    s_lshl_b32 s50, s50, 1
    v_xor_b32 v22, s50, v20
    v_lshl_add_u32 v6, v22, 4, v21
    s_add_u32 s50, s49, 6
    s_and_b32 s50, s50, 7
    s_lshl_b32 s50, s50, 1
    v_xor_b32 v22, s50, v20
    v_lshl_add_u32 v7, v22, 4, v21
    v_mov_b32 v8, v4
    v_add_u32 v9, 1024, v4
    s_cmp_eq_u32 s48, 0
    s_cbranch_scc1 conv1_kernel_nospecial
    v_mov_b32 v8, s37
    v_lshlrev_b32 v22, 4, v20
    v_mov_b32 v23, s37
    v_cmp_eq_u32 vcc, 3, v3
    s_nop 1
    v_cndmask_b32 v9, v23, v22, vcc
conv1_kernel_nospecial:
    s_add_u32 m0, s33, 0
    s_nop 0
    buffer_load_dwordx4 v8, s[8:11], s32 offen lds
    s_add_u32 m0, s33, 4096
    s_add_u32 s36, s31, 32768
    buffer_load_dwordx4 v5, s[8:11], s36 offen lds
    s_add_u32 m0, s33, 8192
    s_add_u32 s36, s31, 65536
    buffer_load_dwordx4 v6, s[8:11], s36 offen lds
    s_add_u32 m0, s33, 12288
    s_add_u32 s36, s31, 98304
    buffer_load_dwordx4 v7, s[8:11], s36 offen lds
    s_add_u32 m0, s33, 16384
    s_add_u32 s36, s31, 131072
    buffer_load_dwordx4 v4, s[8:11], s36 offen lds
    s_add_u32 m0, s33, 20480
    s_add_u32 s36, s31, 163840
    buffer_load_dwordx4 v5, s[8:11], s36 offen lds
    s_add_u32 m0, s33, 24576
    s_add_u32 s36, s31, 196608
    buffer_load_dwordx4 v6, s[8:11], s36 offen lds
    s_add_u32 m0, s33, 28672
    s_add_u32 s36, s31, 229376
    buffer_load_dwordx4 v7, s[8:11], s36 offen lds
    s_add_u32 m0, s33, 32768
    s_add_u32 s36, s31, 262144
    buffer_load_dwordx4 v4, s[8:11], s36 offen lds
    s_mul_i32 s34, s28, 20480
    s_add_u32 s34, s34, 73728
    s_lshl_b32 s29, s28, 15
    s_add_u32 s29, s29, s39
    s_add_u32 s30, s29, 131072
    v_lshrrev_b32 v22, 3, v2
    v_and_b32 v23, 1, v22
    v_lshlrev_b32 v23, 3, v23
    v_bfe_u32 v24, v22, 1, 1
    v_lshl_add_u32 v23, v24, 2, v23
    v_lshrrev_b32 v24, 2, v22
    v_lshl_add_u32 v23, v24, 4, v23
    v_lshlrev_b32 v23, 10, v23
    v_and_b32 v24, 7, v2
    v_xor_b32 v25, 0, v24
    v_lshl_add_u32 v12, v25, 4, v23
    v_xor_b32 v25, 2, v24
    v_lshl_add_u32 v13, v25, 4, v23
    v_xor_b32 v25, 4, v24
    v_lshl_add_u32 v14, v25, 4, v23
    v_xor_b32 v25, 6, v24
    v_lshl_add_u32 v15, v25, 4, v23
    s_add_u32 m0, s34, 0
    s_add_u32 s36, s29, 0
    buffer_load_dwordx4 v12, s[12:15], s36 offen offset:0 lds
    buffer_load_dwordx4 v13, s[12:15], s36 offen offset:1024 lds
    buffer_load_dwordx4 v14, s[12:15], s36 offen offset:2048 lds
    buffer_load_dwordx4 v15, s[12:15], s36 offen offset:3072 lds
    s_add_u32 m0, s34, 4096
    s_add_u32 s36, s29, 1048576
    buffer_load_dwordx4 v12, s[12:15], s36 offen offset:0 lds
    buffer_load_dwordx4 v13, s[12:15], s36 offen offset:1024 lds
    buffer_load_dwordx4 v14, s[12:15], s36 offen offset:2048 lds
    buffer_load_dwordx4 v15, s[12:15], s36 offen offset:3072 lds
    s_mov_b32 s35, 0
    s_lshl_b32 s50, s28, 2
    v_add_u32 v22, s50, v3
    v_add_u32 v23, 0, v20
    v_and_b32 v23, 7, v23
    v_lshlrev_b32 v23, 1, v23
    v_xor_b32 v23, v23, v22
    v_lshlrev_b32 v23, 4, v23
    v_lshl_add_u32 v10, v20, 11, v23
    v_add_u32 v23, 1, v20
    v_and_b32 v23, 7, v23
    v_lshlrev_b32 v23, 1, v23
    v_xor_b32 v23, v23, v22
    v_lshlrev_b32 v23, 4, v23
    v_lshl_add_u32 v11, v20, 11, v23
    v_lshrrev_b32 v22, 2, v20
    v_and_b32 v23, 3, v20
    v_and_b32 v24, 1, v3
    v_lshrrev_b32 v25, 1, v3
    v_lshl_add_u32 v24, v25, 2, v24
    v_lshlrev_b32 v24, 7, v24
    v_lshl_add_u32 v24, v22, 10, v24
    v_lshl_add_u32 v24, v23, 3, v24
    v_add_u32 v24, s34, v24
    v_xor_b32 v25, 0, v22
    v_lshl_add_u32 v16, v25, 5, v24
    v_xor_b32 v25, 1, v22
    v_lshl_add_u32 v17, v25, 5, v24
    v_xor_b32 v25, 2, v22
    v_lshl_add_u32 v18, v25, 5, v24
    v_xor_b32 v25, 3, v22
    v_lshl_add_u32 v19, v25, 5, v24
    v_mov_b32 v40, 0
    v_mov_b32 v41, 0
    v_mov_b32 v42, 0
    v_mov_b32 v43, 0
    v_mov_b32 v44, 0
    v_mov_b32 v45, 0
    v_mov_b32 v46, 0
    v_mov_b32 v47, 0
    v_mov_b32 v48, 0
    v_mov_b32 v49, 0
    v_mov_b32 v50, 0
    v_mov_b32 v51, 0
    v_mov_b32 v52, 0
    v_mov_b32 v53, 0
    v_mov_b32 v54, 0
    v_mov_b32 v55, 0
    v_mov_b32 v56, 0
    v_mov_b32 v57, 0
    v_mov_b32 v58, 0
    v_mov_b32 v59, 0
    v_mov_b32 v60, 0
    v_mov_b32 v61, 0
    v_mov_b32 v62, 0
    v_mov_b32 v63, 0
    v_mov_b32 v64, 0
    v_mov_b32 v65, 0
    v_mov_b32 v66, 0
    v_mov_b32 v67, 0
    v_mov_b32 v68, 0
    v_mov_b32 v69, 0
    v_mov_b32 v70, 0
    v_mov_b32 v71, 0
    v_mov_b32 v72, 0
    v_mov_b32 v73, 0
    v_mov_b32 v74, 0
    v_mov_b32 v75, 0
    v_mov_b32 v76, 0
    v_mov_b32 v77, 0
    v_mov_b32 v78, 0
    v_mov_b32 v79, 0
    v_mov_b32 v80, 0
    v_mov_b32 v81, 0
    v_mov_b32 v82, 0
    v_mov_b32 v83, 0
    v_mov_b32 v84, 0
    v_mov_b32 v85, 0
    v_mov_b32 v86, 0
    v_mov_b32 v87, 0
    v_mov_b32 v88, 0
    v_mov_b32 v89, 0
    v_mov_b32 v90, 0
    v_mov_b32 v91, 0
    v_mov_b32 v92, 0
    v_mov_b32 v93, 0
    v_mov_b32 v94, 0
    v_mov_b32 v95, 0
    v_mov_b32 v96, 0
    v_mov_b32 v97, 0
    v_mov_b32 v98, 0
    v_mov_b32 v99, 0
    v_mov_b32 v100, 0
    v_mov_b32 v101, 0
    v_mov_b32 v102, 0
    v_mov_b32 v103, 0
    v_mov_b32 v104, 0
    v_mov_b32 v105, 0
    v_mov_b32 v106, 0
    v_mov_b32 v107, 0
    v_mov_b32 v108, 0
    v_mov_b32 v109, 0
    v_mov_b32 v110, 0
    v_mov_b32 v111, 0
    v_mov_b32 v112, 0
    v_mov_b32 v113, 0
    v_mov_b32 v114, 0
    v_mov_b32 v115, 0
    v_mov_b32 v116, 0
    v_mov_b32 v117, 0
    v_mov_b32 v118, 0
    v_mov_b32 v119, 0
    v_mov_b32 v120, 0
    v_mov_b32 v121, 0
    v_mov_b32 v122, 0
    v_mov_b32 v123, 0
    v_mov_b32 v124, 0
    v_mov_b32 v125, 0
    v_mov_b32 v126, 0
    v_mov_b32 v127, 0
    v_mov_b32 v128, 0
    v_mov_b32 v129, 0
    v_mov_b32 v130, 0
    v_mov_b32 v131, 0
    v_mov_b32 v132, 0
    v_mov_b32 v133, 0
    v_mov_b32 v134, 0
    v_mov_b32 v135, 0
    v_mov_b32 v136, 0
    v_mov_b32 v137, 0
    v_mov_b32 v138, 0
    v_mov_b32 v139, 0
    v_mov_b32 v140, 0
    v_mov_b32 v141, 0
    v_mov_b32 v142, 0
    v_mov_b32 v143, 0
    v_mov_b32 v144, 0
    v_mov_b32 v145, 0
    v_mov_b32 v146, 0
    v_mov_b32 v147, 0
    v_mov_b32 v148, 0
    v_mov_b32 v149, 0
    v_mov_b32 v150, 0
    v_mov_b32 v151, 0
    v_mov_b32 v152, 0
    v_mov_b32 v153, 0
    v_mov_b32 v154, 0
    v_mov_b32 v155, 0
    v_mov_b32 v156, 0
    v_mov_b32 v157, 0
    v_mov_b32 v158, 0
    v_mov_b32 v159, 0
    v_mov_b32 v160, 0
    v_mov_b32 v161, 0
    v_mov_b32 v162, 0
    v_mov_b32 v163, 0
    v_mov_b32 v164, 0
    v_mov_b32 v165, 0
    v_mov_b32 v166, 0
    v_mov_b32 v167, 0
    s_waitcnt vmcnt(8)
    s_barrier
    ds_read_b128 a[24:27], v10 offset:0
    ds_read_b128 a[28:31], v10 offset:256
    ds_read_b128 a[32:35], v10 offset:512
    ds_read_b128 a[36:39], v10 offset:768
    ds_read_b128 a[40:43], v10 offset:1024
    ds_read_b128 a[44:47], v10 offset:1280
    ds_read_b128 a[60:63], v10 offset:1536
    ds_read_b128 a[64:67], v10 offset:1792
    s_waitcnt vmcnt(4)
    ds_read_b64_tr_b16 a[72:73], v16 offset:0
    ds_read_b64_tr_b16 a[74:75], v16 offset:256
    ds_read_b64_tr_b16 a[76:77], v17 offset:0
    ds_read_b64_tr_b16 a[78:79], v17 offset:256
    ds_read_b64_tr_b16 a[80:81], v18 offset:0
    ds_read_b64_tr_b16 a[82:83], v18 offset:256
    s_waitcnt lgkmcnt(0)
    v_mfma_f32_16x16x32_bf16 v[40:43], a[72:75], a[24:27], v[40:43]
    ds_read_b64_tr_b16 a[84:85], v19 offset:0
    v_mfma_f32_16x16x32_bf16 v[56:59], a[72:75], a[28:31], v[56:59]
    ds_read_b64_tr_b16 a[86:87], v19 offset:256
    s_add_u32 m0, s34, 8192
    s_add_u32 s36, s29, 2097152
    v_mfma_f32_16x16x32_bf16 v[72:75], a[72:75], a[32:35], v[72:75]
    buffer_load_dwordx4 v12, s[12:15], s36 offen offset:0 lds
    v_mfma_f32_16x16x32_bf16 v[88:91], a[72:75], a[36:39], v[88:91]
    buffer_load_dwordx4 v13, s[12:15], s36 offen offset:1024 lds
    v_mfma_f32_16x16x32_bf16 v[104:107], a[72:75], a[40:43], v[104:107]
    v_mfma_f32_16x16x32_bf16 v[120:123], a[72:75], a[44:47], v[120:123]
    buffer_load_dwordx4 v14, s[12:15], s36 offen offset:2048 lds
    v_mfma_f32_16x16x32_bf16 v[136:139], a[72:75], a[60:63], v[136:139]
    buffer_load_dwordx4 v15, s[12:15], s36 offen offset:3072 lds
    v_mfma_f32_16x16x32_bf16 v[152:155], a[72:75], a[64:67], v[152:155]
    v_mfma_f32_16x16x32_bf16 v[44:47], a[76:79], a[24:27], v[44:47]
    s_waitcnt vmcnt(4)
    v_mfma_f32_16x16x32_bf16 v[60:63], a[76:79], a[28:31], v[60:63]
    ds_read_b64_tr_b16 a[72:73], v16 offset:4096
    v_mfma_f32_16x16x32_bf16 v[76:79], a[76:79], a[32:35], v[76:79]
    ds_read_b64_tr_b16 a[74:75], v16 offset:4352
    s_add_u32 m0, s34, 12288
    s_add_u32 s36, s29, 3145728
    v_mfma_f32_16x16x32_bf16 v[92:95], a[76:79], a[36:39], v[92:95]
    buffer_load_dwordx4 v12, s[12:15], s36 offen offset:0 lds
    v_mfma_f32_16x16x32_bf16 v[108:111], a[76:79], a[40:43], v[108:111]
    ds_read_b128 a[0:3], v11 offset:2048
    v_mfma_f32_16x16x32_bf16 v[124:127], a[76:79], a[44:47], v[124:127]
    buffer_load_dwordx4 v13, s[12:15], s36 offen offset:1024 lds
    v_mfma_f32_16x16x32_bf16 v[140:143], a[76:79], a[60:63], v[140:143]
    buffer_load_dwordx4 v14, s[12:15], s36 offen offset:2048 lds
    ds_read_b128 a[4:7], v11 offset:2304
    v_mfma_f32_16x16x32_bf16 v[156:159], a[76:79], a[64:67], v[156:159]
    buffer_load_dwordx4 v15, s[12:15], s36 offen offset:3072 lds
    v_mfma_f32_16x16x32_bf16 v[48:51], a[80:83], a[24:27], v[48:51]
    ds_read_b64_tr_b16 a[76:77], v17 offset:4096
    v_mfma_f32_16x16x32_bf16 v[64:67], a[80:83], a[28:31], v[64:67]
    ds_read_b64_tr_b16 a[78:79], v17 offset:4352
    v_mfma_f32_16x16x32_bf16 v[80:83], a[80:83], a[32:35], v[80:83]
    s_add_u32 m0, s33, 36864
    s_nop 0
    v_mfma_f32_16x16x32_bf16 v[96:99], a[80:83], a[36:39], v[96:99]
    buffer_load_dwordx4 v9, s[8:11], s32 offen lds
    v_mfma_f32_16x16x32_bf16 v[112:115], a[80:83], a[40:43], v[112:115]
    s_add_u32 m0, s33, 40960
    s_add_u32 s36, s31, 33792
    v_mfma_f32_16x16x32_bf16 v[128:131], a[80:83], a[44:47], v[128:131]
    buffer_load_dwordx4 v5, s[8:11], s36 offen lds
    v_mfma_f32_16x16x32_bf16 v[144:147], a[80:83], a[60:63], v[144:147]
    s_add_u32 m0, s33, 45056
    s_add_u32 s36, s31, 66560
    v_mfma_f32_16x16x32_bf16 v[160:163], a[80:83], a[64:67], v[160:163]
    buffer_load_dwordx4 v6, s[8:11], s36 offen lds
    s_waitcnt lgkmcnt(6)
    v_mfma_f32_16x16x32_bf16 v[52:55], a[84:87], a[24:27], v[52:55]
    ds_read_b64_tr_b16 a[80:81], v18 offset:4096
    v_mfma_f32_16x16x32_bf16 v[68:71], a[84:87], a[28:31], v[68:71]
    ds_read_b64_tr_b16 a[82:83], v18 offset:4352
    v_mfma_f32_16x16x32_bf16 v[84:87], a[84:87], a[32:35], v[84:87]
    s_add_u32 m0, s33, 49152
    s_add_u32 s36, s31, 99328
    v_mfma_f32_16x16x32_bf16 v[100:103], a[84:87], a[36:39], v[100:103]
    buffer_load_dwordx4 v7, s[8:11], s36 offen lds
    v_mfma_f32_16x16x32_bf16 v[116:119], a[84:87], a[40:43], v[116:119]
    v_mfma_f32_16x16x32_bf16 v[132:135], a[84:87], a[44:47], v[132:135]
    v_mfma_f32_16x16x32_bf16 v[148:151], a[84:87], a[60:63], v[148:151]
    v_mfma_f32_16x16x32_bf16 v[164:167], a[84:87], a[64:67], v[164:167]
    s_waitcnt lgkmcnt(6)
    v_mfma_f32_16x16x32_bf16 v[40:43], a[72:75], a[28:31], v[40:43]
    ds_read_b64_tr_b16 a[84:85], v19 offset:4096
    v_mfma_f32_16x16x32_bf16 v[56:59], a[72:75], a[32:35], v[56:59]
    ds_read_b64_tr_b16 a[86:87], v19 offset:4352
    s_add_u32 m0, s34, 16384
    s_add_u32 s36, s29, 4194304
    v_mfma_f32_16x16x32_bf16 v[72:75], a[72:75], a[36:39], v[72:75]
    buffer_load_dwordx4 v12, s[12:15], s36 offen offset:0 lds
    v_mfma_f32_16x16x32_bf16 v[88:91], a[72:75], a[40:43], v[88:91]
    buffer_load_dwordx4 v13, s[12:15], s36 offen offset:1024 lds
    v_mfma_f32_16x16x32_bf16 v[104:107], a[72:75], a[44:47], v[104:107]
    v_mfma_f32_16x16x32_bf16 v[120:123], a[72:75], a[60:63], v[120:123]
    buffer_load_dwordx4 v14, s[12:15], s36 offen offset:2048 lds
    v_mfma_f32_16x16x32_bf16 v[136:139], a[72:75], a[64:67], v[136:139]
    buffer_load_dwordx4 v15, s[12:15], s36 offen offset:3072 lds
    s_waitcnt lgkmcnt(7)
    v_mfma_f32_16x16x32_bf16 v[152:155], a[72:75], a[0:3], v[152:155]
    s_waitcnt lgkmcnt(4)
    v_mfma_f32_16x16x32_bf16 v[44:47], a[76:79], a[28:31], v[44:47]
    s_waitcnt vmcnt(12)
    v_mfma_f32_16x16x32_bf16 v[60:63], a[76:79], a[32:35], v[60:63]
    ds_read_b64_tr_b16 a[72:73], v16 offset:8192
    v_mfma_f32_16x16x32_bf16 v[76:79], a[76:79], a[36:39], v[76:79]
    ds_read_b64_tr_b16 a[74:75], v16 offset:8448
    s_add_u32 m0, s33, 53248
    s_add_u32 s36, s31, 132096
    v_mfma_f32_16x16x32_bf16 v[92:95], a[76:79], a[40:43], v[92:95]
    buffer_load_dwordx4 v4, s[8:11], s36 offen lds
    v_mfma_f32_16x16x32_bf16 v[108:111], a[76:79], a[44:47], v[108:111]
    s_add_u32 m0, s33, 57344
    s_add_u32 s36, s31, 164864
    ds_read_b128 a[8:11], v11 offset:2560
    v_mfma_f32_16x16x32_bf16 v[124:127], a[76:79], a[60:63], v[124:127]
    buffer_load_dwordx4 v5, s[8:11], s36 offen lds
    v_mfma_f32_16x16x32_bf16 v[140:143], a[76:79], a[64:67], v[140:143]
    s_add_u32 m0, s33, 61440
    s_add_u32 s36, s31, 197632
    ds_read_b128 a[12:15], v11 offset:2816
    v_mfma_f32_16x16x32_bf16 v[156:159], a[76:79], a[0:3], v[156:159]
    buffer_load_dwordx4 v6, s[8:11], s36 offen lds
    s_waitcnt lgkmcnt(6)
    v_mfma_f32_16x16x32_bf16 v[48:51], a[80:83], a[28:31], v[48:51]
    ds_read_b64_tr_b16 a[76:77], v17 offset:8192
    v_mfma_f32_16x16x32_bf16 v[64:67], a[80:83], a[32:35], v[64:67]
    ds_read_b64_tr_b16 a[78:79], v17 offset:8448
    v_mfma_f32_16x16x32_bf16 v[80:83], a[80:83], a[36:39], v[80:83]
    s_add_u32 m0, s34, 0
    s_add_u32 s36, s29, 5242880
    v_mfma_f32_16x16x32_bf16 v[96:99], a[80:83], a[40:43], v[96:99]
    v_mfma_f32_16x16x32_bf16 v[112:115], a[80:83], a[44:47], v[112:115]
    buffer_load_dwordx4 v12, s[12:15], s36 offen offset:0 lds
    v_mfma_f32_16x16x32_bf16 v[128:131], a[80:83], a[60:63], v[128:131]
    v_mfma_f32_16x16x32_bf16 v[144:147], a[80:83], a[64:67], v[144:147]
    buffer_load_dwordx4 v13, s[12:15], s36 offen offset:1024 lds
    v_mfma_f32_16x16x32_bf16 v[160:163], a[80:83], a[0:3], v[160:163]
    s_waitcnt lgkmcnt(6)
    v_mfma_f32_16x16x32_bf16 v[52:55], a[84:87], a[28:31], v[52:55]
    ds_read_b64_tr_b16 a[80:81], v18 offset:8192
    v_mfma_f32_16x16x32_bf16 v[68:71], a[84:87], a[32:35], v[68:71]
    ds_read_b64_tr_b16 a[82:83], v18 offset:8448
    v_mfma_f32_16x16x32_bf16 v[84:87], a[84:87], a[36:39], v[84:87]
    buffer_load_dwordx4 v14, s[12:15], s36 offen offset:2048 lds
    v_mfma_f32_16x16x32_bf16 v[100:103], a[84:87], a[40:43], v[100:103]
    v_mfma_f32_16x16x32_bf16 v[116:119], a[84:87], a[44:47], v[116:119]
    buffer_load_dwordx4 v15, s[12:15], s36 offen offset:3072 lds
    v_mfma_f32_16x16x32_bf16 v[132:135], a[84:87], a[60:63], v[132:135]
    v_mfma_f32_16x16x32_bf16 v[148:151], a[84:87], a[64:67], v[148:151]
    v_mfma_f32_16x16x32_bf16 v[164:167], a[84:87], a[0:3], v[164:167]
    s_waitcnt lgkmcnt(6)
    v_mfma_f32_16x16x32_bf16 v[40:43], a[72:75], a[32:35], v[40:43]
    ds_read_b64_tr_b16 a[84:85], v19 offset:8192
    v_mfma_f32_16x16x32_bf16 v[56:59], a[72:75], a[36:39], v[56:59]
    ds_read_b64_tr_b16 a[86:87], v19 offset:8448
    s_add_u32 m0, s33, 65536
    s_add_u32 s36, s31, 230400
    v_mfma_f32_16x16x32_bf16 v[72:75], a[72:75], a[40:43], v[72:75]
    buffer_load_dwordx4 v7, s[8:11], s36 offen lds
    v_mfma_f32_16x16x32_bf16 v[88:91], a[72:75], a[44:47], v[88:91]
    s_add_u32 m0, s33, 69632
    s_add_u32 s36, s31, 263168
    v_mfma_f32_16x16x32_bf16 v[104:107], a[72:75], a[60:63], v[104:107]
    buffer_load_dwordx4 v4, s[8:11], s36 offen lds
    v_mfma_f32_16x16x32_bf16 v[120:123], a[72:75], a[64:67], v[120:123]
    s_add_u32 s31, s31, 256
    s_add_u32 s32, s32, 256
    v_mfma_f32_16x16x32_bf16 v[136:139], a[72:75], a[0:3], v[136:139]
    v_mfma_f32_16x16x32_bf16 v[152:155], a[72:75], a[4:7], v[152:155]
    s_waitcnt lgkmcnt(4)
    v_mfma_f32_16x16x32_bf16 v[44:47], a[76:79], a[32:35], v[44:47]
    s_waitcnt vmcnt(17)
    v_mfma_f32_16x16x32_bf16 v[60:63], a[76:79], a[36:39], v[60:63]
    ds_read_b64_tr_b16 a[72:73], v16 offset:12288
    v_mfma_f32_16x16x32_bf16 v[76:79], a[76:79], a[40:43], v[76:79]
    ds_read_b64_tr_b16 a[74:75], v16 offset:12544
    s_add_u32 m0, s34, 4096
    s_add_u32 s36, s29, 6291456
    v_mfma_f32_16x16x32_bf16 v[92:95], a[76:79], a[44:47], v[92:95]
    buffer_load_dwordx4 v12, s[12:15], s36 offen offset:0 lds
    v_mfma_f32_16x16x32_bf16 v[108:111], a[76:79], a[60:63], v[108:111]
    ds_read_b128 a[16:19], v11 offset:3072
    v_mfma_f32_16x16x32_bf16 v[124:127], a[76:79], a[64:67], v[124:127]
    buffer_load_dwordx4 v13, s[12:15], s36 offen offset:1024 lds
    v_mfma_f32_16x16x32_bf16 v[140:143], a[76:79], a[0:3], v[140:143]
    buffer_load_dwordx4 v14, s[12:15], s36 offen offset:2048 lds
    ds_read_b128 a[20:23], v11 offset:3328
    v_mfma_f32_16x16x32_bf16 v[156:159], a[76:79], a[4:7], v[156:159]
    buffer_load_dwordx4 v15, s[12:15], s36 offen offset:3072 lds
    s_waitcnt lgkmcnt(6)
    v_mfma_f32_16x16x32_bf16 v[48:51], a[80:83], a[32:35], v[48:51]
    ds_read_b64_tr_b16 a[76:77], v17 offset:12288
    v_mfma_f32_16x16x32_bf16 v[64:67], a[80:83], a[36:39], v[64:67]
    ds_read_b64_tr_b16 a[78:79], v17 offset:12544
    v_mfma_f32_16x16x32_bf16 v[80:83], a[80:83], a[40:43], v[80:83]
    s_add_u32 m0, s34, 8192
    s_add_u32 s36, s29, 7340032
    v_mfma_f32_16x16x32_bf16 v[96:99], a[80:83], a[44:47], v[96:99]
    s_waitcnt lgkmcnt(6)
    v_mfma_f32_16x16x32_bf16 v[112:115], a[80:83], a[60:63], v[112:115]
    buffer_load_dwordx4 v12, s[12:15], s36 offen offset:0 lds
    v_mfma_f32_16x16x32_bf16 v[128:131], a[80:83], a[64:67], v[128:131]
    v_mfma_f32_16x16x32_bf16 v[144:147], a[80:83], a[0:3], v[144:147]
    buffer_load_dwordx4 v13, s[12:15], s36 offen offset:1024 lds
    v_mfma_f32_16x16x32_bf16 v[160:163], a[80:83], a[4:7], v[160:163]
    v_mfma_f32_16x16x32_bf16 v[52:55], a[84:87], a[32:35], v[52:55]
    ds_read_b64_tr_b16 a[80:81], v18 offset:12288
    v_mfma_f32_16x16x32_bf16 v[68:71], a[84:87], a[36:39], v[68:71]
    ds_read_b64_tr_b16 a[82:83], v18 offset:12544
    v_mfma_f32_16x16x32_bf16 v[84:87], a[84:87], a[40:43], v[84:87]
    buffer_load_dwordx4 v14, s[12:15], s36 offen offset:2048 lds
    v_mfma_f32_16x16x32_bf16 v[100:103], a[84:87], a[44:47], v[100:103]
    v_mfma_f32_16x16x32_bf16 v[116:119], a[84:87], a[60:63], v[116:119]
    buffer_load_dwordx4 v15, s[12:15], s36 offen offset:3072 lds
    v_mfma_f32_16x16x32_bf16 v[132:135], a[84:87], a[64:67], v[132:135]
    v_mfma_f32_16x16x32_bf16 v[148:151], a[84:87], a[0:3], v[148:151]
    v_mfma_f32_16x16x32_bf16 v[164:167], a[84:87], a[4:7], v[164:167]
    s_waitcnt lgkmcnt(6)
    v_mfma_f32_16x16x32_bf16 v[40:43], a[72:75], a[36:39], v[40:43]
    ds_read_b64_tr_b16 a[84:85], v19 offset:12288
    v_mfma_f32_16x16x32_bf16 v[56:59], a[72:75], a[40:43], v[56:59]
    ds_read_b64_tr_b16 a[86:87], v19 offset:12544
    v_mfma_f32_16x16x32_bf16 v[72:75], a[72:75], a[44:47], v[72:75]
    v_mfma_f32_16x16x32_bf16 v[88:91], a[72:75], a[60:63], v[88:91]
    v_mfma_f32_16x16x32_bf16 v[104:107], a[72:75], a[64:67], v[104:107]
    v_mfma_f32_16x16x32_bf16 v[120:123], a[72:75], a[0:3], v[120:123]
    v_mfma_f32_16x16x32_bf16 v[136:139], a[72:75], a[4:7], v[136:139]
    v_mfma_f32_16x16x32_bf16 v[152:155], a[72:75], a[8:11], v[152:155]
    s_waitcnt lgkmcnt(4)
    v_mfma_f32_16x16x32_bf16 v[44:47], a[76:79], a[36:39], v[44:47]
    s_waitcnt vmcnt(17)
    v_mfma_f32_16x16x32_bf16 v[60:63], a[76:79], a[40:43], v[60:63]
    ds_read_b64_tr_b16 a[72:73], v16 offset:16384
    v_mfma_f32_16x16x32_bf16 v[76:79], a[76:79], a[44:47], v[76:79]
    ds_read_b64_tr_b16 a[74:75], v16 offset:16640
    v_mfma_f32_16x16x32_bf16 v[92:95], a[76:79], a[60:63], v[92:95]
    v_mfma_f32_16x16x32_bf16 v[108:111], a[76:79], a[64:67], v[108:111]
    ds_read_b128 a[24:27], v11 offset:3584
    v_mfma_f32_16x16x32_bf16 v[124:127], a[76:79], a[0:3], v[124:127]
    v_mfma_f32_16x16x32_bf16 v[140:143], a[76:79], a[4:7], v[140:143]
    v_mfma_f32_16x16x32_bf16 v[156:159], a[76:79], a[8:11], v[156:159]
    s_waitcnt lgkmcnt(5)
    v_mfma_f32_16x16x32_bf16 v[48:51], a[80:83], a[36:39], v[48:51]
    ds_read_b64_tr_b16 a[76:77], v17 offset:16384
    v_mfma_f32_16x16x32_bf16 v[64:67], a[80:83], a[40:43], v[64:67]
    ds_read_b64_tr_b16 a[78:79], v17 offset:16640
    v_mfma_f32_16x16x32_bf16 v[80:83], a[80:83], a[44:47], v[80:83]
    s_add_u32 m0, s34, 12288
    s_add_u32 s36, s29, 524288
    v_mfma_f32_16x16x32_bf16 v[96:99], a[80:83], a[60:63], v[96:99]
    s_waitcnt lgkmcnt(5)
    v_mfma_f32_16x16x32_bf16 v[112:115], a[80:83], a[64:67], v[112:115]
    buffer_load_dwordx4 v12, s[12:15], s36 offen offset:0 lds
    v_mfma_f32_16x16x32_bf16 v[128:131], a[80:83], a[0:3], v[128:131]
    v_mfma_f32_16x16x32_bf16 v[144:147], a[80:83], a[4:7], v[144:147]
    buffer_load_dwordx4 v13, s[12:15], s36 offen offset:1024 lds
    v_mfma_f32_16x16x32_bf16 v[160:163], a[80:83], a[8:11], v[160:163]
    v_mfma_f32_16x16x32_bf16 v[52:55], a[84:87], a[36:39], v[52:55]
    ds_read_b64_tr_b16 a[80:81], v18 offset:16384
    v_mfma_f32_16x16x32_bf16 v[68:71], a[84:87], a[40:43], v[68:71]
    ds_read_b64_tr_b16 a[82:83], v18 offset:16640
    v_mfma_f32_16x16x32_bf16 v[84:87], a[84:87], a[44:47], v[84:87]
    buffer_load_dwordx4 v14, s[12:15], s36 offen offset:2048 lds
    v_mfma_f32_16x16x32_bf16 v[100:103], a[84:87], a[60:63], v[100:103]
    v_mfma_f32_16x16x32_bf16 v[116:119], a[84:87], a[64:67], v[116:119]
    buffer_load_dwordx4 v15, s[12:15], s36 offen offset:3072 lds
    v_mfma_f32_16x16x32_bf16 v[132:135], a[84:87], a[0:3], v[132:135]
    v_mfma_f32_16x16x32_bf16 v[148:151], a[84:87], a[4:7], v[148:151]
    v_mfma_f32_16x16x32_bf16 v[164:167], a[84:87], a[8:11], v[164:167]
    s_waitcnt lgkmcnt(0)
    s_waitcnt vmcnt(12)
    s_barrier
    v_mfma_f32_16x16x32_bf16 v[40:43], a[72:75], a[40:43], v[40:43]
    ds_read_b64_tr_b16 a[84:85], v19 offset:16384
    v_mfma_f32_16x16x32_bf16 v[56:59], a[72:75], a[44:47], v[56:59]
    ds_read_b64_tr_b16 a[86:87], v19 offset:16640
    v_mfma_f32_16x16x32_bf16 v[72:75], a[72:75], a[60:63], v[72:75]
    s_add_u32 m0, s33, 0
    s_nop 0
    v_mfma_f32_16x16x32_bf16 v[88:91], a[72:75], a[64:67], v[88:91]
    buffer_load_dwordx4 v8, s[8:11], s32 offen lds
    v_mfma_f32_16x16x32_bf16 v[104:107], a[72:75], a[0:3], v[104:107]
    s_add_u32 m0, s33, 4096
    s_add_u32 s36, s31, 32768
    v_mfma_f32_16x16x32_bf16 v[120:123], a[72:75], a[4:7], v[120:123]
    buffer_load_dwordx4 v5, s[8:11], s36 offen lds
    v_mfma_f32_16x16x32_bf16 v[136:139], a[72:75], a[8:11], v[136:139]
    s_add_u32 m0, s33, 8192
    s_add_u32 s36, s31, 65536
    v_mfma_f32_16x16x32_bf16 v[152:155], a[72:75], a[12:15], v[152:155]
    buffer_load_dwordx4 v6, s[8:11], s36 offen lds
    v_mfma_f32_16x16x32_bf16 v[44:47], a[76:79], a[40:43], v[44:47]
    v_mfma_f32_16x16x32_bf16 v[60:63], a[76:79], a[44:47], v[60:63]
    ds_read_b64_tr_b16 a[72:73], v16 offset:0
    v_mfma_f32_16x16x32_bf16 v[76:79], a[76:79], a[60:63], v[76:79]
    ds_read_b64_tr_b16 a[74:75], v16 offset:256
    v_mfma_f32_16x16x32_bf16 v[92:95], a[76:79], a[64:67], v[92:95]
    s_add_u32 m0, s33, 12288
    s_add_u32 s36, s31, 98304
    v_mfma_f32_16x16x32_bf16 v[108:111], a[76:79], a[0:3], v[108:111]
    ds_read_b128 a[28:31], v10 offset:36864
    v_mfma_f32_16x16x32_bf16 v[124:127], a[76:79], a[4:7], v[124:127]
    buffer_load_dwordx4 v7, s[8:11], s36 offen lds
    v_mfma_f32_16x16x32_bf16 v[140:143], a[76:79], a[8:11], v[140:143]
    ds_read_b128 a[32:35], v10 offset:37120
    s_add_u32 m0, s33, 16384
    s_add_u32 s36, s31, 131072
    v_mfma_f32_16x16x32_bf16 v[156:159], a[76:79], a[12:15], v[156:159]
    buffer_load_dwordx4 v4, s[8:11], s36 offen lds
    v_mfma_f32_16x16x32_bf16 v[48:51], a[80:83], a[40:43], v[48:51]
    ds_read_b64_tr_b16 a[76:77], v17 offset:0
    v_mfma_f32_16x16x32_bf16 v[64:67], a[80:83], a[44:47], v[64:67]
    ds_read_b64_tr_b16 a[78:79], v17 offset:256
    v_mfma_f32_16x16x32_bf16 v[80:83], a[80:83], a[60:63], v[80:83]
    s_add_u32 m0, s34, 16384
    s_add_u32 s36, s29, 1572864
    v_mfma_f32_16x16x32_bf16 v[96:99], a[80:83], a[64:67], v[96:99]
    s_waitcnt lgkmcnt(6)
    v_mfma_f32_16x16x32_bf16 v[112:115], a[80:83], a[0:3], v[112:115]
    buffer_load_dwordx4 v12, s[12:15], s36 offen offset:0 lds
    v_mfma_f32_16x16x32_bf16 v[128:131], a[80:83], a[4:7], v[128:131]
    v_mfma_f32_16x16x32_bf16 v[144:147], a[80:83], a[8:11], v[144:147]
    buffer_load_dwordx4 v13, s[12:15], s36 offen offset:1024 lds
    v_mfma_f32_16x16x32_bf16 v[160:163], a[80:83], a[12:15], v[160:163]
    v_mfma_f32_16x16x32_bf16 v[52:55], a[84:87], a[40:43], v[52:55]
    ds_read_b64_tr_b16 a[80:81], v18 offset:0
    v_mfma_f32_16x16x32_bf16 v[68:71], a[84:87], a[44:47], v[68:71]
    ds_read_b64_tr_b16 a[82:83], v18 offset:256
    v_mfma_f32_16x16x32_bf16 v[84:87], a[84:87], a[60:63], v[84:87]
    buffer_load_dwordx4 v14, s[12:15], s36 offen offset:2048 lds
    v_mfma_f32_16x16x32_bf16 v[100:103], a[84:87], a[64:67], v[100:103]
    v_mfma_f32_16x16x32_bf16 v[116:119], a[84:87], a[0:3], v[116:119]
    buffer_load_dwordx4 v15, s[12:15], s36 offen offset:3072 lds
    v_mfma_f32_16x16x32_bf16 v[132:135], a[84:87], a[4:7], v[132:135]
    v_mfma_f32_16x16x32_bf16 v[148:151], a[84:87], a[8:11], v[148:151]
    v_mfma_f32_16x16x32_bf16 v[164:167], a[84:87], a[12:15], v[164:167]
    s_waitcnt lgkmcnt(6)
    v_mfma_f32_16x16x32_bf16 v[40:43], a[72:75], a[44:47], v[40:43]
    ds_read_b64_tr_b16 a[84:85], v19 offset:0
    v_mfma_f32_16x16x32_bf16 v[56:59], a[72:75], a[60:63], v[56:59]
    ds_read_b64_tr_b16 a[86:87], v19 offset:256
    v_mfma_f32_16x16x32_bf16 v[72:75], a[72:75], a[64:67], v[72:75]
    s_add_u32 m0, s33, 20480
    s_add_u32 s36, s31, 163840
    v_mfma_f32_16x16x32_bf16 v[88:91], a[72:75], a[0:3], v[88:91]
    buffer_load_dwordx4 v5, s[8:11], s36 offen lds
    v_mfma_f32_16x16x32_bf16 v[104:107], a[72:75], a[4:7], v[104:107]
    s_add_u32 m0, s33, 24576
    s_add_u32 s36, s31, 196608
    v_mfma_f32_16x16x32_bf16 v[120:123], a[72:75], a[8:11], v[120:123]
    buffer_load_dwordx4 v6, s[8:11], s36 offen lds
    v_mfma_f32_16x16x32_bf16 v[136:139], a[72:75], a[12:15], v[136:139]
    s_add_u32 m0, s33, 28672
    s_add_u32 s36, s31, 229376
    v_mfma_f32_16x16x32_bf16 v[152:155], a[72:75], a[16:19], v[152:155]
    buffer_load_dwordx4 v7, s[8:11], s36 offen lds
    s_waitcnt lgkmcnt(4)
    v_mfma_f32_16x16x32_bf16 v[44:47], a[76:79], a[44:47], v[44:47]
    s_waitcnt vmcnt(20)
    v_mfma_f32_16x16x32_bf16 v[60:63], a[76:79], a[60:63], v[60:63]
    ds_read_b64_tr_b16 a[72:73], v16 offset:4096
    v_mfma_f32_16x16x32_bf16 v[76:79], a[76:79], a[64:67], v[76:79]
    ds_read_b64_tr_b16 a[74:75], v16 offset:4352
    v_mfma_f32_16x16x32_bf16 v[92:95], a[76:79], a[0:3], v[92:95]
    s_add_u32 m0, s33, 32768
    s_add_u32 s36, s31, 262144
    v_mfma_f32_16x16x32_bf16 v[108:111], a[76:79], a[4:7], v[108:111]
    ds_read_b128 a[36:39], v10 offset:37376
    v_mfma_f32_16x16x32_bf16 v[124:127], a[76:79], a[8:11], v[124:127]
    buffer_load_dwordx4 v4, s[8:11], s36 offen lds
    v_mfma_f32_16x16x32_bf16 v[140:143], a[76:79], a[12:15], v[140:143]
    ds_read_b128 a[40:43], v10 offset:37632
    v_mfma_f32_16x16x32_bf16 v[156:159], a[76:79], a[16:19], v[156:159]
    s_waitcnt lgkmcnt(6)
    v_mfma_f32_16x16x32_bf16 v[48:51], a[80:83], a[44:47], v[48:51]
    ds_read_b64_tr_b16 a[76:77], v17 offset:4096
    v_mfma_f32_16x16x32_bf16 v[64:67], a[80:83], a[60:63], v[64:67]
    ds_read_b64_tr_b16 a[78:79], v17 offset:4352
    v_mfma_f32_16x16x32_bf16 v[80:83], a[80:83], a[64:67], v[80:83]
    s_add_u32 m0, s34, 0
    s_add_u32 s36, s29, 2621440
    v_mfma_f32_16x16x32_bf16 v[96:99], a[80:83], a[0:3], v[96:99]
    s_waitcnt lgkmcnt(6)
    v_mfma_f32_16x16x32_bf16 v[112:115], a[80:83], a[4:7], v[112:115]
    buffer_load_dwordx4 v12, s[12:15], s36 offen offset:0 lds
    v_mfma_f32_16x16x32_bf16 v[128:131], a[80:83], a[8:11], v[128:131]
    v_mfma_f32_16x16x32_bf16 v[144:147], a[80:83], a[12:15], v[144:147]
    buffer_load_dwordx4 v13, s[12:15], s36 offen offset:1024 lds
    v_mfma_f32_16x16x32_bf16 v[160:163], a[80:83], a[16:19], v[160:163]
    v_mfma_f32_16x16x32_bf16 v[52:55], a[84:87], a[44:47], v[52:55]
    ds_read_b64_tr_b16 a[80:81], v18 offset:4096
    v_mfma_f32_16x16x32_bf16 v[68:71], a[84:87], a[60:63], v[68:71]
    ds_read_b64_tr_b16 a[82:83], v18 offset:4352
    v_mfma_f32_16x16x32_bf16 v[84:87], a[84:87], a[64:67], v[84:87]
    buffer_load_dwordx4 v14, s[12:15], s36 offen offset:2048 lds
    v_mfma_f32_16x16x32_bf16 v[100:103], a[84:87], a[0:3], v[100:103]
    v_mfma_f32_16x16x32_bf16 v[116:119], a[84:87], a[4:7], v[116:119]
    buffer_load_dwordx4 v15, s[12:15], s36 offen offset:3072 lds
    v_mfma_f32_16x16x32_bf16 v[132:135], a[84:87], a[8:11], v[132:135]
    v_mfma_f32_16x16x32_bf16 v[148:151], a[84:87], a[12:15], v[148:151]
    v_mfma_f32_16x16x32_bf16 v[164:167], a[84:87], a[16:19], v[164:167]
    s_waitcnt lgkmcnt(6)
    v_mfma_f32_16x16x32_bf16 v[40:43], a[72:75], a[60:63], v[40:43]
    ds_read_b64_tr_b16 a[84:85], v19 offset:4096
    v_mfma_f32_16x16x32_bf16 v[56:59], a[72:75], a[64:67], v[56:59]
    ds_read_b64_tr_b16 a[86:87], v19 offset:4352
    v_mfma_f32_16x16x32_bf16 v[72:75], a[72:75], a[0:3], v[72:75]
    v_mfma_f32_16x16x32_bf16 v[88:91], a[72:75], a[4:7], v[88:91]
    v_mfma_f32_16x16x32_bf16 v[104:107], a[72:75], a[8:11], v[104:107]
    v_mfma_f32_16x16x32_bf16 v[120:123], a[72:75], a[12:15], v[120:123]
    v_mfma_f32_16x16x32_bf16 v[136:139], a[72:75], a[16:19], v[136:139]
    v_mfma_f32_16x16x32_bf16 v[152:155], a[72:75], a[20:23], v[152:155]
    s_waitcnt lgkmcnt(4)
    v_mfma_f32_16x16x32_bf16 v[44:47], a[76:79], a[60:63], v[44:47]
    s_waitcnt vmcnt(21)
    v_mfma_f32_16x16x32_bf16 v[60:63], a[76:79], a[64:67], v[60:63]
    ds_read_b64_tr_b16 a[72:73], v16 offset:8192
    v_mfma_f32_16x16x32_bf16 v[76:79], a[76:79], a[0:3], v[76:79]
    ds_read_b64_tr_b16 a[74:75], v16 offset:8448
    v_mfma_f32_16x16x32_bf16 v[92:95], a[76:79], a[4:7], v[92:95]
    v_mfma_f32_16x16x32_bf16 v[108:111], a[76:79], a[8:11], v[108:111]
    ds_read_b128 a[44:47], v10 offset:37888
    v_mfma_f32_16x16x32_bf16 v[124:127], a[76:79], a[12:15], v[124:127]
    v_mfma_f32_16x16x32_bf16 v[140:143], a[76:79], a[16:19], v[140:143]
    ds_read_b128 a[48:51], v10 offset:38144
    v_mfma_f32_16x16x32_bf16 v[156:159], a[76:79], a[20:23], v[156:159]
    s_waitcnt lgkmcnt(6)
    v_mfma_f32_16x16x32_bf16 v[48:51], a[80:83], a[60:63], v[48:51]
    ds_read_b64_tr_b16 a[76:77], v17 offset:8192
    v_mfma_f32_16x16x32_bf16 v[64:67], a[80:83], a[64:67], v[64:67]
    ds_read_b64_tr_b16 a[78:79], v17 offset:8448
    v_mfma_f32_16x16x32_bf16 v[80:83], a[80:83], a[0:3], v[80:83]
    s_add_u32 m0, s34, 4096
    s_add_u32 s36, s29, 3670016
    v_mfma_f32_16x16x32_bf16 v[96:99], a[80:83], a[4:7], v[96:99]
    s_waitcnt lgkmcnt(6)
    v_mfma_f32_16x16x32_bf16 v[112:115], a[80:83], a[8:11], v[112:115]
    buffer_load_dwordx4 v12, s[12:15], s36 offen offset:0 lds
    v_mfma_f32_16x16x32_bf16 v[128:131], a[80:83], a[12:15], v[128:131]
    v_mfma_f32_16x16x32_bf16 v[144:147], a[80:83], a[16:19], v[144:147]
    buffer_load_dwordx4 v13, s[12:15], s36 offen offset:1024 lds
    v_mfma_f32_16x16x32_bf16 v[160:163], a[80:83], a[20:23], v[160:163]
    v_mfma_f32_16x16x32_bf16 v[52:55], a[84:87], a[60:63], v[52:55]
    ds_read_b64_tr_b16 a[80:81], v18 offset:8192
    v_mfma_f32_16x16x32_bf16 v[68:71], a[84:87], a[64:67], v[68:71]
    ds_read_b64_tr_b16 a[82:83], v18 offset:8448
    v_mfma_f32_16x16x32_bf16 v[84:87], a[84:87], a[0:3], v[84:87]
    buffer_load_dwordx4 v14, s[12:15], s36 offen offset:2048 lds
    v_mfma_f32_16x16x32_bf16 v[100:103], a[84:87], a[4:7], v[100:103]
    v_mfma_f32_16x16x32_bf16 v[116:119], a[84:87], a[8:11], v[116:119]
    buffer_load_dwordx4 v15, s[12:15], s36 offen offset:3072 lds
    v_mfma_f32_16x16x32_bf16 v[132:135], a[84:87], a[12:15], v[132:135]
    v_mfma_f32_16x16x32_bf16 v[148:151], a[84:87], a[16:19], v[148:151]
    v_mfma_f32_16x16x32_bf16 v[164:167], a[84:87], a[20:23], v[164:167]
    s_waitcnt lgkmcnt(6)
    v_mfma_f32_16x16x32_bf16 v[40:43], a[72:75], a[64:67], v[40:43]
    ds_read_b64_tr_b16 a[84:85], v19 offset:8192
    v_mfma_f32_16x16x32_bf16 v[56:59], a[72:75], a[0:3], v[56:59]
    ds_read_b64_tr_b16 a[86:87], v19 offset:8448
    v_mfma_f32_16x16x32_bf16 v[72:75], a[72:75], a[4:7], v[72:75]
    v_mfma_f32_16x16x32_bf16 v[88:91], a[72:75], a[8:11], v[88:91]
    v_mfma_f32_16x16x32_bf16 v[104:107], a[72:75], a[12:15], v[104:107]
    v_mfma_f32_16x16x32_bf16 v[120:123], a[72:75], a[16:19], v[120:123]
    v_mfma_f32_16x16x32_bf16 v[136:139], a[72:75], a[20:23], v[136:139]
    v_mfma_f32_16x16x32_bf16 v[152:155], a[72:75], a[24:27], v[152:155]
    s_waitcnt lgkmcnt(4)
    v_mfma_f32_16x16x32_bf16 v[44:47], a[76:79], a[64:67], v[44:47]
    s_waitcnt vmcnt(21)
    v_mfma_f32_16x16x32_bf16 v[60:63], a[76:79], a[0:3], v[60:63]
    ds_read_b64_tr_b16 a[72:73], v16 offset:12288
    v_mfma_f32_16x16x32_bf16 v[76:79], a[76:79], a[4:7], v[76:79]
    ds_read_b64_tr_b16 a[74:75], v16 offset:12544
    v_mfma_f32_16x16x32_bf16 v[92:95], a[76:79], a[8:11], v[92:95]
    v_mfma_f32_16x16x32_bf16 v[108:111], a[76:79], a[12:15], v[108:111]
    ds_read_b128 a[52:55], v10 offset:38400
    v_mfma_f32_16x16x32_bf16 v[124:127], a[76:79], a[16:19], v[124:127]
    v_mfma_f32_16x16x32_bf16 v[140:143], a[76:79], a[20:23], v[140:143]
    ds_read_b128 a[56:59], v10 offset:38656
    v_mfma_f32_16x16x32_bf16 v[156:159], a[76:79], a[24:27], v[156:159]
    s_waitcnt lgkmcnt(6)
    v_mfma_f32_16x16x32_bf16 v[48:51], a[80:83], a[64:67], v[48:51]
    ds_read_b64_tr_b16 a[76:77], v17 offset:12288
    v_mfma_f32_16x16x32_bf16 v[64:67], a[80:83], a[0:3], v[64:67]
    ds_read_b64_tr_b16 a[78:79], v17 offset:12544
    v_mfma_f32_16x16x32_bf16 v[80:83], a[80:83], a[4:7], v[80:83]
    s_add_u32 m0, s34, 8192
    s_add_u32 s36, s29, 4718592
    v_mfma_f32_16x16x32_bf16 v[96:99], a[80:83], a[8:11], v[96:99]
    s_waitcnt lgkmcnt(6)
    v_mfma_f32_16x16x32_bf16 v[112:115], a[80:83], a[12:15], v[112:115]
    buffer_load_dwordx4 v12, s[12:15], s36 offen offset:0 lds
    v_mfma_f32_16x16x32_bf16 v[128:131], a[80:83], a[16:19], v[128:131]
    v_mfma_f32_16x16x32_bf16 v[144:147], a[80:83], a[20:23], v[144:147]
    buffer_load_dwordx4 v13, s[12:15], s36 offen offset:1024 lds
    v_mfma_f32_16x16x32_bf16 v[160:163], a[80:83], a[24:27], v[160:163]
    v_mfma_f32_16x16x32_bf16 v[52:55], a[84:87], a[64:67], v[52:55]
    ds_read_b64_tr_b16 a[80:81], v18 offset:12288
    v_mfma_f32_16x16x32_bf16 v[68:71], a[84:87], a[0:3], v[68:71]
    ds_read_b64_tr_b16 a[82:83], v18 offset:12544
    v_mfma_f32_16x16x32_bf16 v[84:87], a[84:87], a[4:7], v[84:87]
    buffer_load_dwordx4 v14, s[12:15], s36 offen offset:2048 lds
    v_mfma_f32_16x16x32_bf16 v[100:103], a[84:87], a[8:11], v[100:103]
    v_mfma_f32_16x16x32_bf16 v[116:119], a[84:87], a[12:15], v[116:119]
    buffer_load_dwordx4 v15, s[12:15], s36 offen offset:3072 lds
    v_mfma_f32_16x16x32_bf16 v[132:135], a[84:87], a[16:19], v[132:135]
    v_mfma_f32_16x16x32_bf16 v[148:151], a[84:87], a[20:23], v[148:151]
    v_mfma_f32_16x16x32_bf16 v[164:167], a[84:87], a[24:27], v[164:167]
    s_waitcnt lgkmcnt(6)
    v_mfma_f32_16x16x32_bf16 v[40:43], a[72:75], a[28:31], v[40:43]
    ds_read_b64_tr_b16 a[84:85], v19 offset:12288
    v_mfma_f32_16x16x32_bf16 v[56:59], a[72:75], a[32:35], v[56:59]
    ds_read_b64_tr_b16 a[86:87], v19 offset:12544
    v_mfma_f32_16x16x32_bf16 v[72:75], a[72:75], a[36:39], v[72:75]
    v_mfma_f32_16x16x32_bf16 v[88:91], a[72:75], a[40:43], v[88:91]
    v_mfma_f32_16x16x32_bf16 v[104:107], a[72:75], a[44:47], v[104:107]
    v_mfma_f32_16x16x32_bf16 v[120:123], a[72:75], a[48:51], v[120:123]
    s_waitcnt lgkmcnt(7)
    v_mfma_f32_16x16x32_bf16 v[136:139], a[72:75], a[52:55], v[136:139]
    s_waitcnt lgkmcnt(6)
    v_mfma_f32_16x16x32_bf16 v[152:155], a[72:75], a[56:59], v[152:155]
    s_waitcnt lgkmcnt(4)
    v_mfma_f32_16x16x32_bf16 v[44:47], a[76:79], a[28:31], v[44:47]
    s_waitcnt vmcnt(16)
    v_mfma_f32_16x16x32_bf16 v[60:63], a[76:79], a[32:35], v[60:63]
    ds_read_b64_tr_b16 a[72:73], v16 offset:16384
    v_mfma_f32_16x16x32_bf16 v[76:79], a[76:79], a[36:39], v[76:79]
    ds_read_b64_tr_b16 a[74:75], v16 offset:16640
    v_mfma_f32_16x16x32_bf16 v[92:95], a[76:79], a[40:43], v[92:95]
    v_mfma_f32_16x16x32_bf16 v[108:111], a[76:79], a[44:47], v[108:111]
    ds_read_b128 a[0:3], v11 offset:38912
    v_mfma_f32_16x16x32_bf16 v[124:127], a[76:79], a[48:51], v[124:127]
    v_mfma_f32_16x16x32_bf16 v[140:143], a[76:79], a[52:55], v[140:143]
    ds_read_b128 a[4:7], v11 offset:39168
    v_mfma_f32_16x16x32_bf16 v[156:159], a[76:79], a[56:59], v[156:159]
    s_waitcnt lgkmcnt(6)
    v_mfma_f32_16x16x32_bf16 v[48:51], a[80:83], a[28:31], v[48:51]
    ds_read_b64_tr_b16 a[76:77], v17 offset:16384
    v_mfma_f32_16x16x32_bf16 v[64:67], a[80:83], a[32:35], v[64:67]
    ds_read_b64_tr_b16 a[78:79], v17 offset:16640
    v_mfma_f32_16x16x32_bf16 v[80:83], a[80:83], a[36:39], v[80:83]
    s_add_u32 m0, s34, 12288
    s_add_u32 s36, s29, 5767168
    v_mfma_f32_16x16x32_bf16 v[96:99], a[80:83], a[40:43], v[96:99]
    s_waitcnt lgkmcnt(6)
    v_mfma_f32_16x16x32_bf16 v[112:115], a[80:83], a[44:47], v[112:115]
    buffer_load_dwordx4 v12, s[12:15], s36 offen offset:0 lds
    v_mfma_f32_16x16x32_bf16 v[128:131], a[80:83], a[48:51], v[128:131]
    v_mfma_f32_16x16x32_bf16 v[144:147], a[80:83], a[52:55], v[144:147]
    buffer_load_dwordx4 v13, s[12:15], s36 offen offset:1024 lds
    v_mfma_f32_16x16x32_bf16 v[160:163], a[80:83], a[56:59], v[160:163]
    v_mfma_f32_16x16x32_bf16 v[52:55], a[84:87], a[28:31], v[52:55]
    ds_read_b64_tr_b16 a[80:81], v18 offset:16384
    v_mfma_f32_16x16x32_bf16 v[68:71], a[84:87], a[32:35], v[68:71]
    ds_read_b64_tr_b16 a[82:83], v18 offset:16640
    v_mfma_f32_16x16x32_bf16 v[84:87], a[84:87], a[36:39], v[84:87]
    buffer_load_dwordx4 v14, s[12:15], s36 offen offset:2048 lds
    v_mfma_f32_16x16x32_bf16 v[100:103], a[84:87], a[40:43], v[100:103]
    v_mfma_f32_16x16x32_bf16 v[116:119], a[84:87], a[44:47], v[116:119]
    buffer_load_dwordx4 v15, s[12:15], s36 offen offset:3072 lds
    v_mfma_f32_16x16x32_bf16 v[132:135], a[84:87], a[48:51], v[132:135]
    v_mfma_f32_16x16x32_bf16 v[148:151], a[84:87], a[52:55], v[148:151]
    v_mfma_f32_16x16x32_bf16 v[164:167], a[84:87], a[56:59], v[164:167]
    s_waitcnt lgkmcnt(6)
    v_mfma_f32_16x16x32_bf16 v[40:43], a[72:75], a[32:35], v[40:43]
    ds_read_b64_tr_b16 a[84:85], v19 offset:16384
    v_mfma_f32_16x16x32_bf16 v[56:59], a[72:75], a[36:39], v[56:59]
    ds_read_b64_tr_b16 a[86:87], v19 offset:16640
    v_mfma_f32_16x16x32_bf16 v[72:75], a[72:75], a[40:43], v[72:75]
    v_mfma_f32_16x16x32_bf16 v[88:91], a[72:75], a[44:47], v[88:91]
    v_mfma_f32_16x16x32_bf16 v[104:107], a[72:75], a[48:51], v[104:107]
    v_mfma_f32_16x16x32_bf16 v[120:123], a[72:75], a[52:55], v[120:123]
    v_mfma_f32_16x16x32_bf16 v[136:139], a[72:75], a[56:59], v[136:139]
    s_waitcnt lgkmcnt(7)
    v_mfma_f32_16x16x32_bf16 v[152:155], a[72:75], a[0:3], v[152:155]
    s_waitcnt lgkmcnt(4)
    v_mfma_f32_16x16x32_bf16 v[44:47], a[76:79], a[32:35], v[44:47]
    s_waitcnt vmcnt(12)
    v_mfma_f32_16x16x32_bf16 v[60:63], a[76:79], a[36:39], v[60:63]
    ds_read_b64_tr_b16 a[72:73], v16 offset:0
    v_mfma_f32_16x16x32_bf16 v[76:79], a[76:79], a[40:43], v[76:79]
    ds_read_b64_tr_b16 a[74:75], v16 offset:256
    v_mfma_f32_16x16x32_bf16 v[92:95], a[76:79], a[44:47], v[92:95]
    v_mfma_f32_16x16x32_bf16 v[108:111], a[76:79], a[48:51], v[108:111]
    ds_read_b128 a[8:11], v11 offset:39424
    v_mfma_f32_16x16x32_bf16 v[124:127], a[76:79], a[52:55], v[124:127]
    v_mfma_f32_16x16x32_bf16 v[140:143], a[76:79], a[56:59], v[140:143]
    ds_read_b128 a[12:15], v11 offset:39680
    v_mfma_f32_16x16x32_bf16 v[156:159], a[76:79], a[0:3], v[156:159]
    s_waitcnt lgkmcnt(6)
    v_mfma_f32_16x16x32_bf16 v[48:51], a[80:83], a[32:35], v[48:51]
    ds_read_b64_tr_b16 a[76:77], v17 offset:0
    v_mfma_f32_16x16x32_bf16 v[64:67], a[80:83], a[36:39], v[64:67]
    ds_read_b64_tr_b16 a[78:79], v17 offset:256
    v_mfma_f32_16x16x32_bf16 v[80:83], a[80:83], a[40:43], v[80:83]
    s_add_u32 m0, s34, 16384
    s_add_u32 s36, s29, 6815744
    v_mfma_f32_16x16x32_bf16 v[96:99], a[80:83], a[44:47], v[96:99]
    s_waitcnt lgkmcnt(6)
    v_mfma_f32_16x16x32_bf16 v[112:115], a[80:83], a[48:51], v[112:115]
    buffer_load_dwordx4 v12, s[12:15], s36 offen offset:0 lds
    v_mfma_f32_16x16x32_bf16 v[128:131], a[80:83], a[52:55], v[128:131]
    v_mfma_f32_16x16x32_bf16 v[144:147], a[80:83], a[56:59], v[144:147]
    buffer_load_dwordx4 v13, s[12:15], s36 offen offset:1024 lds
    v_mfma_f32_16x16x32_bf16 v[160:163], a[80:83], a[0:3], v[160:163]
    v_mfma_f32_16x16x32_bf16 v[52:55], a[84:87], a[32:35], v[52:55]
    ds_read_b64_tr_b16 a[80:81], v18 offset:0
    v_mfma_f32_16x16x32_bf16 v[68:71], a[84:87], a[36:39], v[68:71]
    ds_read_b64_tr_b16 a[82:83], v18 offset:256
    v_mfma_f32_16x16x32_bf16 v[84:87], a[84:87], a[40:43], v[84:87]
    buffer_load_dwordx4 v14, s[12:15], s36 offen offset:2048 lds
    v_mfma_f32_16x16x32_bf16 v[100:103], a[84:87], a[44:47], v[100:103]
    v_mfma_f32_16x16x32_bf16 v[116:119], a[84:87], a[48:51], v[116:119]
    buffer_load_dwordx4 v15, s[12:15], s36 offen offset:3072 lds
    v_mfma_f32_16x16x32_bf16 v[132:135], a[84:87], a[52:55], v[132:135]
    v_mfma_f32_16x16x32_bf16 v[148:151], a[84:87], a[56:59], v[148:151]
    v_mfma_f32_16x16x32_bf16 v[164:167], a[84:87], a[0:3], v[164:167]
    s_waitcnt lgkmcnt(6)
    v_mfma_f32_16x16x32_bf16 v[40:43], a[72:75], a[36:39], v[40:43]
    ds_read_b64_tr_b16 a[84:85], v19 offset:0
    v_mfma_f32_16x16x32_bf16 v[56:59], a[72:75], a[40:43], v[56:59]
    ds_read_b64_tr_b16 a[86:87], v19 offset:256
    v_mfma_f32_16x16x32_bf16 v[72:75], a[72:75], a[44:47], v[72:75]
    v_mfma_f32_16x16x32_bf16 v[88:91], a[72:75], a[48:51], v[88:91]
    v_mfma_f32_16x16x32_bf16 v[104:107], a[72:75], a[52:55], v[104:107]
    v_mfma_f32_16x16x32_bf16 v[120:123], a[72:75], a[56:59], v[120:123]
    v_mfma_f32_16x16x32_bf16 v[136:139], a[72:75], a[0:3], v[136:139]
    v_mfma_f32_16x16x32_bf16 v[152:155], a[72:75], a[4:7], v[152:155]
    s_waitcnt lgkmcnt(4)
    v_mfma_f32_16x16x32_bf16 v[44:47], a[76:79], a[36:39], v[44:47]
    s_waitcnt vmcnt(12)
    v_mfma_f32_16x16x32_bf16 v[60:63], a[76:79], a[40:43], v[60:63]
    ds_read_b64_tr_b16 a[72:73], v16 offset:4096
    v_mfma_f32_16x16x32_bf16 v[76:79], a[76:79], a[44:47], v[76:79]
    ds_read_b64_tr_b16 a[74:75], v16 offset:4352
    v_mfma_f32_16x16x32_bf16 v[92:95], a[76:79], a[48:51], v[92:95]
    v_mfma_f32_16x16x32_bf16 v[108:111], a[76:79], a[52:55], v[108:111]
    ds_read_b128 a[16:19], v11 offset:39936
    v_mfma_f32_16x16x32_bf16 v[124:127], a[76:79], a[56:59], v[124:127]
    v_mfma_f32_16x16x32_bf16 v[140:143], a[76:79], a[0:3], v[140:143]
    ds_read_b128 a[20:23], v11 offset:40192
    v_mfma_f32_16x16x32_bf16 v[156:159], a[76:79], a[4:7], v[156:159]
    s_waitcnt lgkmcnt(6)
    v_mfma_f32_16x16x32_bf16 v[48:51], a[80:83], a[36:39], v[48:51]
    ds_read_b64_tr_b16 a[76:77], v17 offset:4096
    v_mfma_f32_16x16x32_bf16 v[64:67], a[80:83], a[40:43], v[64:67]
    ds_read_b64_tr_b16 a[78:79], v17 offset:4352
    v_mfma_f32_16x16x32_bf16 v[80:83], a[80:83], a[44:47], v[80:83]
    s_add_u32 m0, s34, 0
    s_add_u32 s36, s30, 0
    v_mfma_f32_16x16x32_bf16 v[96:99], a[80:83], a[48:51], v[96:99]
    s_waitcnt lgkmcnt(6)
    v_mfma_f32_16x16x32_bf16 v[112:115], a[80:83], a[52:55], v[112:115]
    buffer_load_dwordx4 v12, s[12:15], s36 offen offset:0 lds
    v_mfma_f32_16x16x32_bf16 v[128:131], a[80:83], a[56:59], v[128:131]
    v_mfma_f32_16x16x32_bf16 v[144:147], a[80:83], a[0:3], v[144:147]
    buffer_load_dwordx4 v13, s[12:15], s36 offen offset:1024 lds
    v_mfma_f32_16x16x32_bf16 v[160:163], a[80:83], a[4:7], v[160:163]
    v_mfma_f32_16x16x32_bf16 v[52:55], a[84:87], a[36:39], v[52:55]
    ds_read_b64_tr_b16 a[80:81], v18 offset:4096
    v_mfma_f32_16x16x32_bf16 v[68:71], a[84:87], a[40:43], v[68:71]
    ds_read_b64_tr_b16 a[82:83], v18 offset:4352
    v_mfma_f32_16x16x32_bf16 v[84:87], a[84:87], a[44:47], v[84:87]
    buffer_load_dwordx4 v14, s[12:15], s36 offen offset:2048 lds
    v_mfma_f32_16x16x32_bf16 v[100:103], a[84:87], a[48:51], v[100:103]
    v_mfma_f32_16x16x32_bf16 v[116:119], a[84:87], a[52:55], v[116:119]
    buffer_load_dwordx4 v15, s[12:15], s36 offen offset:3072 lds
    v_mfma_f32_16x16x32_bf16 v[132:135], a[84:87], a[56:59], v[132:135]
    v_mfma_f32_16x16x32_bf16 v[148:151], a[84:87], a[0:3], v[148:151]
    v_mfma_f32_16x16x32_bf16 v[164:167], a[84:87], a[4:7], v[164:167]
    s_waitcnt lgkmcnt(0)
    s_barrier
    v_mfma_f32_16x16x32_bf16 v[40:43], a[72:75], a[40:43], v[40:43]
    ds_read_b64_tr_b16 a[84:85], v19 offset:4096
    v_mfma_f32_16x16x32_bf16 v[56:59], a[72:75], a[44:47], v[56:59]
    ds_read_b64_tr_b16 a[86:87], v19 offset:4352
    v_mfma_f32_16x16x32_bf16 v[72:75], a[72:75], a[48:51], v[72:75]
    s_add_u32 m0, s33, 36864
    s_nop 0
    v_mfma_f32_16x16x32_bf16 v[88:91], a[72:75], a[52:55], v[88:91]
    buffer_load_dwordx4 v9, s[8:11], s32 offen lds
    v_mfma_f32_16x16x32_bf16 v[104:107], a[72:75], a[56:59], v[104:107]
    s_add_u32 m0, s33, 40960
    s_add_u32 s36, s31, 33792
    v_mfma_f32_16x16x32_bf16 v[120:123], a[72:75], a[0:3], v[120:123]
    buffer_load_dwordx4 v5, s[8:11], s36 offen lds
    v_mfma_f32_16x16x32_bf16 v[136:139], a[72:75], a[4:7], v[136:139]
    s_add_u32 m0, s33, 45056
    s_add_u32 s36, s31, 66560
    v_mfma_f32_16x16x32_bf16 v[152:155], a[72:75], a[8:11], v[152:155]
    buffer_load_dwordx4 v6, s[8:11], s36 offen lds
    v_mfma_f32_16x16x32_bf16 v[44:47], a[76:79], a[40:43], v[44:47]
    s_waitcnt vmcnt(15)
    v_mfma_f32_16x16x32_bf16 v[60:63], a[76:79], a[44:47], v[60:63]
    ds_read_b64_tr_b16 a[72:73], v16 offset:8192
    v_mfma_f32_16x16x32_bf16 v[76:79], a[76:79], a[48:51], v[76:79]
    ds_read_b64_tr_b16 a[74:75], v16 offset:8448
    v_mfma_f32_16x16x32_bf16 v[92:95], a[76:79], a[52:55], v[92:95]
    s_add_u32 m0, s33, 49152
    s_add_u32 s36, s31, 99328
    v_mfma_f32_16x16x32_bf16 v[108:111], a[76:79], a[56:59], v[108:111]
    ds_read_b128 a[24:27], v10 offset:0
    v_mfma_f32_16x16x32_bf16 v[124:127], a[76:79], a[0:3], v[124:127]
    buffer_load_dwordx4 v7, s[8:11], s36 offen lds
    v_mfma_f32_16x16x32_bf16 v[140:143], a[76:79], a[4:7], v[140:143]
    ds_read_b128 a[28:31], v10 offset:256
    s_add_u32 m0, s33, 53248
    s_add_u32 s36, s31, 132096
    v_mfma_f32_16x16x32_bf16 v[156:159], a[76:79], a[8:11], v[156:159]
    buffer_load_dwordx4 v4, s[8:11], s36 offen lds
    v_mfma_f32_16x16x32_bf16 v[48:51], a[80:83], a[40:43], v[48:51]
    ds_read_b64_tr_b16 a[76:77], v17 offset:8192
    v_mfma_f32_16x16x32_bf16 v[64:67], a[80:83], a[44:47], v[64:67]
    ds_read_b64_tr_b16 a[78:79], v17 offset:8448
    v_mfma_f32_16x16x32_bf16 v[80:83], a[80:83], a[48:51], v[80:83]
    s_add_u32 m0, s34, 4096
    s_add_u32 s36, s30, 1048576
    v_mfma_f32_16x16x32_bf16 v[96:99], a[80:83], a[52:55], v[96:99]
    s_waitcnt lgkmcnt(6)
    v_mfma_f32_16x16x32_bf16 v[112:115], a[80:83], a[56:59], v[112:115]
    buffer_load_dwordx4 v12, s[12:15], s36 offen offset:0 lds
    v_mfma_f32_16x16x32_bf16 v[128:131], a[80:83], a[0:3], v[128:131]
    v_mfma_f32_16x16x32_bf16 v[144:147], a[80:83], a[4:7], v[144:147]
    buffer_load_dwordx4 v13, s[12:15], s36 offen offset:1024 lds
    v_mfma_f32_16x16x32_bf16 v[160:163], a[80:83], a[8:11], v[160:163]
    v_mfma_f32_16x16x32_bf16 v[52:55], a[84:87], a[40:43], v[52:55]
    ds_read_b64_tr_b16 a[80:81], v18 offset:8192
    v_mfma_f32_16x16x32_bf16 v[68:71], a[84:87], a[44:47], v[68:71]
    ds_read_b64_tr_b16 a[82:83], v18 offset:8448
    v_mfma_f32_16x16x32_bf16 v[84:87], a[84:87], a[48:51], v[84:87]
    buffer_load_dwordx4 v14, s[12:15], s36 offen offset:2048 lds
    v_mfma_f32_16x16x32_bf16 v[100:103], a[84:87], a[52:55], v[100:103]
    v_mfma_f32_16x16x32_bf16 v[116:119], a[84:87], a[56:59], v[116:119]
    buffer_load_dwordx4 v15, s[12:15], s36 offen offset:3072 lds
    v_mfma_f32_16x16x32_bf16 v[132:135], a[84:87], a[0:3], v[132:135]
    v_mfma_f32_16x16x32_bf16 v[148:151], a[84:87], a[4:7], v[148:151]
    v_mfma_f32_16x16x32_bf16 v[164:167], a[84:87], a[8:11], v[164:167]
    s_waitcnt lgkmcnt(6)
    v_mfma_f32_16x16x32_bf16 v[40:43], a[72:75], a[44:47], v[40:43]
    ds_read_b64_tr_b16 a[84:85], v19 offset:8192
    v_mfma_f32_16x16x32_bf16 v[56:59], a[72:75], a[48:51], v[56:59]
    ds_read_b64_tr_b16 a[86:87], v19 offset:8448
    v_mfma_f32_16x16x32_bf16 v[72:75], a[72:75], a[52:55], v[72:75]
    s_add_u32 m0, s33, 57344
    s_add_u32 s36, s31, 164864
    v_mfma_f32_16x16x32_bf16 v[88:91], a[72:75], a[56:59], v[88:91]
    buffer_load_dwordx4 v5, s[8:11], s36 offen lds
    v_mfma_f32_16x16x32_bf16 v[104:107], a[72:75], a[0:3], v[104:107]
    s_add_u32 m0, s33, 61440
    s_add_u32 s36, s31, 197632
    v_mfma_f32_16x16x32_bf16 v[120:123], a[72:75], a[4:7], v[120:123]
    buffer_load_dwordx4 v6, s[8:11], s36 offen lds
    v_mfma_f32_16x16x32_bf16 v[136:139], a[72:75], a[8:11], v[136:139]
    s_add_u32 m0, s33, 65536
    s_add_u32 s36, s31, 230400
    v_mfma_f32_16x16x32_bf16 v[152:155], a[72:75], a[12:15], v[152:155]
    buffer_load_dwordx4 v7, s[8:11], s36 offen lds
    s_waitcnt lgkmcnt(4)
    v_mfma_f32_16x16x32_bf16 v[44:47], a[76:79], a[44:47], v[44:47]
    s_waitcnt vmcnt(20)
    v_mfma_f32_16x16x32_bf16 v[60:63], a[76:79], a[48:51], v[60:63]
    ds_read_b64_tr_b16 a[72:73], v16 offset:12288
    v_mfma_f32_16x16x32_bf16 v[76:79], a[76:79], a[52:55], v[76:79]
    ds_read_b64_tr_b16 a[74:75], v16 offset:12544
    v_mfma_f32_16x16x32_bf16 v[92:95], a[76:79], a[56:59], v[92:95]
    s_add_u32 m0, s33, 69632
    s_add_u32 s36, s31, 263168
    v_mfma_f32_16x16x32_bf16 v[108:111], a[76:79], a[0:3], v[108:111]
    ds_read_b128 a[32:35], v10 offset:512
    v_mfma_f32_16x16x32_bf16 v[124:127], a[76:79], a[4:7], v[124:127]
    buffer_load_dwordx4 v4, s[8:11], s36 offen lds
    v_mfma_f32_16x16x32_bf16 v[140:143], a[76:79], a[8:11], v[140:143]
    ds_read_b128 a[36:39], v10 offset:768
    v_mfma_f32_16x16x32_bf16 v[156:159], a[76:79], a[12:15], v[156:159]
    s_waitcnt lgkmcnt(6)
    v_mfma_f32_16x16x32_bf16 v[48:51], a[80:83], a[44:47], v[48:51]
    ds_read_b64_tr_b16 a[76:77], v17 offset:12288
    v_mfma_f32_16x16x32_bf16 v[64:67], a[80:83], a[48:51], v[64:67]
    ds_read_b64_tr_b16 a[78:79], v17 offset:12544
    v_mfma_f32_16x16x32_bf16 v[80:83], a[80:83], a[52:55], v[80:83]
    s_add_u32 m0, s34, 8192
    s_add_u32 s36, s30, 2097152
    v_mfma_f32_16x16x32_bf16 v[96:99], a[80:83], a[56:59], v[96:99]
    s_waitcnt lgkmcnt(6)
    v_mfma_f32_16x16x32_bf16 v[112:115], a[80:83], a[0:3], v[112:115]
    buffer_load_dwordx4 v12, s[12:15], s36 offen offset:0 lds
    v_mfma_f32_16x16x32_bf16 v[128:131], a[80:83], a[4:7], v[128:131]
    v_mfma_f32_16x16x32_bf16 v[144:147], a[80:83], a[8:11], v[144:147]
    buffer_load_dwordx4 v13, s[12:15], s36 offen offset:1024 lds
    v_mfma_f32_16x16x32_bf16 v[160:163], a[80:83], a[12:15], v[160:163]
    v_mfma_f32_16x16x32_bf16 v[52:55], a[84:87], a[44:47], v[52:55]
    ds_read_b64_tr_b16 a[80:81], v18 offset:12288
    v_mfma_f32_16x16x32_bf16 v[68:71], a[84:87], a[48:51], v[68:71]
    ds_read_b64_tr_b16 a[82:83], v18 offset:12544
    v_mfma_f32_16x16x32_bf16 v[84:87], a[84:87], a[52:55], v[84:87]
    buffer_load_dwordx4 v14, s[12:15], s36 offen offset:2048 lds
    v_mfma_f32_16x16x32_bf16 v[100:103], a[84:87], a[56:59], v[100:103]
    v_mfma_f32_16x16x32_bf16 v[116:119], a[84:87], a[0:3], v[116:119]
    buffer_load_dwordx4 v15, s[12:15], s36 offen offset:3072 lds
    v_mfma_f32_16x16x32_bf16 v[132:135], a[84:87], a[4:7], v[132:135]
    v_mfma_f32_16x16x32_bf16 v[148:151], a[84:87], a[8:11], v[148:151]
    v_mfma_f32_16x16x32_bf16 v[164:167], a[84:87], a[12:15], v[164:167]
    s_waitcnt lgkmcnt(6)
    v_mfma_f32_16x16x32_bf16 v[40:43], a[72:75], a[48:51], v[40:43]
    ds_read_b64_tr_b16 a[84:85], v19 offset:12288
    v_mfma_f32_16x16x32_bf16 v[56:59], a[72:75], a[52:55], v[56:59]
    ds_read_b64_tr_b16 a[86:87], v19 offset:12544
    v_mfma_f32_16x16x32_bf16 v[72:75], a[72:75], a[56:59], v[72:75]
    v_mfma_f32_16x16x32_bf16 v[88:91], a[72:75], a[0:3], v[88:91]
    v_mfma_f32_16x16x32_bf16 v[104:107], a[72:75], a[4:7], v[104:107]
    v_mfma_f32_16x16x32_bf16 v[120:123], a[72:75], a[8:11], v[120:123]
    v_mfma_f32_16x16x32_bf16 v[136:139], a[72:75], a[12:15], v[136:139]
    v_mfma_f32_16x16x32_bf16 v[152:155], a[72:75], a[16:19], v[152:155]
    s_waitcnt lgkmcnt(4)
    v_mfma_f32_16x16x32_bf16 v[44:47], a[76:79], a[48:51], v[44:47]
    s_waitcnt vmcnt(21)
    v_mfma_f32_16x16x32_bf16 v[60:63], a[76:79], a[52:55], v[60:63]
    ds_read_b64_tr_b16 a[72:73], v16 offset:16384
    v_mfma_f32_16x16x32_bf16 v[76:79], a[76:79], a[56:59], v[76:79]
    ds_read_b64_tr_b16 a[74:75], v16 offset:16640
    v_mfma_f32_16x16x32_bf16 v[92:95], a[76:79], a[0:3], v[92:95]
    v_mfma_f32_16x16x32_bf16 v[108:111], a[76:79], a[4:7], v[108:111]
    ds_read_b128 a[40:43], v10 offset:1024
    v_mfma_f32_16x16x32_bf16 v[124:127], a[76:79], a[8:11], v[124:127]
    v_mfma_f32_16x16x32_bf16 v[140:143], a[76:79], a[12:15], v[140:143]
    ds_read_b128 a[44:47], v10 offset:1280
    v_mfma_f32_16x16x32_bf16 v[156:159], a[76:79], a[16:19], v[156:159]
    s_waitcnt lgkmcnt(6)
    v_mfma_f32_16x16x32_bf16 v[48:51], a[80:83], a[48:51], v[48:51]
    ds_read_b64_tr_b16 a[76:77], v17 offset:16384
    v_mfma_f32_16x16x32_bf16 v[64:67], a[80:83], a[52:55], v[64:67]
    ds_read_b64_tr_b16 a[78:79], v17 offset:16640
    v_mfma_f32_16x16x32_bf16 v[80:83], a[80:83], a[56:59], v[80:83]
    s_add_u32 m0, s34, 12288
    s_add_u32 s36, s30, 3145728
    v_mfma_f32_16x16x32_bf16 v[96:99], a[80:83], a[0:3], v[96:99]
    s_waitcnt lgkmcnt(6)
    v_mfma_f32_16x16x32_bf16 v[112:115], a[80:83], a[4:7], v[112:115]
    buffer_load_dwordx4 v12, s[12:15], s36 offen offset:0 lds
    v_mfma_f32_16x16x32_bf16 v[128:131], a[80:83], a[8:11], v[128:131]
    v_mfma_f32_16x16x32_bf16 v[144:147], a[80:83], a[12:15], v[144:147]
    buffer_load_dwordx4 v13, s[12:15], s36 offen offset:1024 lds
    v_mfma_f32_16x16x32_bf16 v[160:163], a[80:83], a[16:19], v[160:163]
    v_mfma_f32_16x16x32_bf16 v[52:55], a[84:87], a[48:51], v[52:55]
    ds_read_b64_tr_b16 a[80:81], v18 offset:16384
    v_mfma_f32_16x16x32_bf16 v[68:71], a[84:87], a[52:55], v[68:71]
    ds_read_b64_tr_b16 a[82:83], v18 offset:16640
    v_mfma_f32_16x16x32_bf16 v[84:87], a[84:87], a[56:59], v[84:87]
    buffer_load_dwordx4 v14, s[12:15], s36 offen offset:2048 lds
    v_mfma_f32_16x16x32_bf16 v[100:103], a[84:87], a[0:3], v[100:103]
    v_mfma_f32_16x16x32_bf16 v[116:119], a[84:87], a[4:7], v[116:119]
    buffer_load_dwordx4 v15, s[12:15], s36 offen offset:3072 lds
    v_mfma_f32_16x16x32_bf16 v[132:135], a[84:87], a[8:11], v[132:135]
    v_mfma_f32_16x16x32_bf16 v[148:151], a[84:87], a[12:15], v[148:151]
    v_mfma_f32_16x16x32_bf16 v[164:167], a[84:87], a[16:19], v[164:167]
    s_waitcnt lgkmcnt(6)
    v_mfma_f32_16x16x32_bf16 v[40:43], a[72:75], a[52:55], v[40:43]
    ds_read_b64_tr_b16 a[84:85], v19 offset:16384
    v_mfma_f32_16x16x32_bf16 v[56:59], a[72:75], a[56:59], v[56:59]
    ds_read_b64_tr_b16 a[86:87], v19 offset:16640
    v_mfma_f32_16x16x32_bf16 v[72:75], a[72:75], a[0:3], v[72:75]
    s_add_u32 s35, s35, 1
    v_mfma_f32_16x16x32_bf16 v[88:91], a[72:75], a[4:7], v[88:91]
    v_mfma_f32_16x16x32_bf16 v[104:107], a[72:75], a[8:11], v[104:107]
    v_mfma_f32_16x16x32_bf16 v[120:123], a[72:75], a[12:15], v[120:123]
    v_mfma_f32_16x16x32_bf16 v[136:139], a[72:75], a[16:19], v[136:139]
    v_mfma_f32_16x16x32_bf16 v[152:155], a[72:75], a[20:23], v[152:155]
    s_waitcnt lgkmcnt(4)
    v_mfma_f32_16x16x32_bf16 v[44:47], a[76:79], a[52:55], v[44:47]
    s_waitcnt vmcnt(21)
    v_mfma_f32_16x16x32_bf16 v[60:63], a[76:79], a[56:59], v[60:63]
    ds_read_b64_tr_b16 a[72:73], v16 offset:0
    v_mfma_f32_16x16x32_bf16 v[76:79], a[76:79], a[0:3], v[76:79]
    ds_read_b64_tr_b16 a[74:75], v16 offset:256
    v_mfma_f32_16x16x32_bf16 v[92:95], a[76:79], a[4:7], v[92:95]
    v_mfma_f32_16x16x32_bf16 v[108:111], a[76:79], a[8:11], v[108:111]
    ds_read_b128 a[60:63], v10 offset:1536
    v_mfma_f32_16x16x32_bf16 v[124:127], a[76:79], a[12:15], v[124:127]
    v_mfma_f32_16x16x32_bf16 v[140:143], a[76:79], a[16:19], v[140:143]
    ds_read_b128 a[64:67], v10 offset:1792
    v_mfma_f32_16x16x32_bf16 v[156:159], a[76:79], a[20:23], v[156:159]
    s_waitcnt lgkmcnt(6)
    v_mfma_f32_16x16x32_bf16 v[48:51], a[80:83], a[52:55], v[48:51]
    ds_read_b64_tr_b16 a[76:77], v17 offset:0
    v_mfma_f32_16x16x32_bf16 v[64:67], a[80:83], a[56:59], v[64:67]
    ds_read_b64_tr_b16 a[78:79], v17 offset:256
    v_mfma_f32_16x16x32_bf16 v[80:83], a[80:83], a[0:3], v[80:83]
    s_add_u32 m0, s34, 16384
    s_add_u32 s36, s30, 4194304
    v_mfma_f32_16x16x32_bf16 v[96:99], a[80:83], a[4:7], v[96:99]
    s_waitcnt lgkmcnt(6)
    v_mfma_f32_16x16x32_bf16 v[112:115], a[80:83], a[8:11], v[112:115]
    buffer_load_dwordx4 v12, s[12:15], s36 offen offset:0 lds
    v_mfma_f32_16x16x32_bf16 v[128:131], a[80:83], a[12:15], v[128:131]
    v_mfma_f32_16x16x32_bf16 v[144:147], a[80:83], a[16:19], v[144:147]
    buffer_load_dwordx4 v13, s[12:15], s36 offen offset:1024 lds
    v_mfma_f32_16x16x32_bf16 v[160:163], a[80:83], a[20:23], v[160:163]
    v_mfma_f32_16x16x32_bf16 v[52:55], a[84:87], a[52:55], v[52:55]
    ds_read_b64_tr_b16 a[80:81], v18 offset:0
    v_mfma_f32_16x16x32_bf16 v[68:71], a[84:87], a[56:59], v[68:71]
    ds_read_b64_tr_b16 a[82:83], v18 offset:256
    v_mfma_f32_16x16x32_bf16 v[84:87], a[84:87], a[0:3], v[84:87]
    buffer_load_dwordx4 v14, s[12:15], s36 offen offset:2048 lds
    v_mfma_f32_16x16x32_bf16 v[100:103], a[84:87], a[4:7], v[100:103]
    v_mfma_f32_16x16x32_bf16 v[116:119], a[84:87], a[8:11], v[116:119]
    buffer_load_dwordx4 v15, s[12:15], s36 offen offset:3072 lds
    v_mfma_f32_16x16x32_bf16 v[132:135], a[84:87], a[12:15], v[132:135]
    s_add_u32 s29, s29, 131072
    s_add_u32 s30, s30, 131072
    v_mfma_f32_16x16x32_bf16 v[148:151], a[84:87], a[16:19], v[148:151]
    s_add_u32 s31, s31, 256
    s_add_u32 s32, s32, 256
    v_mfma_f32_16x16x32_bf16 v[164:167], a[84:87], a[20:23], v[164:167]
conv1_kernel_loop:
    s_waitcnt lgkmcnt(6)
    v_mfma_f32_16x16x32_bf16 v[40:43], a[72:75], a[24:27], v[40:43]
    ds_read_b64_tr_b16 a[84:85], v19 offset:0
    v_mfma_f32_16x16x32_bf16 v[56:59], a[72:75], a[28:31], v[56:59]
    ds_read_b64_tr_b16 a[86:87], v19 offset:256
    v_mfma_f32_16x16x32_bf16 v[72:75], a[72:75], a[32:35], v[72:75]
    v_mfma_f32_16x16x32_bf16 v[88:91], a[72:75], a[36:39], v[88:91]
    v_mfma_f32_16x16x32_bf16 v[104:107], a[72:75], a[40:43], v[104:107]
    v_mfma_f32_16x16x32_bf16 v[120:123], a[72:75], a[44:47], v[120:123]
    s_waitcnt lgkmcnt(7)
    v_mfma_f32_16x16x32_bf16 v[136:139], a[72:75], a[60:63], v[136:139]
    s_waitcnt lgkmcnt(6)
    v_mfma_f32_16x16x32_bf16 v[152:155], a[72:75], a[64:67], v[152:155]
    s_waitcnt lgkmcnt(4)
    v_mfma_f32_16x16x32_bf16 v[44:47], a[76:79], a[24:27], v[44:47]
    s_waitcnt vmcnt(16)
    v_mfma_f32_16x16x32_bf16 v[60:63], a[76:79], a[28:31], v[60:63]
    ds_read_b64_tr_b16 a[72:73], v16 offset:4096
    v_mfma_f32_16x16x32_bf16 v[76:79], a[76:79], a[32:35], v[76:79]
    ds_read_b64_tr_b16 a[74:75], v16 offset:4352
    v_mfma_f32_16x16x32_bf16 v[92:95], a[76:79], a[36:39], v[92:95]
    v_mfma_f32_16x16x32_bf16 v[108:111], a[76:79], a[40:43], v[108:111]
    ds_read_b128 a[0:3], v11 offset:2048
    v_mfma_f32_16x16x32_bf16 v[124:127], a[76:79], a[44:47], v[124:127]
    v_mfma_f32_16x16x32_bf16 v[140:143], a[76:79], a[60:63], v[140:143]
    ds_read_b128 a[4:7], v11 offset:2304
    v_mfma_f32_16x16x32_bf16 v[156:159], a[76:79], a[64:67], v[156:159]
    s_waitcnt lgkmcnt(6)
    v_mfma_f32_16x16x32_bf16 v[48:51], a[80:83], a[24:27], v[48:51]
    ds_read_b64_tr_b16 a[76:77], v17 offset:4096
    v_mfma_f32_16x16x32_bf16 v[64:67], a[80:83], a[28:31], v[64:67]
    ds_read_b64_tr_b16 a[78:79], v17 offset:4352
    v_mfma_f32_16x16x32_bf16 v[80:83], a[80:83], a[32:35], v[80:83]
    s_add_u32 m0, s34, 0
    s_add_u32 s36, s29, 5242880
    v_mfma_f32_16x16x32_bf16 v[96:99], a[80:83], a[36:39], v[96:99]
    s_waitcnt lgkmcnt(6)
    v_mfma_f32_16x16x32_bf16 v[112:115], a[80:83], a[40:43], v[112:115]
    buffer_load_dwordx4 v12, s[12:15], s36 offen offset:0 lds
    v_mfma_f32_16x16x32_bf16 v[128:131], a[80:83], a[44:47], v[128:131]
    v_mfma_f32_16x16x32_bf16 v[144:147], a[80:83], a[60:63], v[144:147]
    buffer_load_dwordx4 v13, s[12:15], s36 offen offset:1024 lds
    v_mfma_f32_16x16x32_bf16 v[160:163], a[80:83], a[64:67], v[160:163]
    v_mfma_f32_16x16x32_bf16 v[52:55], a[84:87], a[24:27], v[52:55]
    ds_read_b64_tr_b16 a[80:81], v18 offset:4096
    v_mfma_f32_16x16x32_bf16 v[68:71], a[84:87], a[28:31], v[68:71]
    ds_read_b64_tr_b16 a[82:83], v18 offset:4352
    v_mfma_f32_16x16x32_bf16 v[84:87], a[84:87], a[32:35], v[84:87]
    buffer_load_dwordx4 v14, s[12:15], s36 offen offset:2048 lds
    v_mfma_f32_16x16x32_bf16 v[100:103], a[84:87], a[36:39], v[100:103]
    v_mfma_f32_16x16x32_bf16 v[116:119], a[84:87], a[40:43], v[116:119]
    buffer_load_dwordx4 v15, s[12:15], s36 offen offset:3072 lds
    v_mfma_f32_16x16x32_bf16 v[132:135], a[84:87], a[44:47], v[132:135]
    v_mfma_f32_16x16x32_bf16 v[148:151], a[84:87], a[60:63], v[148:151]
    v_mfma_f32_16x16x32_bf16 v[164:167], a[84:87], a[64:67], v[164:167]
    s_waitcnt lgkmcnt(6)
    v_mfma_f32_16x16x32_bf16 v[40:43], a[72:75], a[28:31], v[40:43]
    ds_read_b64_tr_b16 a[84:85], v19 offset:4096
    v_mfma_f32_16x16x32_bf16 v[56:59], a[72:75], a[32:35], v[56:59]
    ds_read_b64_tr_b16 a[86:87], v19 offset:4352
    v_mfma_f32_16x16x32_bf16 v[72:75], a[72:75], a[36:39], v[72:75]
    v_mfma_f32_16x16x32_bf16 v[88:91], a[72:75], a[40:43], v[88:91]
    v_mfma_f32_16x16x32_bf16 v[104:107], a[72:75], a[44:47], v[104:107]
    v_mfma_f32_16x16x32_bf16 v[120:123], a[72:75], a[60:63], v[120:123]
    v_mfma_f32_16x16x32_bf16 v[136:139], a[72:75], a[64:67], v[136:139]
    s_waitcnt lgkmcnt(7)
    v_mfma_f32_16x16x32_bf16 v[152:155], a[72:75], a[0:3], v[152:155]
    s_waitcnt lgkmcnt(4)
    v_mfma_f32_16x16x32_bf16 v[44:47], a[76:79], a[28:31], v[44:47]
    s_waitcnt vmcnt(12)
    v_mfma_f32_16x16x32_bf16 v[60:63], a[76:79], a[32:35], v[60:63]
    ds_read_b64_tr_b16 a[72:73], v16 offset:8192
    v_mfma_f32_16x16x32_bf16 v[76:79], a[76:79], a[36:39], v[76:79]
    ds_read_b64_tr_b16 a[74:75], v16 offset:8448
    v_mfma_f32_16x16x32_bf16 v[92:95], a[76:79], a[40:43], v[92:95]
    v_mfma_f32_16x16x32_bf16 v[108:111], a[76:79], a[44:47], v[108:111]
    ds_read_b128 a[8:11], v11 offset:2560
    v_mfma_f32_16x16x32_bf16 v[124:127], a[76:79], a[60:63], v[124:127]
    v_mfma_f32_16x16x32_bf16 v[140:143], a[76:79], a[64:67], v[140:143]
    ds_read_b128 a[12:15], v11 offset:2816
    v_mfma_f32_16x16x32_bf16 v[156:159], a[76:79], a[0:3], v[156:159]
    s_waitcnt lgkmcnt(6)
    v_mfma_f32_16x16x32_bf16 v[48:51], a[80:83], a[28:31], v[48:51]
    ds_read_b64_tr_b16 a[76:77], v17 offset:8192
    v_mfma_f32_16x16x32_bf16 v[64:67], a[80:83], a[32:35], v[64:67]
    ds_read_b64_tr_b16 a[78:79], v17 offset:8448
    v_mfma_f32_16x16x32_bf16 v[80:83], a[80:83], a[36:39], v[80:83]
    s_add_u32 m0, s34, 4096
    s_add_u32 s36, s29, 6291456
    v_mfma_f32_16x16x32_bf16 v[96:99], a[80:83], a[40:43], v[96:99]
    s_waitcnt lgkmcnt(6)
    v_mfma_f32_16x16x32_bf16 v[112:115], a[80:83], a[44:47], v[112:115]
    buffer_load_dwordx4 v12, s[12:15], s36 offen offset:0 lds
    v_mfma_f32_16x16x32_bf16 v[128:131], a[80:83], a[60:63], v[128:131]
    v_mfma_f32_16x16x32_bf16 v[144:147], a[80:83], a[64:67], v[144:147]
    buffer_load_dwordx4 v13, s[12:15], s36 offen offset:1024 lds
    v_mfma_f32_16x16x32_bf16 v[160:163], a[80:83], a[0:3], v[160:163]
    v_mfma_f32_16x16x32_bf16 v[52:55], a[84:87], a[28:31], v[52:55]
    ds_read_b64_tr_b16 a[80:81], v18 offset:8192
    v_mfma_f32_16x16x32_bf16 v[68:71], a[84:87], a[32:35], v[68:71]
    ds_read_b64_tr_b16 a[82:83], v18 offset:8448
    v_mfma_f32_16x16x32_bf16 v[84:87], a[84:87], a[36:39], v[84:87]
    buffer_load_dwordx4 v14, s[12:15], s36 offen offset:2048 lds
    v_mfma_f32_16x16x32_bf16 v[100:103], a[84:87], a[40:43], v[100:103]
    v_mfma_f32_16x16x32_bf16 v[116:119], a[84:87], a[44:47], v[116:119]
    buffer_load_dwordx4 v15, s[12:15], s36 offen offset:3072 lds
    v_mfma_f32_16x16x32_bf16 v[132:135], a[84:87], a[60:63], v[132:135]
    v_mfma_f32_16x16x32_bf16 v[148:151], a[84:87], a[64:67], v[148:151]
    v_mfma_f32_16x16x32_bf16 v[164:167], a[84:87], a[0:3], v[164:167]
    s_waitcnt lgkmcnt(6)
    v_mfma_f32_16x16x32_bf16 v[40:43], a[72:75], a[32:35], v[40:43]
    ds_read_b64_tr_b16 a[84:85], v19 offset:8192
    v_mfma_f32_16x16x32_bf16 v[56:59], a[72:75], a[36:39], v[56:59]
    ds_read_b64_tr_b16 a[86:87], v19 offset:8448
    v_mfma_f32_16x16x32_bf16 v[72:75], a[72:75], a[40:43], v[72:75]
    v_mfma_f32_16x16x32_bf16 v[88:91], a[72:75], a[44:47], v[88:91]
    v_mfma_f32_16x16x32_bf16 v[104:107], a[72:75], a[60:63], v[104:107]
    v_mfma_f32_16x16x32_bf16 v[120:123], a[72:75], a[64:67], v[120:123]
    v_mfma_f32_16x16x32_bf16 v[136:139], a[72:75], a[0:3], v[136:139]
    v_mfma_f32_16x16x32_bf16 v[152:155], a[72:75], a[4:7], v[152:155]
    s_waitcnt lgkmcnt(4)
    v_mfma_f32_16x16x32_bf16 v[44:47], a[76:79], a[32:35], v[44:47]
    s_waitcnt vmcnt(12)
    v_mfma_f32_16x16x32_bf16 v[60:63], a[76:79], a[36:39], v[60:63]
    ds_read_b64_tr_b16 a[72:73], v16 offset:12288
    v_mfma_f32_16x16x32_bf16 v[76:79], a[76:79], a[40:43], v[76:79]
    ds_read_b64_tr_b16 a[74:75], v16 offset:12544
    v_mfma_f32_16x16x32_bf16 v[92:95], a[76:79], a[44:47], v[92:95]
    v_mfma_f32_16x16x32_bf16 v[108:111], a[76:79], a[60:63], v[108:111]
    ds_read_b128 a[16:19], v11 offset:3072
    v_mfma_f32_16x16x32_bf16 v[124:127], a[76:79], a[64:67], v[124:127]
    v_mfma_f32_16x16x32_bf16 v[140:143], a[76:79], a[0:3], v[140:143]
    ds_read_b128 a[20:23], v11 offset:3328
    v_mfma_f32_16x16x32_bf16 v[156:159], a[76:79], a[4:7], v[156:159]
    s_waitcnt lgkmcnt(6)
    v_mfma_f32_16x16x32_bf16 v[48:51], a[80:83], a[32:35], v[48:51]
    ds_read_b64_tr_b16 a[76:77], v17 offset:12288
    v_mfma_f32_16x16x32_bf16 v[64:67], a[80:83], a[36:39], v[64:67]
    ds_read_b64_tr_b16 a[78:79], v17 offset:12544
    v_mfma_f32_16x16x32_bf16 v[80:83], a[80:83], a[40:43], v[80:83]
    s_add_u32 m0, s34, 8192
    s_add_u32 s36, s29, 7340032
    v_mfma_f32_16x16x32_bf16 v[96:99], a[80:83], a[44:47], v[96:99]
    s_waitcnt lgkmcnt(6)
    v_mfma_f32_16x16x32_bf16 v[112:115], a[80:83], a[60:63], v[112:115]
    buffer_load_dwordx4 v12, s[12:15], s36 offen offset:0 lds
    v_mfma_f32_16x16x32_bf16 v[128:131], a[80:83], a[64:67], v[128:131]
    v_mfma_f32_16x16x32_bf16 v[144:147], a[80:83], a[0:3], v[144:147]
    buffer_load_dwordx4 v13, s[12:15], s36 offen offset:1024 lds
    v_mfma_f32_16x16x32_bf16 v[160:163], a[80:83], a[4:7], v[160:163]
    v_mfma_f32_16x16x32_bf16 v[52:55], a[84:87], a[32:35], v[52:55]
    ds_read_b64_tr_b16 a[80:81], v18 offset:12288
    v_mfma_f32_16x16x32_bf16 v[68:71], a[84:87], a[36:39], v[68:71]
    ds_read_b64_tr_b16 a[82:83], v18 offset:12544
    v_mfma_f32_16x16x32_bf16 v[84:87], a[84:87], a[40:43], v[84:87]
    buffer_load_dwordx4 v14, s[12:15], s36 offen offset:2048 lds
    v_mfma_f32_16x16x32_bf16 v[100:103], a[84:87], a[44:47], v[100:103]
    v_mfma_f32_16x16x32_bf16 v[116:119], a[84:87], a[60:63], v[116:119]
    buffer_load_dwordx4 v15, s[12:15], s36 offen offset:3072 lds
    v_mfma_f32_16x16x32_bf16 v[132:135], a[84:87], a[64:67], v[132:135]
    v_mfma_f32_16x16x32_bf16 v[148:151], a[84:87], a[0:3], v[148:151]
    v_mfma_f32_16x16x32_bf16 v[164:167], a[84:87], a[4:7], v[164:167]
    s_waitcnt lgkmcnt(6)
    v_mfma_f32_16x16x32_bf16 v[40:43], a[72:75], a[36:39], v[40:43]
    ds_read_b64_tr_b16 a[84:85], v19 offset:12288
    v_mfma_f32_16x16x32_bf16 v[56:59], a[72:75], a[40:43], v[56:59]
    ds_read_b64_tr_b16 a[86:87], v19 offset:12544
    v_mfma_f32_16x16x32_bf16 v[72:75], a[72:75], a[44:47], v[72:75]
    v_mfma_f32_16x16x32_bf16 v[88:91], a[72:75], a[60:63], v[88:91]
    v_mfma_f32_16x16x32_bf16 v[104:107], a[72:75], a[64:67], v[104:107]
    v_mfma_f32_16x16x32_bf16 v[120:123], a[72:75], a[0:3], v[120:123]
    v_mfma_f32_16x16x32_bf16 v[136:139], a[72:75], a[4:7], v[136:139]
    v_mfma_f32_16x16x32_bf16 v[152:155], a[72:75], a[8:11], v[152:155]
    s_waitcnt lgkmcnt(4)
    v_mfma_f32_16x16x32_bf16 v[44:47], a[76:79], a[36:39], v[44:47]
    s_waitcnt vmcnt(12)
    v_mfma_f32_16x16x32_bf16 v[60:63], a[76:79], a[40:43], v[60:63]
    ds_read_b64_tr_b16 a[72:73], v16 offset:16384
    v_mfma_f32_16x16x32_bf16 v[76:79], a[76:79], a[44:47], v[76:79]
    ds_read_b64_tr_b16 a[74:75], v16 offset:16640
    v_mfma_f32_16x16x32_bf16 v[92:95], a[76:79], a[60:63], v[92:95]
    v_mfma_f32_16x16x32_bf16 v[108:111], a[76:79], a[64:67], v[108:111]
    ds_read_b128 a[24:27], v11 offset:3584
    v_mfma_f32_16x16x32_bf16 v[124:127], a[76:79], a[0:3], v[124:127]
    v_mfma_f32_16x16x32_bf16 v[140:143], a[76:79], a[4:7], v[140:143]
    v_mfma_f32_16x16x32_bf16 v[156:159], a[76:79], a[8:11], v[156:159]
    s_waitcnt lgkmcnt(5)
    v_mfma_f32_16x16x32_bf16 v[48:51], a[80:83], a[36:39], v[48:51]
    ds_read_b64_tr_b16 a[76:77], v17 offset:16384
    v_mfma_f32_16x16x32_bf16 v[64:67], a[80:83], a[40:43], v[64:67]
    ds_read_b64_tr_b16 a[78:79], v17 offset:16640
    v_mfma_f32_16x16x32_bf16 v[80:83], a[80:83], a[44:47], v[80:83]
    s_add_u32 m0, s34, 12288
    s_add_u32 s36, s29, 524288
    v_mfma_f32_16x16x32_bf16 v[96:99], a[80:83], a[60:63], v[96:99]
    s_waitcnt lgkmcnt(5)
    v_mfma_f32_16x16x32_bf16 v[112:115], a[80:83], a[64:67], v[112:115]
    buffer_load_dwordx4 v12, s[12:15], s36 offen offset:0 lds
    v_mfma_f32_16x16x32_bf16 v[128:131], a[80:83], a[0:3], v[128:131]
    v_mfma_f32_16x16x32_bf16 v[144:147], a[80:83], a[4:7], v[144:147]
    buffer_load_dwordx4 v13, s[12:15], s36 offen offset:1024 lds
    v_mfma_f32_16x16x32_bf16 v[160:163], a[80:83], a[8:11], v[160:163]
    v_mfma_f32_16x16x32_bf16 v[52:55], a[84:87], a[36:39], v[52:55]
    ds_read_b64_tr_b16 a[80:81], v18 offset:16384
    v_mfma_f32_16x16x32_bf16 v[68:71], a[84:87], a[40:43], v[68:71]
    ds_read_b64_tr_b16 a[82:83], v18 offset:16640
    v_mfma_f32_16x16x32_bf16 v[84:87], a[84:87], a[44:47], v[84:87]
    buffer_load_dwordx4 v14, s[12:15], s36 offen offset:2048 lds
    v_mfma_f32_16x16x32_bf16 v[100:103], a[84:87], a[60:63], v[100:103]
    v_mfma_f32_16x16x32_bf16 v[116:119], a[84:87], a[64:67], v[116:119]
    buffer_load_dwordx4 v15, s[12:15], s36 offen offset:3072 lds
    v_mfma_f32_16x16x32_bf16 v[132:135], a[84:87], a[0:3], v[132:135]
    v_mfma_f32_16x16x32_bf16 v[148:151], a[84:87], a[4:7], v[148:151]
    v_mfma_f32_16x16x32_bf16 v[164:167], a[84:87], a[8:11], v[164:167]
    s_waitcnt lgkmcnt(0)
    s_barrier
    v_mfma_f32_16x16x32_bf16 v[40:43], a[72:75], a[40:43], v[40:43]
    ds_read_b64_tr_b16 a[84:85], v19 offset:16384
    v_mfma_f32_16x16x32_bf16 v[56:59], a[72:75], a[44:47], v[56:59]
    ds_read_b64_tr_b16 a[86:87], v19 offset:16640
    v_mfma_f32_16x16x32_bf16 v[72:75], a[72:75], a[60:63], v[72:75]
    s_add_u32 m0, s33, 0
    s_nop 0
    v_mfma_f32_16x16x32_bf16 v[88:91], a[72:75], a[64:67], v[88:91]
    buffer_load_dwordx4 v8, s[8:11], s32 offen lds
    v_mfma_f32_16x16x32_bf16 v[104:107], a[72:75], a[0:3], v[104:107]
    s_add_u32 m0, s33, 4096
    s_add_u32 s36, s31, 32768
    v_mfma_f32_16x16x32_bf16 v[120:123], a[72:75], a[4:7], v[120:123]
    buffer_load_dwordx4 v5, s[8:11], s36 offen lds
    v_mfma_f32_16x16x32_bf16 v[136:139], a[72:75], a[8:11], v[136:139]
    s_add_u32 m0, s33, 8192
    s_add_u32 s36, s31, 65536
    v_mfma_f32_16x16x32_bf16 v[152:155], a[72:75], a[12:15], v[152:155]
    buffer_load_dwordx4 v6, s[8:11], s36 offen lds
    v_mfma_f32_16x16x32_bf16 v[44:47], a[76:79], a[40:43], v[44:47]
    s_waitcnt vmcnt(15)
    v_mfma_f32_16x16x32_bf16 v[60:63], a[76:79], a[44:47], v[60:63]
    ds_read_b64_tr_b16 a[72:73], v16 offset:0
    v_mfma_f32_16x16x32_bf16 v[76:79], a[76:79], a[60:63], v[76:79]
    ds_read_b64_tr_b16 a[74:75], v16 offset:256
    v_mfma_f32_16x16x32_bf16 v[92:95], a[76:79], a[64:67], v[92:95]
    s_add_u32 m0, s33, 12288
    s_add_u32 s36, s31, 98304
    v_mfma_f32_16x16x32_bf16 v[108:111], a[76:79], a[0:3], v[108:111]
    ds_read_b128 a[28:31], v10 offset:36864
    v_mfma_f32_16x16x32_bf16 v[124:127], a[76:79], a[4:7], v[124:127]
    buffer_load_dwordx4 v7, s[8:11], s36 offen lds
    v_mfma_f32_16x16x32_bf16 v[140:143], a[76:79], a[8:11], v[140:143]
    ds_read_b128 a[32:35], v10 offset:37120
    s_add_u32 m0, s33, 16384
    s_add_u32 s36, s31, 131072
    v_mfma_f32_16x16x32_bf16 v[156:159], a[76:79], a[12:15], v[156:159]
    buffer_load_dwordx4 v4, s[8:11], s36 offen lds
    v_mfma_f32_16x16x32_bf16 v[48:51], a[80:83], a[40:43], v[48:51]
    ds_read_b64_tr_b16 a[76:77], v17 offset:0
    v_mfma_f32_16x16x32_bf16 v[64:67], a[80:83], a[44:47], v[64:67]
    ds_read_b64_tr_b16 a[78:79], v17 offset:256
    v_mfma_f32_16x16x32_bf16 v[80:83], a[80:83], a[60:63], v[80:83]
    s_add_u32 m0, s34, 16384
    s_add_u32 s36, s29, 1572864
    v_mfma_f32_16x16x32_bf16 v[96:99], a[80:83], a[64:67], v[96:99]
    s_waitcnt lgkmcnt(6)
    v_mfma_f32_16x16x32_bf16 v[112:115], a[80:83], a[0:3], v[112:115]
    buffer_load_dwordx4 v12, s[12:15], s36 offen offset:0 lds
    v_mfma_f32_16x16x32_bf16 v[128:131], a[80:83], a[4:7], v[128:131]
    v_mfma_f32_16x16x32_bf16 v[144:147], a[80:83], a[8:11], v[144:147]
    buffer_load_dwordx4 v13, s[12:15], s36 offen offset:1024 lds
    v_mfma_f32_16x16x32_bf16 v[160:163], a[80:83], a[12:15], v[160:163]
    v_mfma_f32_16x16x32_bf16 v[52:55], a[84:87], a[40:43], v[52:55]
    ds_read_b64_tr_b16 a[80:81], v18 offset:0
    v_mfma_f32_16x16x32_bf16 v[68:71], a[84:87], a[44:47], v[68:71]
    ds_read_b64_tr_b16 a[82:83], v18 offset:256
    v_mfma_f32_16x16x32_bf16 v[84:87], a[84:87], a[60:63], v[84:87]
    buffer_load_dwordx4 v14, s[12:15], s36 offen offset:2048 lds
    v_mfma_f32_16x16x32_bf16 v[100:103], a[84:87], a[64:67], v[100:103]
    v_mfma_f32_16x16x32_bf16 v[116:119], a[84:87], a[0:3], v[116:119]
    buffer_load_dwordx4 v15, s[12:15], s36 offen offset:3072 lds
    v_mfma_f32_16x16x32_bf16 v[132:135], a[84:87], a[4:7], v[132:135]
    v_mfma_f32_16x16x32_bf16 v[148:151], a[84:87], a[8:11], v[148:151]
    v_mfma_f32_16x16x32_bf16 v[164:167], a[84:87], a[12:15], v[164:167]
    s_waitcnt lgkmcnt(6)
    v_mfma_f32_16x16x32_bf16 v[40:43], a[72:75], a[44:47], v[40:43]
    ds_read_b64_tr_b16 a[84:85], v19 offset:0
    v_mfma_f32_16x16x32_bf16 v[56:59], a[72:75], a[60:63], v[56:59]
    ds_read_b64_tr_b16 a[86:87], v19 offset:256
    v_mfma_f32_16x16x32_bf16 v[72:75], a[72:75], a[64:67], v[72:75]
    s_add_u32 m0, s33, 20480
    s_add_u32 s36, s31, 163840
    v_mfma_f32_16x16x32_bf16 v[88:91], a[72:75], a[0:3], v[88:91]
    buffer_load_dwordx4 v5, s[8:11], s36 offen lds
    v_mfma_f32_16x16x32_bf16 v[104:107], a[72:75], a[4:7], v[104:107]
    s_add_u32 m0, s33, 24576
    s_add_u32 s36, s31, 196608
    v_mfma_f32_16x16x32_bf16 v[120:123], a[72:75], a[8:11], v[120:123]
    buffer_load_dwordx4 v6, s[8:11], s36 offen lds
    v_mfma_f32_16x16x32_bf16 v[136:139], a[72:75], a[12:15], v[136:139]
    s_add_u32 m0, s33, 28672
    s_add_u32 s36, s31, 229376
    v_mfma_f32_16x16x32_bf16 v[152:155], a[72:75], a[16:19], v[152:155]
    buffer_load_dwordx4 v7, s[8:11], s36 offen lds
    s_waitcnt lgkmcnt(4)
    v_mfma_f32_16x16x32_bf16 v[44:47], a[76:79], a[44:47], v[44:47]
    s_waitcnt vmcnt(20)
    v_mfma_f32_16x16x32_bf16 v[60:63], a[76:79], a[60:63], v[60:63]
    ds_read_b64_tr_b16 a[72:73], v16 offset:4096
    v_mfma_f32_16x16x32_bf16 v[76:79], a[76:79], a[64:67], v[76:79]
    ds_read_b64_tr_b16 a[74:75], v16 offset:4352
    v_mfma_f32_16x16x32_bf16 v[92:95], a[76:79], a[0:3], v[92:95]
    s_add_u32 m0, s33, 32768
    s_add_u32 s36, s31, 262144
    v_mfma_f32_16x16x32_bf16 v[108:111], a[76:79], a[4:7], v[108:111]
    ds_read_b128 a[36:39], v10 offset:37376
    v_mfma_f32_16x16x32_bf16 v[124:127], a[76:79], a[8:11], v[124:127]
    buffer_load_dwordx4 v4, s[8:11], s36 offen lds
    v_mfma_f32_16x16x32_bf16 v[140:143], a[76:79], a[12:15], v[140:143]
    ds_read_b128 a[40:43], v10 offset:37632
    v_mfma_f32_16x16x32_bf16 v[156:159], a[76:79], a[16:19], v[156:159]
    s_waitcnt lgkmcnt(6)
    v_mfma_f32_16x16x32_bf16 v[48:51], a[80:83], a[44:47], v[48:51]
    ds_read_b64_tr_b16 a[76:77], v17 offset:4096
    v_mfma_f32_16x16x32_bf16 v[64:67], a[80:83], a[60:63], v[64:67]
    ds_read_b64_tr_b16 a[78:79], v17 offset:4352
    v_mfma_f32_16x16x32_bf16 v[80:83], a[80:83], a[64:67], v[80:83]
    s_add_u32 m0, s34, 0
    s_add_u32 s36, s29, 2621440
    v_mfma_f32_16x16x32_bf16 v[96:99], a[80:83], a[0:3], v[96:99]
    s_waitcnt lgkmcnt(6)
    v_mfma_f32_16x16x32_bf16 v[112:115], a[80:83], a[4:7], v[112:115]
    buffer_load_dwordx4 v12, s[12:15], s36 offen offset:0 lds
    v_mfma_f32_16x16x32_bf16 v[128:131], a[80:83], a[8:11], v[128:131]
    v_mfma_f32_16x16x32_bf16 v[144:147], a[80:83], a[12:15], v[144:147]
    buffer_load_dwordx4 v13, s[12:15], s36 offen offset:1024 lds
    v_mfma_f32_16x16x32_bf16 v[160:163], a[80:83], a[16:19], v[160:163]
    v_mfma_f32_16x16x32_bf16 v[52:55], a[84:87], a[44:47], v[52:55]
    ds_read_b64_tr_b16 a[80:81], v18 offset:4096
    v_mfma_f32_16x16x32_bf16 v[68:71], a[84:87], a[60:63], v[68:71]
    ds_read_b64_tr_b16 a[82:83], v18 offset:4352
    v_mfma_f32_16x16x32_bf16 v[84:87], a[84:87], a[64:67], v[84:87]
    buffer_load_dwordx4 v14, s[12:15], s36 offen offset:2048 lds
    v_mfma_f32_16x16x32_bf16 v[100:103], a[84:87], a[0:3], v[100:103]
    v_mfma_f32_16x16x32_bf16 v[116:119], a[84:87], a[4:7], v[116:119]
    buffer_load_dwordx4 v15, s[12:15], s36 offen offset:3072 lds
    v_mfma_f32_16x16x32_bf16 v[132:135], a[84:87], a[8:11], v[132:135]
    v_mfma_f32_16x16x32_bf16 v[148:151], a[84:87], a[12:15], v[148:151]
    v_mfma_f32_16x16x32_bf16 v[164:167], a[84:87], a[16:19], v[164:167]
    s_waitcnt lgkmcnt(6)
    v_mfma_f32_16x16x32_bf16 v[40:43], a[72:75], a[60:63], v[40:43]
    ds_read_b64_tr_b16 a[84:85], v19 offset:4096
    v_mfma_f32_16x16x32_bf16 v[56:59], a[72:75], a[64:67], v[56:59]
    ds_read_b64_tr_b16 a[86:87], v19 offset:4352
    v_mfma_f32_16x16x32_bf16 v[72:75], a[72:75], a[0:3], v[72:75]
    v_mfma_f32_16x16x32_bf16 v[88:91], a[72:75], a[4:7], v[88:91]
    v_mfma_f32_16x16x32_bf16 v[104:107], a[72:75], a[8:11], v[104:107]
    v_mfma_f32_16x16x32_bf16 v[120:123], a[72:75], a[12:15], v[120:123]
    v_mfma_f32_16x16x32_bf16 v[136:139], a[72:75], a[16:19], v[136:139]
    v_mfma_f32_16x16x32_bf16 v[152:155], a[72:75], a[20:23], v[152:155]
    s_waitcnt lgkmcnt(4)
    v_mfma_f32_16x16x32_bf16 v[44:47], a[76:79], a[60:63], v[44:47]
    s_waitcnt vmcnt(21)
    v_mfma_f32_16x16x32_bf16 v[60:63], a[76:79], a[64:67], v[60:63]
    ds_read_b64_tr_b16 a[72:73], v16 offset:8192
    v_mfma_f32_16x16x32_bf16 v[76:79], a[76:79], a[0:3], v[76:79]
    ds_read_b64_tr_b16 a[74:75], v16 offset:8448
    v_mfma_f32_16x16x32_bf16 v[92:95], a[76:79], a[4:7], v[92:95]
    v_mfma_f32_16x16x32_bf16 v[108:111], a[76:79], a[8:11], v[108:111]
    ds_read_b128 a[44:47], v10 offset:37888
    v_mfma_f32_16x16x32_bf16 v[124:127], a[76:79], a[12:15], v[124:127]
    v_mfma_f32_16x16x32_bf16 v[140:143], a[76:79], a[16:19], v[140:143]
    ds_read_b128 a[48:51], v10 offset:38144
    v_mfma_f32_16x16x32_bf16 v[156:159], a[76:79], a[20:23], v[156:159]
    s_waitcnt lgkmcnt(6)
    v_mfma_f32_16x16x32_bf16 v[48:51], a[80:83], a[60:63], v[48:51]
    ds_read_b64_tr_b16 a[76:77], v17 offset:8192
    v_mfma_f32_16x16x32_bf16 v[64:67], a[80:83], a[64:67], v[64:67]
    ds_read_b64_tr_b16 a[78:79], v17 offset:8448
    v_mfma_f32_16x16x32_bf16 v[80:83], a[80:83], a[0:3], v[80:83]
    s_add_u32 m0, s34, 4096
    s_add_u32 s36, s29, 3670016
    v_mfma_f32_16x16x32_bf16 v[96:99], a[80:83], a[4:7], v[96:99]
    s_waitcnt lgkmcnt(6)
    v_mfma_f32_16x16x32_bf16 v[112:115], a[80:83], a[8:11], v[112:115]
    buffer_load_dwordx4 v12, s[12:15], s36 offen offset:0 lds
    v_mfma_f32_16x16x32_bf16 v[128:131], a[80:83], a[12:15], v[128:131]
    v_mfma_f32_16x16x32_bf16 v[144:147], a[80:83], a[16:19], v[144:147]
    buffer_load_dwordx4 v13, s[12:15], s36 offen offset:1024 lds
    v_mfma_f32_16x16x32_bf16 v[160:163], a[80:83], a[20:23], v[160:163]
    v_mfma_f32_16x16x32_bf16 v[52:55], a[84:87], a[60:63], v[52:55]
    ds_read_b64_tr_b16 a[80:81], v18 offset:8192
    v_mfma_f32_16x16x32_bf16 v[68:71], a[84:87], a[64:67], v[68:71]
    ds_read_b64_tr_b16 a[82:83], v18 offset:8448
    v_mfma_f32_16x16x32_bf16 v[84:87], a[84:87], a[0:3], v[84:87]
    buffer_load_dwordx4 v14, s[12:15], s36 offen offset:2048 lds
    v_mfma_f32_16x16x32_bf16 v[100:103], a[84:87], a[4:7], v[100:103]
    v_mfma_f32_16x16x32_bf16 v[116:119], a[84:87], a[8:11], v[116:119]
    buffer_load_dwordx4 v15, s[12:15], s36 offen offset:3072 lds
    v_mfma_f32_16x16x32_bf16 v[132:135], a[84:87], a[12:15], v[132:135]
    v_mfma_f32_16x16x32_bf16 v[148:151], a[84:87], a[16:19], v[148:151]
    v_mfma_f32_16x16x32_bf16 v[164:167], a[84:87], a[20:23], v[164:167]
    s_waitcnt lgkmcnt(6)
    v_mfma_f32_16x16x32_bf16 v[40:43], a[72:75], a[64:67], v[40:43]
    ds_read_b64_tr_b16 a[84:85], v19 offset:8192
    v_mfma_f32_16x16x32_bf16 v[56:59], a[72:75], a[0:3], v[56:59]
    ds_read_b64_tr_b16 a[86:87], v19 offset:8448
    v_mfma_f32_16x16x32_bf16 v[72:75], a[72:75], a[4:7], v[72:75]
    v_mfma_f32_16x16x32_bf16 v[88:91], a[72:75], a[8:11], v[88:91]
    v_mfma_f32_16x16x32_bf16 v[104:107], a[72:75], a[12:15], v[104:107]
    v_mfma_f32_16x16x32_bf16 v[120:123], a[72:75], a[16:19], v[120:123]
    v_mfma_f32_16x16x32_bf16 v[136:139], a[72:75], a[20:23], v[136:139]
    v_mfma_f32_16x16x32_bf16 v[152:155], a[72:75], a[24:27], v[152:155]
    s_waitcnt lgkmcnt(4)
    v_mfma_f32_16x16x32_bf16 v[44:47], a[76:79], a[64:67], v[44:47]
    s_waitcnt vmcnt(21)
    v_mfma_f32_16x16x32_bf16 v[60:63], a[76:79], a[0:3], v[60:63]
    ds_read_b64_tr_b16 a[72:73], v16 offset:12288
    v_mfma_f32_16x16x32_bf16 v[76:79], a[76:79], a[4:7], v[76:79]
    ds_read_b64_tr_b16 a[74:75], v16 offset:12544
    v_mfma_f32_16x16x32_bf16 v[92:95], a[76:79], a[8:11], v[92:95]
    v_mfma_f32_16x16x32_bf16 v[108:111], a[76:79], a[12:15], v[108:111]
    ds_read_b128 a[52:55], v10 offset:38400
    v_mfma_f32_16x16x32_bf16 v[124:127], a[76:79], a[16:19], v[124:127]
    v_mfma_f32_16x16x32_bf16 v[140:143], a[76:79], a[20:23], v[140:143]
    ds_read_b128 a[56:59], v10 offset:38656
    v_mfma_f32_16x16x32_bf16 v[156:159], a[76:79], a[24:27], v[156:159]
    s_waitcnt lgkmcnt(6)
    v_mfma_f32_16x16x32_bf16 v[48:51], a[80:83], a[64:67], v[48:51]
    ds_read_b64_tr_b16 a[76:77], v17 offset:12288
    v_mfma_f32_16x16x32_bf16 v[64:67], a[80:83], a[0:3], v[64:67]
    ds_read_b64_tr_b16 a[78:79], v17 offset:12544
    v_mfma_f32_16x16x32_bf16 v[80:83], a[80:83], a[4:7], v[80:83]
    s_add_u32 m0, s34, 8192
    s_add_u32 s36, s29, 4718592
    v_mfma_f32_16x16x32_bf16 v[96:99], a[80:83], a[8:11], v[96:99]
    s_waitcnt lgkmcnt(6)
    v_mfma_f32_16x16x32_bf16 v[112:115], a[80:83], a[12:15], v[112:115]
    buffer_load_dwordx4 v12, s[12:15], s36 offen offset:0 lds
    v_mfma_f32_16x16x32_bf16 v[128:131], a[80:83], a[16:19], v[128:131]
    v_mfma_f32_16x16x32_bf16 v[144:147], a[80:83], a[20:23], v[144:147]
    buffer_load_dwordx4 v13, s[12:15], s36 offen offset:1024 lds
    v_mfma_f32_16x16x32_bf16 v[160:163], a[80:83], a[24:27], v[160:163]
    v_mfma_f32_16x16x32_bf16 v[52:55], a[84:87], a[64:67], v[52:55]
    ds_read_b64_tr_b16 a[80:81], v18 offset:12288
    v_mfma_f32_16x16x32_bf16 v[68:71], a[84:87], a[0:3], v[68:71]
    ds_read_b64_tr_b16 a[82:83], v18 offset:12544
    v_mfma_f32_16x16x32_bf16 v[84:87], a[84:87], a[4:7], v[84:87]
    buffer_load_dwordx4 v14, s[12:15], s36 offen offset:2048 lds
    v_mfma_f32_16x16x32_bf16 v[100:103], a[84:87], a[8:11], v[100:103]
    v_mfma_f32_16x16x32_bf16 v[116:119], a[84:87], a[12:15], v[116:119]
    buffer_load_dwordx4 v15, s[12:15], s36 offen offset:3072 lds
    v_mfma_f32_16x16x32_bf16 v[132:135], a[84:87], a[16:19], v[132:135]
    v_mfma_f32_16x16x32_bf16 v[148:151], a[84:87], a[20:23], v[148:151]
    v_mfma_f32_16x16x32_bf16 v[164:167], a[84:87], a[24:27], v[164:167]
    s_waitcnt lgkmcnt(6)
    v_mfma_f32_16x16x32_bf16 v[40:43], a[72:75], a[28:31], v[40:43]
    ds_read_b64_tr_b16 a[84:85], v19 offset:12288
    v_mfma_f32_16x16x32_bf16 v[56:59], a[72:75], a[32:35], v[56:59]
    ds_read_b64_tr_b16 a[86:87], v19 offset:12544
    v_mfma_f32_16x16x32_bf16 v[72:75], a[72:75], a[36:39], v[72:75]
    v_mfma_f32_16x16x32_bf16 v[88:91], a[72:75], a[40:43], v[88:91]
    v_mfma_f32_16x16x32_bf16 v[104:107], a[72:75], a[44:47], v[104:107]
    v_mfma_f32_16x16x32_bf16 v[120:123], a[72:75], a[48:51], v[120:123]
    s_waitcnt lgkmcnt(7)
    v_mfma_f32_16x16x32_bf16 v[136:139], a[72:75], a[52:55], v[136:139]
    s_waitcnt lgkmcnt(6)
    v_mfma_f32_16x16x32_bf16 v[152:155], a[72:75], a[56:59], v[152:155]
    s_waitcnt lgkmcnt(4)
    v_mfma_f32_16x16x32_bf16 v[44:47], a[76:79], a[28:31], v[44:47]
    s_waitcnt vmcnt(16)
    v_mfma_f32_16x16x32_bf16 v[60:63], a[76:79], a[32:35], v[60:63]
    ds_read_b64_tr_b16 a[72:73], v16 offset:16384
    v_mfma_f32_16x16x32_bf16 v[76:79], a[76:79], a[36:39], v[76:79]
    ds_read_b64_tr_b16 a[74:75], v16 offset:16640
    v_mfma_f32_16x16x32_bf16 v[92:95], a[76:79], a[40:43], v[92:95]
    v_mfma_f32_16x16x32_bf16 v[108:111], a[76:79], a[44:47], v[108:111]
    ds_read_b128 a[0:3], v11 offset:38912
    v_mfma_f32_16x16x32_bf16 v[124:127], a[76:79], a[48:51], v[124:127]
    v_mfma_f32_16x16x32_bf16 v[140:143], a[76:79], a[52:55], v[140:143]
    ds_read_b128 a[4:7], v11 offset:39168
    v_mfma_f32_16x16x32_bf16 v[156:159], a[76:79], a[56:59], v[156:159]
    s_waitcnt lgkmcnt(6)
    v_mfma_f32_16x16x32_bf16 v[48:51], a[80:83], a[28:31], v[48:51]
    ds_read_b64_tr_b16 a[76:77], v17 offset:16384
    v_mfma_f32_16x16x32_bf16 v[64:67], a[80:83], a[32:35], v[64:67]
    ds_read_b64_tr_b16 a[78:79], v17 offset:16640
    v_mfma_f32_16x16x32_bf16 v[80:83], a[80:83], a[36:39], v[80:83]
    s_add_u32 m0, s34, 12288
    s_add_u32 s36, s29, 5767168
    v_mfma_f32_16x16x32_bf16 v[96:99], a[80:83], a[40:43], v[96:99]
    s_waitcnt lgkmcnt(6)
    v_mfma_f32_16x16x32_bf16 v[112:115], a[80:83], a[44:47], v[112:115]
    buffer_load_dwordx4 v12, s[12:15], s36 offen offset:0 lds
    v_mfma_f32_16x16x32_bf16 v[128:131], a[80:83], a[48:51], v[128:131]
    v_mfma_f32_16x16x32_bf16 v[144:147], a[80:83], a[52:55], v[144:147]
    buffer_load_dwordx4 v13, s[12:15], s36 offen offset:1024 lds
    v_mfma_f32_16x16x32_bf16 v[160:163], a[80:83], a[56:59], v[160:163]
    v_mfma_f32_16x16x32_bf16 v[52:55], a[84:87], a[28:31], v[52:55]
    ds_read_b64_tr_b16 a[80:81], v18 offset:16384
    v_mfma_f32_16x16x32_bf16 v[68:71], a[84:87], a[32:35], v[68:71]
    ds_read_b64_tr_b16 a[82:83], v18 offset:16640
    v_mfma_f32_16x16x32_bf16 v[84:87], a[84:87], a[36:39], v[84:87]
    buffer_load_dwordx4 v14, s[12:15], s36 offen offset:2048 lds
    v_mfma_f32_16x16x32_bf16 v[100:103], a[84:87], a[40:43], v[100:103]
    v_mfma_f32_16x16x32_bf16 v[116:119], a[84:87], a[44:47], v[116:119]
    buffer_load_dwordx4 v15, s[12:15], s36 offen offset:3072 lds
    v_mfma_f32_16x16x32_bf16 v[132:135], a[84:87], a[48:51], v[132:135]
    v_mfma_f32_16x16x32_bf16 v[148:151], a[84:87], a[52:55], v[148:151]
    v_mfma_f32_16x16x32_bf16 v[164:167], a[84:87], a[56:59], v[164:167]
    s_waitcnt lgkmcnt(6)
    v_mfma_f32_16x16x32_bf16 v[40:43], a[72:75], a[32:35], v[40:43]
    ds_read_b64_tr_b16 a[84:85], v19 offset:16384
    v_mfma_f32_16x16x32_bf16 v[56:59], a[72:75], a[36:39], v[56:59]
    ds_read_b64_tr_b16 a[86:87], v19 offset:16640
    v_mfma_f32_16x16x32_bf16 v[72:75], a[72:75], a[40:43], v[72:75]
    v_mfma_f32_16x16x32_bf16 v[88:91], a[72:75], a[44:47], v[88:91]
    v_mfma_f32_16x16x32_bf16 v[104:107], a[72:75], a[48:51], v[104:107]
    v_mfma_f32_16x16x32_bf16 v[120:123], a[72:75], a[52:55], v[120:123]
    v_mfma_f32_16x16x32_bf16 v[136:139], a[72:75], a[56:59], v[136:139]
    s_waitcnt lgkmcnt(7)
    v_mfma_f32_16x16x32_bf16 v[152:155], a[72:75], a[0:3], v[152:155]
    s_waitcnt lgkmcnt(4)
    v_mfma_f32_16x16x32_bf16 v[44:47], a[76:79], a[32:35], v[44:47]
    s_waitcnt vmcnt(12)
    v_mfma_f32_16x16x32_bf16 v[60:63], a[76:79], a[36:39], v[60:63]
    ds_read_b64_tr_b16 a[72:73], v16 offset:0
    v_mfma_f32_16x16x32_bf16 v[76:79], a[76:79], a[40:43], v[76:79]
    ds_read_b64_tr_b16 a[74:75], v16 offset:256
    v_mfma_f32_16x16x32_bf16 v[92:95], a[76:79], a[44:47], v[92:95]
    v_mfma_f32_16x16x32_bf16 v[108:111], a[76:79], a[48:51], v[108:111]
    ds_read_b128 a[8:11], v11 offset:39424
    v_mfma_f32_16x16x32_bf16 v[124:127], a[76:79], a[52:55], v[124:127]
    v_mfma_f32_16x16x32_bf16 v[140:143], a[76:79], a[56:59], v[140:143]
    ds_read_b128 a[12:15], v11 offset:39680
    v_mfma_f32_16x16x32_bf16 v[156:159], a[76:79], a[0:3], v[156:159]
    s_waitcnt lgkmcnt(6)
    v_mfma_f32_16x16x32_bf16 v[48:51], a[80:83], a[32:35], v[48:51]
    ds_read_b64_tr_b16 a[76:77], v17 offset:0
    v_mfma_f32_16x16x32_bf16 v[64:67], a[80:83], a[36:39], v[64:67]
    ds_read_b64_tr_b16 a[78:79], v17 offset:256
    v_mfma_f32_16x16x32_bf16 v[80:83], a[80:83], a[40:43], v[80:83]
    s_add_u32 m0, s34, 16384
    s_add_u32 s36, s29, 6815744
    v_mfma_f32_16x16x32_bf16 v[96:99], a[80:83], a[44:47], v[96:99]
    s_waitcnt lgkmcnt(6)
    v_mfma_f32_16x16x32_bf16 v[112:115], a[80:83], a[48:51], v[112:115]
    buffer_load_dwordx4 v12, s[12:15], s36 offen offset:0 lds
    v_mfma_f32_16x16x32_bf16 v[128:131], a[80:83], a[52:55], v[128:131]
    v_mfma_f32_16x16x32_bf16 v[144:147], a[80:83], a[56:59], v[144:147]
    buffer_load_dwordx4 v13, s[12:15], s36 offen offset:1024 lds
    v_mfma_f32_16x16x32_bf16 v[160:163], a[80:83], a[0:3], v[160:163]
    v_mfma_f32_16x16x32_bf16 v[52:55], a[84:87], a[32:35], v[52:55]
    ds_read_b64_tr_b16 a[80:81], v18 offset:0
    v_mfma_f32_16x16x32_bf16 v[68:71], a[84:87], a[36:39], v[68:71]
    ds_read_b64_tr_b16 a[82:83], v18 offset:256
    v_mfma_f32_16x16x32_bf16 v[84:87], a[84:87], a[40:43], v[84:87]
    buffer_load_dwordx4 v14, s[12:15], s36 offen offset:2048 lds
    v_mfma_f32_16x16x32_bf16 v[100:103], a[84:87], a[44:47], v[100:103]
    v_mfma_f32_16x16x32_bf16 v[116:119], a[84:87], a[48:51], v[116:119]
    buffer_load_dwordx4 v15, s[12:15], s36 offen offset:3072 lds
    v_mfma_f32_16x16x32_bf16 v[132:135], a[84:87], a[52:55], v[132:135]
    v_mfma_f32_16x16x32_bf16 v[148:151], a[84:87], a[56:59], v[148:151]
    v_mfma_f32_16x16x32_bf16 v[164:167], a[84:87], a[0:3], v[164:167]
    s_waitcnt lgkmcnt(6)
    v_mfma_f32_16x16x32_bf16 v[40:43], a[72:75], a[36:39], v[40:43]
    ds_read_b64_tr_b16 a[84:85], v19 offset:0
    v_mfma_f32_16x16x32_bf16 v[56:59], a[72:75], a[40:43], v[56:59]
    ds_read_b64_tr_b16 a[86:87], v19 offset:256
    v_mfma_f32_16x16x32_bf16 v[72:75], a[72:75], a[44:47], v[72:75]
    v_mfma_f32_16x16x32_bf16 v[88:91], a[72:75], a[48:51], v[88:91]
    v_mfma_f32_16x16x32_bf16 v[104:107], a[72:75], a[52:55], v[104:107]
    v_mfma_f32_16x16x32_bf16 v[120:123], a[72:75], a[56:59], v[120:123]
    v_mfma_f32_16x16x32_bf16 v[136:139], a[72:75], a[0:3], v[136:139]
    v_mfma_f32_16x16x32_bf16 v[152:155], a[72:75], a[4:7], v[152:155]
    s_waitcnt lgkmcnt(4)
    v_mfma_f32_16x16x32_bf16 v[44:47], a[76:79], a[36:39], v[44:47]
    s_waitcnt vmcnt(12)
    v_mfma_f32_16x16x32_bf16 v[60:63], a[76:79], a[40:43], v[60:63]
    ds_read_b64_tr_b16 a[72:73], v16 offset:4096
    v_mfma_f32_16x16x32_bf16 v[76:79], a[76:79], a[44:47], v[76:79]
    ds_read_b64_tr_b16 a[74:75], v16 offset:4352
    v_mfma_f32_16x16x32_bf16 v[92:95], a[76:79], a[48:51], v[92:95]
    v_mfma_f32_16x16x32_bf16 v[108:111], a[76:79], a[52:55], v[108:111]
    ds_read_b128 a[16:19], v11 offset:39936
    v_mfma_f32_16x16x32_bf16 v[124:127], a[76:79], a[56:59], v[124:127]
    v_mfma_f32_16x16x32_bf16 v[140:143], a[76:79], a[0:3], v[140:143]
    ds_read_b128 a[20:23], v11 offset:40192
    v_mfma_f32_16x16x32_bf16 v[156:159], a[76:79], a[4:7], v[156:159]
    s_waitcnt lgkmcnt(6)
    v_mfma_f32_16x16x32_bf16 v[48:51], a[80:83], a[36:39], v[48:51]
    ds_read_b64_tr_b16 a[76:77], v17 offset:4096
    v_mfma_f32_16x16x32_bf16 v[64:67], a[80:83], a[40:43], v[64:67]
    ds_read_b64_tr_b16 a[78:79], v17 offset:4352
    v_mfma_f32_16x16x32_bf16 v[80:83], a[80:83], a[44:47], v[80:83]
    s_add_u32 m0, s34, 0
    s_add_u32 s36, s30, 0
    v_mfma_f32_16x16x32_bf16 v[96:99], a[80:83], a[48:51], v[96:99]
    s_waitcnt lgkmcnt(6)
    v_mfma_f32_16x16x32_bf16 v[112:115], a[80:83], a[52:55], v[112:115]
    buffer_load_dwordx4 v12, s[12:15], s36 offen offset:0 lds
    v_mfma_f32_16x16x32_bf16 v[128:131], a[80:83], a[56:59], v[128:131]
    v_mfma_f32_16x16x32_bf16 v[144:147], a[80:83], a[0:3], v[144:147]
    buffer_load_dwordx4 v13, s[12:15], s36 offen offset:1024 lds
    v_mfma_f32_16x16x32_bf16 v[160:163], a[80:83], a[4:7], v[160:163]
    v_mfma_f32_16x16x32_bf16 v[52:55], a[84:87], a[36:39], v[52:55]
    ds_read_b64_tr_b16 a[80:81], v18 offset:4096
    v_mfma_f32_16x16x32_bf16 v[68:71], a[84:87], a[40:43], v[68:71]
    ds_read_b64_tr_b16 a[82:83], v18 offset:4352
    v_mfma_f32_16x16x32_bf16 v[84:87], a[84:87], a[44:47], v[84:87]
    buffer_load_dwordx4 v14, s[12:15], s36 offen offset:2048 lds
    v_mfma_f32_16x16x32_bf16 v[100:103], a[84:87], a[48:51], v[100:103]
    v_mfma_f32_16x16x32_bf16 v[116:119], a[84:87], a[52:55], v[116:119]
    buffer_load_dwordx4 v15, s[12:15], s36 offen offset:3072 lds
    v_mfma_f32_16x16x32_bf16 v[132:135], a[84:87], a[56:59], v[132:135]
    v_mfma_f32_16x16x32_bf16 v[148:151], a[84:87], a[0:3], v[148:151]
    v_mfma_f32_16x16x32_bf16 v[164:167], a[84:87], a[4:7], v[164:167]
    s_waitcnt lgkmcnt(0)
    s_barrier
    v_mfma_f32_16x16x32_bf16 v[40:43], a[72:75], a[40:43], v[40:43]
    ds_read_b64_tr_b16 a[84:85], v19 offset:4096
    v_mfma_f32_16x16x32_bf16 v[56:59], a[72:75], a[44:47], v[56:59]
    ds_read_b64_tr_b16 a[86:87], v19 offset:4352
    v_mfma_f32_16x16x32_bf16 v[72:75], a[72:75], a[48:51], v[72:75]
    s_add_u32 m0, s33, 36864
    s_nop 0
    v_mfma_f32_16x16x32_bf16 v[88:91], a[72:75], a[52:55], v[88:91]
    buffer_load_dwordx4 v9, s[8:11], s32 offen lds
    v_mfma_f32_16x16x32_bf16 v[104:107], a[72:75], a[56:59], v[104:107]
    s_add_u32 m0, s33, 40960
    s_add_u32 s36, s31, 33792
    v_mfma_f32_16x16x32_bf16 v[120:123], a[72:75], a[0:3], v[120:123]
    buffer_load_dwordx4 v5, s[8:11], s36 offen lds
    v_mfma_f32_16x16x32_bf16 v[136:139], a[72:75], a[4:7], v[136:139]
    s_add_u32 m0, s33, 45056
    s_add_u32 s36, s31, 66560
    v_mfma_f32_16x16x32_bf16 v[152:155], a[72:75], a[8:11], v[152:155]
    buffer_load_dwordx4 v6, s[8:11], s36 offen lds
    v_mfma_f32_16x16x32_bf16 v[44:47], a[76:79], a[40:43], v[44:47]
    s_waitcnt vmcnt(15)
    v_mfma_f32_16x16x32_bf16 v[60:63], a[76:79], a[44:47], v[60:63]
    ds_read_b64_tr_b16 a[72:73], v16 offset:8192
    v_mfma_f32_16x16x32_bf16 v[76:79], a[76:79], a[48:51], v[76:79]
    ds_read_b64_tr_b16 a[74:75], v16 offset:8448
    v_mfma_f32_16x16x32_bf16 v[92:95], a[76:79], a[52:55], v[92:95]
    s_add_u32 m0, s33, 49152
    s_add_u32 s36, s31, 99328
    v_mfma_f32_16x16x32_bf16 v[108:111], a[76:79], a[56:59], v[108:111]
    ds_read_b128 a[24:27], v10 offset:0
    v_mfma_f32_16x16x32_bf16 v[124:127], a[76:79], a[0:3], v[124:127]
    buffer_load_dwordx4 v7, s[8:11], s36 offen lds
    v_mfma_f32_16x16x32_bf16 v[140:143], a[76:79], a[4:7], v[140:143]
    ds_read_b128 a[28:31], v10 offset:256
    s_add_u32 m0, s33, 53248
    s_add_u32 s36, s31, 132096
    v_mfma_f32_16x16x32_bf16 v[156:159], a[76:79], a[8:11], v[156:159]
    buffer_load_dwordx4 v4, s[8:11], s36 offen lds
    v_mfma_f32_16x16x32_bf16 v[48:51], a[80:83], a[40:43], v[48:51]
    ds_read_b64_tr_b16 a[76:77], v17 offset:8192
    v_mfma_f32_16x16x32_bf16 v[64:67], a[80:83], a[44:47], v[64:67]
    ds_read_b64_tr_b16 a[78:79], v17 offset:8448
    v_mfma_f32_16x16x32_bf16 v[80:83], a[80:83], a[48:51], v[80:83]
    s_add_u32 m0, s34, 4096
    s_add_u32 s36, s30, 1048576
    v_mfma_f32_16x16x32_bf16 v[96:99], a[80:83], a[52:55], v[96:99]
    s_waitcnt lgkmcnt(6)
    v_mfma_f32_16x16x32_bf16 v[112:115], a[80:83], a[56:59], v[112:115]
    buffer_load_dwordx4 v12, s[12:15], s36 offen offset:0 lds
    v_mfma_f32_16x16x32_bf16 v[128:131], a[80:83], a[0:3], v[128:131]
    v_mfma_f32_16x16x32_bf16 v[144:147], a[80:83], a[4:7], v[144:147]
    buffer_load_dwordx4 v13, s[12:15], s36 offen offset:1024 lds
    v_mfma_f32_16x16x32_bf16 v[160:163], a[80:83], a[8:11], v[160:163]
    v_mfma_f32_16x16x32_bf16 v[52:55], a[84:87], a[40:43], v[52:55]
    ds_read_b64_tr_b16 a[80:81], v18 offset:8192
    v_mfma_f32_16x16x32_bf16 v[68:71], a[84:87], a[44:47], v[68:71]
    ds_read_b64_tr_b16 a[82:83], v18 offset:8448
    v_mfma_f32_16x16x32_bf16 v[84:87], a[84:87], a[48:51], v[84:87]
    buffer_load_dwordx4 v14, s[12:15], s36 offen offset:2048 lds
    v_mfma_f32_16x16x32_bf16 v[100:103], a[84:87], a[52:55], v[100:103]
    v_mfma_f32_16x16x32_bf16 v[116:119], a[84:87], a[56:59], v[116:119]
    buffer_load_dwordx4 v15, s[12:15], s36 offen offset:3072 lds
    v_mfma_f32_16x16x32_bf16 v[132:135], a[84:87], a[0:3], v[132:135]
    v_mfma_f32_16x16x32_bf16 v[148:151], a[84:87], a[4:7], v[148:151]
    v_mfma_f32_16x16x32_bf16 v[164:167], a[84:87], a[8:11], v[164:167]
    s_waitcnt lgkmcnt(6)
    v_mfma_f32_16x16x32_bf16 v[40:43], a[72:75], a[44:47], v[40:43]
    ds_read_b64_tr_b16 a[84:85], v19 offset:8192
    v_mfma_f32_16x16x32_bf16 v[56:59], a[72:75], a[48:51], v[56:59]
    ds_read_b64_tr_b16 a[86:87], v19 offset:8448
    v_mfma_f32_16x16x32_bf16 v[72:75], a[72:75], a[52:55], v[72:75]
    s_add_u32 m0, s33, 57344
    s_add_u32 s36, s31, 164864
    v_mfma_f32_16x16x32_bf16 v[88:91], a[72:75], a[56:59], v[88:91]
    buffer_load_dwordx4 v5, s[8:11], s36 offen lds
    v_mfma_f32_16x16x32_bf16 v[104:107], a[72:75], a[0:3], v[104:107]
    s_add_u32 m0, s33, 61440
    s_add_u32 s36, s31, 197632
    v_mfma_f32_16x16x32_bf16 v[120:123], a[72:75], a[4:7], v[120:123]
    buffer_load_dwordx4 v6, s[8:11], s36 offen lds
    v_mfma_f32_16x16x32_bf16 v[136:139], a[72:75], a[8:11], v[136:139]
    s_add_u32 m0, s33, 65536
    s_add_u32 s36, s31, 230400
    v_mfma_f32_16x16x32_bf16 v[152:155], a[72:75], a[12:15], v[152:155]
    buffer_load_dwordx4 v7, s[8:11], s36 offen lds
    s_waitcnt lgkmcnt(4)
    v_mfma_f32_16x16x32_bf16 v[44:47], a[76:79], a[44:47], v[44:47]
    s_waitcnt vmcnt(20)
    v_mfma_f32_16x16x32_bf16 v[60:63], a[76:79], a[48:51], v[60:63]
    ds_read_b64_tr_b16 a[72:73], v16 offset:12288
    v_mfma_f32_16x16x32_bf16 v[76:79], a[76:79], a[52:55], v[76:79]
    ds_read_b64_tr_b16 a[74:75], v16 offset:12544
    v_mfma_f32_16x16x32_bf16 v[92:95], a[76:79], a[56:59], v[92:95]
    s_add_u32 m0, s33, 69632
    s_add_u32 s36, s31, 263168
    v_mfma_f32_16x16x32_bf16 v[108:111], a[76:79], a[0:3], v[108:111]
    ds_read_b128 a[32:35], v10 offset:512
    v_mfma_f32_16x16x32_bf16 v[124:127], a[76:79], a[4:7], v[124:127]
    buffer_load_dwordx4 v4, s[8:11], s36 offen lds
    v_mfma_f32_16x16x32_bf16 v[140:143], a[76:79], a[8:11], v[140:143]
    ds_read_b128 a[36:39], v10 offset:768
    v_mfma_f32_16x16x32_bf16 v[156:159], a[76:79], a[12:15], v[156:159]
    s_waitcnt lgkmcnt(6)
    v_mfma_f32_16x16x32_bf16 v[48:51], a[80:83], a[44:47], v[48:51]
    ds_read_b64_tr_b16 a[76:77], v17 offset:12288
    v_mfma_f32_16x16x32_bf16 v[64:67], a[80:83], a[48:51], v[64:67]
    ds_read_b64_tr_b16 a[78:79], v17 offset:12544
    v_mfma_f32_16x16x32_bf16 v[80:83], a[80:83], a[52:55], v[80:83]
    s_add_u32 m0, s34, 8192
    s_add_u32 s36, s30, 2097152
    v_mfma_f32_16x16x32_bf16 v[96:99], a[80:83], a[56:59], v[96:99]
    s_waitcnt lgkmcnt(6)
    v_mfma_f32_16x16x32_bf16 v[112:115], a[80:83], a[0:3], v[112:115]
    buffer_load_dwordx4 v12, s[12:15], s36 offen offset:0 lds
    v_mfma_f32_16x16x32_bf16 v[128:131], a[80:83], a[4:7], v[128:131]
    v_mfma_f32_16x16x32_bf16 v[144:147], a[80:83], a[8:11], v[144:147]
    buffer_load_dwordx4 v13, s[12:15], s36 offen offset:1024 lds
    v_mfma_f32_16x16x32_bf16 v[160:163], a[80:83], a[12:15], v[160:163]
    v_mfma_f32_16x16x32_bf16 v[52:55], a[84:87], a[44:47], v[52:55]
    ds_read_b64_tr_b16 a[80:81], v18 offset:12288
    v_mfma_f32_16x16x32_bf16 v[68:71], a[84:87], a[48:51], v[68:71]
    ds_read_b64_tr_b16 a[82:83], v18 offset:12544
    v_mfma_f32_16x16x32_bf16 v[84:87], a[84:87], a[52:55], v[84:87]
    buffer_load_dwordx4 v14, s[12:15], s36 offen offset:2048 lds
    v_mfma_f32_16x16x32_bf16 v[100:103], a[84:87], a[56:59], v[100:103]
    v_mfma_f32_16x16x32_bf16 v[116:119], a[84:87], a[0:3], v[116:119]
    buffer_load_dwordx4 v15, s[12:15], s36 offen offset:3072 lds
    v_mfma_f32_16x16x32_bf16 v[132:135], a[84:87], a[4:7], v[132:135]
    v_mfma_f32_16x16x32_bf16 v[148:151], a[84:87], a[8:11], v[148:151]
    v_mfma_f32_16x16x32_bf16 v[164:167], a[84:87], a[12:15], v[164:167]
    s_waitcnt lgkmcnt(6)
    v_mfma_f32_16x16x32_bf16 v[40:43], a[72:75], a[48:51], v[40:43]
    ds_read_b64_tr_b16 a[84:85], v19 offset:12288
    v_mfma_f32_16x16x32_bf16 v[56:59], a[72:75], a[52:55], v[56:59]
    ds_read_b64_tr_b16 a[86:87], v19 offset:12544
    v_mfma_f32_16x16x32_bf16 v[72:75], a[72:75], a[56:59], v[72:75]
    v_mfma_f32_16x16x32_bf16 v[88:91], a[72:75], a[0:3], v[88:91]
    v_mfma_f32_16x16x32_bf16 v[104:107], a[72:75], a[4:7], v[104:107]
    v_mfma_f32_16x16x32_bf16 v[120:123], a[72:75], a[8:11], v[120:123]
    v_mfma_f32_16x16x32_bf16 v[136:139], a[72:75], a[12:15], v[136:139]
    v_mfma_f32_16x16x32_bf16 v[152:155], a[72:75], a[16:19], v[152:155]
    s_waitcnt lgkmcnt(4)
    v_mfma_f32_16x16x32_bf16 v[44:47], a[76:79], a[48:51], v[44:47]
    s_waitcnt vmcnt(21)
    v_mfma_f32_16x16x32_bf16 v[60:63], a[76:79], a[52:55], v[60:63]
    ds_read_b64_tr_b16 a[72:73], v16 offset:16384
    v_mfma_f32_16x16x32_bf16 v[76:79], a[76:79], a[56:59], v[76:79]
    ds_read_b64_tr_b16 a[74:75], v16 offset:16640
    v_mfma_f32_16x16x32_bf16 v[92:95], a[76:79], a[0:3], v[92:95]
    v_mfma_f32_16x16x32_bf16 v[108:111], a[76:79], a[4:7], v[108:111]
    ds_read_b128 a[40:43], v10 offset:1024
    v_mfma_f32_16x16x32_bf16 v[124:127], a[76:79], a[8:11], v[124:127]
    v_mfma_f32_16x16x32_bf16 v[140:143], a[76:79], a[12:15], v[140:143]
    ds_read_b128 a[44:47], v10 offset:1280
    v_mfma_f32_16x16x32_bf16 v[156:159], a[76:79], a[16:19], v[156:159]
    s_waitcnt lgkmcnt(6)
    v_mfma_f32_16x16x32_bf16 v[48:51], a[80:83], a[48:51], v[48:51]
    ds_read_b64_tr_b16 a[76:77], v17 offset:16384
    v_mfma_f32_16x16x32_bf16 v[64:67], a[80:83], a[52:55], v[64:67]
    ds_read_b64_tr_b16 a[78:79], v17 offset:16640
    v_mfma_f32_16x16x32_bf16 v[80:83], a[80:83], a[56:59], v[80:83]
    s_add_u32 m0, s34, 12288
    s_add_u32 s36, s30, 3145728
    v_mfma_f32_16x16x32_bf16 v[96:99], a[80:83], a[0:3], v[96:99]
    s_waitcnt lgkmcnt(6)
    v_mfma_f32_16x16x32_bf16 v[112:115], a[80:83], a[4:7], v[112:115]
    buffer_load_dwordx4 v12, s[12:15], s36 offen offset:0 lds
    v_mfma_f32_16x16x32_bf16 v[128:131], a[80:83], a[8:11], v[128:131]
    v_mfma_f32_16x16x32_bf16 v[144:147], a[80:83], a[12:15], v[144:147]
    buffer_load_dwordx4 v13, s[12:15], s36 offen offset:1024 lds
    v_mfma_f32_16x16x32_bf16 v[160:163], a[80:83], a[16:19], v[160:163]
    v_mfma_f32_16x16x32_bf16 v[52:55], a[84:87], a[48:51], v[52:55]
    ds_read_b64_tr_b16 a[80:81], v18 offset:16384
    v_mfma_f32_16x16x32_bf16 v[68:71], a[84:87], a[52:55], v[68:71]
    ds_read_b64_tr_b16 a[82:83], v18 offset:16640
    v_mfma_f32_16x16x32_bf16 v[84:87], a[84:87], a[56:59], v[84:87]
    buffer_load_dwordx4 v14, s[12:15], s36 offen offset:2048 lds
    v_mfma_f32_16x16x32_bf16 v[100:103], a[84:87], a[0:3], v[100:103]
    v_mfma_f32_16x16x32_bf16 v[116:119], a[84:87], a[4:7], v[116:119]
    buffer_load_dwordx4 v15, s[12:15], s36 offen offset:3072 lds
    v_mfma_f32_16x16x32_bf16 v[132:135], a[84:87], a[8:11], v[132:135]
    v_mfma_f32_16x16x32_bf16 v[148:151], a[84:87], a[12:15], v[148:151]
    v_mfma_f32_16x16x32_bf16 v[164:167], a[84:87], a[16:19], v[164:167]
    s_waitcnt lgkmcnt(6)
    v_mfma_f32_16x16x32_bf16 v[40:43], a[72:75], a[52:55], v[40:43]
    ds_read_b64_tr_b16 a[84:85], v19 offset:16384
    v_mfma_f32_16x16x32_bf16 v[56:59], a[72:75], a[56:59], v[56:59]
    ds_read_b64_tr_b16 a[86:87], v19 offset:16640
    v_mfma_f32_16x16x32_bf16 v[72:75], a[72:75], a[0:3], v[72:75]
    s_add_u32 s35, s35, 1
    v_mfma_f32_16x16x32_bf16 v[88:91], a[72:75], a[4:7], v[88:91]
    v_mfma_f32_16x16x32_bf16 v[104:107], a[72:75], a[8:11], v[104:107]
    v_mfma_f32_16x16x32_bf16 v[120:123], a[72:75], a[12:15], v[120:123]
    v_mfma_f32_16x16x32_bf16 v[136:139], a[72:75], a[16:19], v[136:139]
    v_mfma_f32_16x16x32_bf16 v[152:155], a[72:75], a[20:23], v[152:155]
    s_waitcnt lgkmcnt(4)
    v_mfma_f32_16x16x32_bf16 v[44:47], a[76:79], a[52:55], v[44:47]
    s_waitcnt vmcnt(21)
    v_mfma_f32_16x16x32_bf16 v[60:63], a[76:79], a[56:59], v[60:63]
    ds_read_b64_tr_b16 a[72:73], v16 offset:0
    v_mfma_f32_16x16x32_bf16 v[76:79], a[76:79], a[0:3], v[76:79]
    ds_read_b64_tr_b16 a[74:75], v16 offset:256
    v_mfma_f32_16x16x32_bf16 v[92:95], a[76:79], a[4:7], v[92:95]
    v_mfma_f32_16x16x32_bf16 v[108:111], a[76:79], a[8:11], v[108:111]
    ds_read_b128 a[60:63], v10 offset:1536
    v_mfma_f32_16x16x32_bf16 v[124:127], a[76:79], a[12:15], v[124:127]
    v_mfma_f32_16x16x32_bf16 v[140:143], a[76:79], a[16:19], v[140:143]
    ds_read_b128 a[64:67], v10 offset:1792
    v_mfma_f32_16x16x32_bf16 v[156:159], a[76:79], a[20:23], v[156:159]
    s_waitcnt lgkmcnt(6)
    v_mfma_f32_16x16x32_bf16 v[48:51], a[80:83], a[52:55], v[48:51]
    ds_read_b64_tr_b16 a[76:77], v17 offset:0
    v_mfma_f32_16x16x32_bf16 v[64:67], a[80:83], a[56:59], v[64:67]
    ds_read_b64_tr_b16 a[78:79], v17 offset:256
    v_mfma_f32_16x16x32_bf16 v[80:83], a[80:83], a[0:3], v[80:83]
    s_add_u32 m0, s34, 16384
    s_add_u32 s36, s30, 4194304
    v_mfma_f32_16x16x32_bf16 v[96:99], a[80:83], a[4:7], v[96:99]
    s_waitcnt lgkmcnt(6)
    v_mfma_f32_16x16x32_bf16 v[112:115], a[80:83], a[8:11], v[112:115]
    buffer_load_dwordx4 v12, s[12:15], s36 offen offset:0 lds
    v_mfma_f32_16x16x32_bf16 v[128:131], a[80:83], a[12:15], v[128:131]
    v_mfma_f32_16x16x32_bf16 v[144:147], a[80:83], a[16:19], v[144:147]
    buffer_load_dwordx4 v13, s[12:15], s36 offen offset:1024 lds
    v_mfma_f32_16x16x32_bf16 v[160:163], a[80:83], a[20:23], v[160:163]
    v_mfma_f32_16x16x32_bf16 v[52:55], a[84:87], a[52:55], v[52:55]
    ds_read_b64_tr_b16 a[80:81], v18 offset:0
    v_mfma_f32_16x16x32_bf16 v[68:71], a[84:87], a[56:59], v[68:71]
    ds_read_b64_tr_b16 a[82:83], v18 offset:256
    v_mfma_f32_16x16x32_bf16 v[84:87], a[84:87], a[0:3], v[84:87]
    buffer_load_dwordx4 v14, s[12:15], s36 offen offset:2048 lds
    v_mfma_f32_16x16x32_bf16 v[100:103], a[84:87], a[4:7], v[100:103]
    v_mfma_f32_16x16x32_bf16 v[116:119], a[84:87], a[8:11], v[116:119]
    buffer_load_dwordx4 v15, s[12:15], s36 offen offset:3072 lds
    v_mfma_f32_16x16x32_bf16 v[132:135], a[84:87], a[12:15], v[132:135]
    s_add_u32 s29, s29, 131072
    s_add_u32 s30, s30, 131072
    v_mfma_f32_16x16x32_bf16 v[148:151], a[84:87], a[16:19], v[148:151]
    s_add_u32 s31, s31, 256
    s_add_u32 s32, s32, 256
    v_mfma_f32_16x16x32_bf16 v[164:167], a[84:87], a[20:23], v[164:167]
    s_cmp_lt_u32 s35, 3
    s_cbranch_scc1 conv1_kernel_loop
conv1_kernel_last:
    s_waitcnt lgkmcnt(6)
    v_mfma_f32_16x16x32_bf16 v[40:43], a[72:75], a[24:27], v[40:43]
    ds_read_b64_tr_b16 a[84:85], v19 offset:0
    v_mfma_f32_16x16x32_bf16 v[56:59], a[72:75], a[28:31], v[56:59]
    ds_read_b64_tr_b16 a[86:87], v19 offset:256
    v_mfma_f32_16x16x32_bf16 v[72:75], a[72:75], a[32:35], v[72:75]
    v_mfma_f32_16x16x32_bf16 v[88:91], a[72:75], a[36:39], v[88:91]
    v_mfma_f32_16x16x32_bf16 v[104:107], a[72:75], a[40:43], v[104:107]
    v_mfma_f32_16x16x32_bf16 v[120:123], a[72:75], a[44:47], v[120:123]
    s_waitcnt lgkmcnt(7)
    v_mfma_f32_16x16x32_bf16 v[136:139], a[72:75], a[60:63], v[136:139]
    s_waitcnt lgkmcnt(6)
    v_mfma_f32_16x16x32_bf16 v[152:155], a[72:75], a[64:67], v[152:155]
    s_waitcnt lgkmcnt(4)
    v_mfma_f32_16x16x32_bf16 v[44:47], a[76:79], a[24:27], v[44:47]
    s_waitcnt vmcnt(16)
    v_mfma_f32_16x16x32_bf16 v[60:63], a[76:79], a[28:31], v[60:63]
    ds_read_b64_tr_b16 a[72:73], v16 offset:4096
    v_mfma_f32_16x16x32_bf16 v[76:79], a[76:79], a[32:35], v[76:79]
    ds_read_b64_tr_b16 a[74:75], v16 offset:4352
    v_mfma_f32_16x16x32_bf16 v[92:95], a[76:79], a[36:39], v[92:95]
    v_mfma_f32_16x16x32_bf16 v[108:111], a[76:79], a[40:43], v[108:111]
    ds_read_b128 a[0:3], v11 offset:2048
    v_mfma_f32_16x16x32_bf16 v[124:127], a[76:79], a[44:47], v[124:127]
    v_mfma_f32_16x16x32_bf16 v[140:143], a[76:79], a[60:63], v[140:143]
    ds_read_b128 a[4:7], v11 offset:2304
    v_mfma_f32_16x16x32_bf16 v[156:159], a[76:79], a[64:67], v[156:159]
    s_waitcnt lgkmcnt(6)
    v_mfma_f32_16x16x32_bf16 v[48:51], a[80:83], a[24:27], v[48:51]
    ds_read_b64_tr_b16 a[76:77], v17 offset:4096
    v_mfma_f32_16x16x32_bf16 v[64:67], a[80:83], a[28:31], v[64:67]
    ds_read_b64_tr_b16 a[78:79], v17 offset:4352
    v_mfma_f32_16x16x32_bf16 v[80:83], a[80:83], a[32:35], v[80:83]
    s_add_u32 m0, s34, 0
    s_add_u32 s36, s29, 5242880
    v_mfma_f32_16x16x32_bf16 v[96:99], a[80:83], a[36:39], v[96:99]
    s_waitcnt lgkmcnt(6)
    v_mfma_f32_16x16x32_bf16 v[112:115], a[80:83], a[40:43], v[112:115]
    buffer_load_dwordx4 v12, s[12:15], s36 offen offset:0 lds
    v_mfma_f32_16x16x32_bf16 v[128:131], a[80:83], a[44:47], v[128:131]
    v_mfma_f32_16x16x32_bf16 v[144:147], a[80:83], a[60:63], v[144:147]
    buffer_load_dwordx4 v13, s[12:15], s36 offen offset:1024 lds
    v_mfma_f32_16x16x32_bf16 v[160:163], a[80:83], a[64:67], v[160:163]
    v_mfma_f32_16x16x32_bf16 v[52:55], a[84:87], a[24:27], v[52:55]
    ds_read_b64_tr_b16 a[80:81], v18 offset:4096
    v_mfma_f32_16x16x32_bf16 v[68:71], a[84:87], a[28:31], v[68:71]
    ds_read_b64_tr_b16 a[82:83], v18 offset:4352
    v_mfma_f32_16x16x32_bf16 v[84:87], a[84:87], a[32:35], v[84:87]
    buffer_load_dwordx4 v14, s[12:15], s36 offen offset:2048 lds
    v_mfma_f32_16x16x32_bf16 v[100:103], a[84:87], a[36:39], v[100:103]
    v_mfma_f32_16x16x32_bf16 v[116:119], a[84:87], a[40:43], v[116:119]
    buffer_load_dwordx4 v15, s[12:15], s36 offen offset:3072 lds
    v_mfma_f32_16x16x32_bf16 v[132:135], a[84:87], a[44:47], v[132:135]
    v_mfma_f32_16x16x32_bf16 v[148:151], a[84:87], a[60:63], v[148:151]
    v_mfma_f32_16x16x32_bf16 v[164:167], a[84:87], a[64:67], v[164:167]
    s_waitcnt lgkmcnt(6)
    v_mfma_f32_16x16x32_bf16 v[40:43], a[72:75], a[28:31], v[40:43]
    ds_read_b64_tr_b16 a[84:85], v19 offset:4096
    v_mfma_f32_16x16x32_bf16 v[56:59], a[72:75], a[32:35], v[56:59]
    ds_read_b64_tr_b16 a[86:87], v19 offset:4352
    v_mfma_f32_16x16x32_bf16 v[72:75], a[72:75], a[36:39], v[72:75]
    v_mfma_f32_16x16x32_bf16 v[88:91], a[72:75], a[40:43], v[88:91]
    v_mfma_f32_16x16x32_bf16 v[104:107], a[72:75], a[44:47], v[104:107]
    v_mfma_f32_16x16x32_bf16 v[120:123], a[72:75], a[60:63], v[120:123]
    v_mfma_f32_16x16x32_bf16 v[136:139], a[72:75], a[64:67], v[136:139]
    s_waitcnt lgkmcnt(7)
    v_mfma_f32_16x16x32_bf16 v[152:155], a[72:75], a[0:3], v[152:155]
    s_waitcnt lgkmcnt(4)
    v_mfma_f32_16x16x32_bf16 v[44:47], a[76:79], a[28:31], v[44:47]
    s_waitcnt vmcnt(12)
    v_mfma_f32_16x16x32_bf16 v[60:63], a[76:79], a[32:35], v[60:63]
    ds_read_b64_tr_b16 a[72:73], v16 offset:8192
    v_mfma_f32_16x16x32_bf16 v[76:79], a[76:79], a[36:39], v[76:79]
    ds_read_b64_tr_b16 a[74:75], v16 offset:8448
    v_mfma_f32_16x16x32_bf16 v[92:95], a[76:79], a[40:43], v[92:95]
    v_mfma_f32_16x16x32_bf16 v[108:111], a[76:79], a[44:47], v[108:111]
    ds_read_b128 a[8:11], v11 offset:2560
    v_mfma_f32_16x16x32_bf16 v[124:127], a[76:79], a[60:63], v[124:127]
    v_mfma_f32_16x16x32_bf16 v[140:143], a[76:79], a[64:67], v[140:143]
    ds_read_b128 a[12:15], v11 offset:2816
    v_mfma_f32_16x16x32_bf16 v[156:159], a[76:79], a[0:3], v[156:159]
    s_waitcnt lgkmcnt(6)
    v_mfma_f32_16x16x32_bf16 v[48:51], a[80:83], a[28:31], v[48:51]
    ds_read_b64_tr_b16 a[76:77], v17 offset:8192
    v_mfma_f32_16x16x32_bf16 v[64:67], a[80:83], a[32:35], v[64:67]
    ds_read_b64_tr_b16 a[78:79], v17 offset:8448
    v_mfma_f32_16x16x32_bf16 v[80:83], a[80:83], a[36:39], v[80:83]
    s_add_u32 m0, s34, 4096
    s_add_u32 s36, s29, 6291456
    v_mfma_f32_16x16x32_bf16 v[96:99], a[80:83], a[40:43], v[96:99]
    s_waitcnt lgkmcnt(6)
    v_mfma_f32_16x16x32_bf16 v[112:115], a[80:83], a[44:47], v[112:115]
    buffer_load_dwordx4 v12, s[12:15], s36 offen offset:0 lds
    v_mfma_f32_16x16x32_bf16 v[128:131], a[80:83], a[60:63], v[128:131]
    v_mfma_f32_16x16x32_bf16 v[144:147], a[80:83], a[64:67], v[144:147]
    buffer_load_dwordx4 v13, s[12:15], s36 offen offset:1024 lds
    v_mfma_f32_16x16x32_bf16 v[160:163], a[80:83], a[0:3], v[160:163]
    v_mfma_f32_16x16x32_bf16 v[52:55], a[84:87], a[28:31], v[52:55]
    ds_read_b64_tr_b16 a[80:81], v18 offset:8192
    v_mfma_f32_16x16x32_bf16 v[68:71], a[84:87], a[32:35], v[68:71]
    ds_read_b64_tr_b16 a[82:83], v18 offset:8448
    v_mfma_f32_16x16x32_bf16 v[84:87], a[84:87], a[36:39], v[84:87]
    buffer_load_dwordx4 v14, s[12:15], s36 offen offset:2048 lds
    v_mfma_f32_16x16x32_bf16 v[100:103], a[84:87], a[40:43], v[100:103]
    v_mfma_f32_16x16x32_bf16 v[116:119], a[84:87], a[44:47], v[116:119]
    buffer_load_dwordx4 v15, s[12:15], s36 offen offset:3072 lds
    v_mfma_f32_16x16x32_bf16 v[132:135], a[84:87], a[60:63], v[132:135]
    v_mfma_f32_16x16x32_bf16 v[148:151], a[84:87], a[64:67], v[148:151]
    v_mfma_f32_16x16x32_bf16 v[164:167], a[84:87], a[0:3], v[164:167]
    s_waitcnt lgkmcnt(6)
    v_mfma_f32_16x16x32_bf16 v[40:43], a[72:75], a[32:35], v[40:43]
    ds_read_b64_tr_b16 a[84:85], v19 offset:8192
    v_mfma_f32_16x16x32_bf16 v[56:59], a[72:75], a[36:39], v[56:59]
    ds_read_b64_tr_b16 a[86:87], v19 offset:8448
    v_mfma_f32_16x16x32_bf16 v[72:75], a[72:75], a[40:43], v[72:75]
    v_mfma_f32_16x16x32_bf16 v[88:91], a[72:75], a[44:47], v[88:91]
    v_mfma_f32_16x16x32_bf16 v[104:107], a[72:75], a[60:63], v[104:107]
    v_mfma_f32_16x16x32_bf16 v[120:123], a[72:75], a[64:67], v[120:123]
    v_mfma_f32_16x16x32_bf16 v[136:139], a[72:75], a[0:3], v[136:139]
    v_mfma_f32_16x16x32_bf16 v[152:155], a[72:75], a[4:7], v[152:155]
    s_waitcnt lgkmcnt(4)
    v_mfma_f32_16x16x32_bf16 v[44:47], a[76:79], a[32:35], v[44:47]
    s_waitcnt vmcnt(12)
    v_mfma_f32_16x16x32_bf16 v[60:63], a[76:79], a[36:39], v[60:63]
    ds_read_b64_tr_b16 a[72:73], v16 offset:12288
    v_mfma_f32_16x16x32_bf16 v[76:79], a[76:79], a[40:43], v[76:79]
    ds_read_b64_tr_b16 a[74:75], v16 offset:12544
    v_mfma_f32_16x16x32_bf16 v[92:95], a[76:79], a[44:47], v[92:95]
    v_mfma_f32_16x16x32_bf16 v[108:111], a[76:79], a[60:63], v[108:111]
    ds_read_b128 a[16:19], v11 offset:3072
    v_mfma_f32_16x16x32_bf16 v[124:127], a[76:79], a[64:67], v[124:127]
    v_mfma_f32_16x16x32_bf16 v[140:143], a[76:79], a[0:3], v[140:143]
    ds_read_b128 a[20:23], v11 offset:3328
    v_mfma_f32_16x16x32_bf16 v[156:159], a[76:79], a[4:7], v[156:159]
    s_waitcnt lgkmcnt(6)
    v_mfma_f32_16x16x32_bf16 v[48:51], a[80:83], a[32:35], v[48:51]
    ds_read_b64_tr_b16 a[76:77], v17 offset:12288
    v_mfma_f32_16x16x32_bf16 v[64:67], a[80:83], a[36:39], v[64:67]
    ds_read_b64_tr_b16 a[78:79], v17 offset:12544
    v_mfma_f32_16x16x32_bf16 v[80:83], a[80:83], a[40:43], v[80:83]
    s_add_u32 m0, s34, 8192
    s_add_u32 s36, s29, 7340032
    v_mfma_f32_16x16x32_bf16 v[96:99], a[80:83], a[44:47], v[96:99]
    s_waitcnt lgkmcnt(6)
    v_mfma_f32_16x16x32_bf16 v[112:115], a[80:83], a[60:63], v[112:115]
    buffer_load_dwordx4 v12, s[12:15], s36 offen offset:0 lds
    v_mfma_f32_16x16x32_bf16 v[128:131], a[80:83], a[64:67], v[128:131]
    v_mfma_f32_16x16x32_bf16 v[144:147], a[80:83], a[0:3], v[144:147]
    buffer_load_dwordx4 v13, s[12:15], s36 offen offset:1024 lds
    v_mfma_f32_16x16x32_bf16 v[160:163], a[80:83], a[4:7], v[160:163]
    v_mfma_f32_16x16x32_bf16 v[52:55], a[84:87], a[32:35], v[52:55]
    ds_read_b64_tr_b16 a[80:81], v18 offset:12288
    v_mfma_f32_16x16x32_bf16 v[68:71], a[84:87], a[36:39], v[68:71]
    ds_read_b64_tr_b16 a[82:83], v18 offset:12544
    v_mfma_f32_16x16x32_bf16 v[84:87], a[84:87], a[40:43], v[84:87]
    buffer_load_dwordx4 v14, s[12:15], s36 offen offset:2048 lds
    v_mfma_f32_16x16x32_bf16 v[100:103], a[84:87], a[44:47], v[100:103]
    v_mfma_f32_16x16x32_bf16 v[116:119], a[84:87], a[60:63], v[116:119]
    buffer_load_dwordx4 v15, s[12:15], s36 offen offset:3072 lds
    v_mfma_f32_16x16x32_bf16 v[132:135], a[84:87], a[64:67], v[132:135]
    v_mfma_f32_16x16x32_bf16 v[148:151], a[84:87], a[0:3], v[148:151]
    v_mfma_f32_16x16x32_bf16 v[164:167], a[84:87], a[4:7], v[164:167]
    s_waitcnt lgkmcnt(6)
    v_mfma_f32_16x16x32_bf16 v[40:43], a[72:75], a[36:39], v[40:43]
    ds_read_b64_tr_b16 a[84:85], v19 offset:12288
    v_mfma_f32_16x16x32_bf16 v[56:59], a[72:75], a[40:43], v[56:59]
    ds_read_b64_tr_b16 a[86:87], v19 offset:12544
    v_mfma_f32_16x16x32_bf16 v[72:75], a[72:75], a[44:47], v[72:75]
    v_mfma_f32_16x16x32_bf16 v[88:91], a[72:75], a[60:63], v[88:91]
    v_mfma_f32_16x16x32_bf16 v[104:107], a[72:75], a[64:67], v[104:107]
    v_mfma_f32_16x16x32_bf16 v[120:123], a[72:75], a[0:3], v[120:123]
    v_mfma_f32_16x16x32_bf16 v[136:139], a[72:75], a[4:7], v[136:139]
    v_mfma_f32_16x16x32_bf16 v[152:155], a[72:75], a[8:11], v[152:155]
    s_waitcnt lgkmcnt(4)
    v_mfma_f32_16x16x32_bf16 v[44:47], a[76:79], a[36:39], v[44:47]
    s_waitcnt vmcnt(12)
    v_mfma_f32_16x16x32_bf16 v[60:63], a[76:79], a[40:43], v[60:63]
    ds_read_b64_tr_b16 a[72:73], v16 offset:16384
    v_mfma_f32_16x16x32_bf16 v[76:79], a[76:79], a[44:47], v[76:79]
    ds_read_b64_tr_b16 a[74:75], v16 offset:16640
    v_mfma_f32_16x16x32_bf16 v[92:95], a[76:79], a[60:63], v[92:95]
    v_mfma_f32_16x16x32_bf16 v[108:111], a[76:79], a[64:67], v[108:111]
    ds_read_b128 a[24:27], v11 offset:3584
    v_mfma_f32_16x16x32_bf16 v[124:127], a[76:79], a[0:3], v[124:127]
    v_mfma_f32_16x16x32_bf16 v[140:143], a[76:79], a[4:7], v[140:143]
    v_mfma_f32_16x16x32_bf16 v[156:159], a[76:79], a[8:11], v[156:159]
    s_waitcnt lgkmcnt(5)
    v_mfma_f32_16x16x32_bf16 v[48:51], a[80:83], a[36:39], v[48:51]
    ds_read_b64_tr_b16 a[76:77], v17 offset:16384
    v_mfma_f32_16x16x32_bf16 v[64:67], a[80:83], a[40:43], v[64:67]
    ds_read_b64_tr_b16 a[78:79], v17 offset:16640
    v_mfma_f32_16x16x32_bf16 v[80:83], a[80:83], a[44:47], v[80:83]
    s_add_u32 m0, s34, 12288
    s_add_u32 s36, s29, 524288
    v_mfma_f32_16x16x32_bf16 v[96:99], a[80:83], a[60:63], v[96:99]
    s_waitcnt lgkmcnt(5)
    v_mfma_f32_16x16x32_bf16 v[112:115], a[80:83], a[64:67], v[112:115]
    buffer_load_dwordx4 v12, s[12:15], s36 offen offset:0 lds
    v_mfma_f32_16x16x32_bf16 v[128:131], a[80:83], a[0:3], v[128:131]
    v_mfma_f32_16x16x32_bf16 v[144:147], a[80:83], a[4:7], v[144:147]
    buffer_load_dwordx4 v13, s[12:15], s36 offen offset:1024 lds
    v_mfma_f32_16x16x32_bf16 v[160:163], a[80:83], a[8:11], v[160:163]
    v_mfma_f32_16x16x32_bf16 v[52:55], a[84:87], a[36:39], v[52:55]
    ds_read_b64_tr_b16 a[80:81], v18 offset:16384
    v_mfma_f32_16x16x32_bf16 v[68:71], a[84:87], a[40:43], v[68:71]
    ds_read_b64_tr_b16 a[82:83], v18 offset:16640
    v_mfma_f32_16x16x32_bf16 v[84:87], a[84:87], a[44:47], v[84:87]
    buffer_load_dwordx4 v14, s[12:15], s36 offen offset:2048 lds
    v_mfma_f32_16x16x32_bf16 v[100:103], a[84:87], a[60:63], v[100:103]
    v_mfma_f32_16x16x32_bf16 v[116:119], a[84:87], a[64:67], v[116:119]
    buffer_load_dwordx4 v15, s[12:15], s36 offen offset:3072 lds
    v_mfma_f32_16x16x32_bf16 v[132:135], a[84:87], a[0:3], v[132:135]
    v_mfma_f32_16x16x32_bf16 v[148:151], a[84:87], a[4:7], v[148:151]
    v_mfma_f32_16x16x32_bf16 v[164:167], a[84:87], a[8:11], v[164:167]
    s_waitcnt lgkmcnt(0)
    s_barrier
    v_mfma_f32_16x16x32_bf16 v[40:43], a[72:75], a[40:43], v[40:43]
    ds_read_b64_tr_b16 a[84:85], v19 offset:16384
    v_mfma_f32_16x16x32_bf16 v[56:59], a[72:75], a[44:47], v[56:59]
    ds_read_b64_tr_b16 a[86:87], v19 offset:16640
    v_mfma_f32_16x16x32_bf16 v[72:75], a[72:75], a[60:63], v[72:75]
    v_mfma_f32_16x16x32_bf16 v[88:91], a[72:75], a[64:67], v[88:91]
    v_mfma_f32_16x16x32_bf16 v[104:107], a[72:75], a[0:3], v[104:107]
    v_mfma_f32_16x16x32_bf16 v[120:123], a[72:75], a[4:7], v[120:123]
    v_mfma_f32_16x16x32_bf16 v[136:139], a[72:75], a[8:11], v[136:139]
    v_mfma_f32_16x16x32_bf16 v[152:155], a[72:75], a[12:15], v[152:155]
    v_mfma_f32_16x16x32_bf16 v[44:47], a[76:79], a[40:43], v[44:47]
    s_waitcnt vmcnt(12)
    v_mfma_f32_16x16x32_bf16 v[60:63], a[76:79], a[44:47], v[60:63]
    ds_read_b64_tr_b16 a[72:73], v16 offset:0
    v_mfma_f32_16x16x32_bf16 v[76:79], a[76:79], a[60:63], v[76:79]
    ds_read_b64_tr_b16 a[74:75], v16 offset:256
    v_mfma_f32_16x16x32_bf16 v[92:95], a[76:79], a[64:67], v[92:95]
    v_mfma_f32_16x16x32_bf16 v[108:111], a[76:79], a[0:3], v[108:111]
    ds_read_b128 a[28:31], v10 offset:36864
    v_mfma_f32_16x16x32_bf16 v[124:127], a[76:79], a[4:7], v[124:127]
    v_mfma_f32_16x16x32_bf16 v[140:143], a[76:79], a[8:11], v[140:143]
    ds_read_b128 a[32:35], v10 offset:37120
    v_mfma_f32_16x16x32_bf16 v[156:159], a[76:79], a[12:15], v[156:159]
    v_mfma_f32_16x16x32_bf16 v[48:51], a[80:83], a[40:43], v[48:51]
    ds_read_b64_tr_b16 a[76:77], v17 offset:0
    v_mfma_f32_16x16x32_bf16 v[64:67], a[80:83], a[44:47], v[64:67]
    ds_read_b64_tr_b16 a[78:79], v17 offset:256
    v_mfma_f32_16x16x32_bf16 v[80:83], a[80:83], a[60:63], v[80:83]
    s_add_u32 m0, s34, 16384
    s_add_u32 s36, s29, 1572864
    v_mfma_f32_16x16x32_bf16 v[96:99], a[80:83], a[64:67], v[96:99]
    s_waitcnt lgkmcnt(6)
    v_mfma_f32_16x16x32_bf16 v[112:115], a[80:83], a[0:3], v[112:115]
    buffer_load_dwordx4 v12, s[12:15], s36 offen offset:0 lds
    v_mfma_f32_16x16x32_bf16 v[128:131], a[80:83], a[4:7], v[128:131]
    v_mfma_f32_16x16x32_bf16 v[144:147], a[80:83], a[8:11], v[144:147]
    buffer_load_dwordx4 v13, s[12:15], s36 offen offset:1024 lds
    v_mfma_f32_16x16x32_bf16 v[160:163], a[80:83], a[12:15], v[160:163]
    v_mfma_f32_16x16x32_bf16 v[52:55], a[84:87], a[40:43], v[52:55]
    ds_read_b64_tr_b16 a[80:81], v18 offset:0
    v_mfma_f32_16x16x32_bf16 v[68:71], a[84:87], a[44:47], v[68:71]
    ds_read_b64_tr_b16 a[82:83], v18 offset:256
    v_mfma_f32_16x16x32_bf16 v[84:87], a[84:87], a[60:63], v[84:87]
    buffer_load_dwordx4 v14, s[12:15], s36 offen offset:2048 lds
    v_mfma_f32_16x16x32_bf16 v[100:103], a[84:87], a[64:67], v[100:103]
    v_mfma_f32_16x16x32_bf16 v[116:119], a[84:87], a[0:3], v[116:119]
    buffer_load_dwordx4 v15, s[12:15], s36 offen offset:3072 lds
    v_mfma_f32_16x16x32_bf16 v[132:135], a[84:87], a[4:7], v[132:135]
    v_mfma_f32_16x16x32_bf16 v[148:151], a[84:87], a[8:11], v[148:151]
    v_mfma_f32_16x16x32_bf16 v[164:167], a[84:87], a[12:15], v[164:167]
    s_waitcnt lgkmcnt(6)
    v_mfma_f32_16x16x32_bf16 v[40:43], a[72:75], a[44:47], v[40:43]
    ds_read_b64_tr_b16 a[84:85], v19 offset:0
    v_mfma_f32_16x16x32_bf16 v[56:59], a[72:75], a[60:63], v[56:59]
    ds_read_b64_tr_b16 a[86:87], v19 offset:256
    v_mfma_f32_16x16x32_bf16 v[72:75], a[72:75], a[64:67], v[72:75]
    v_mfma_f32_16x16x32_bf16 v[88:91], a[72:75], a[0:3], v[88:91]
    v_mfma_f32_16x16x32_bf16 v[104:107], a[72:75], a[4:7], v[104:107]
    v_mfma_f32_16x16x32_bf16 v[120:123], a[72:75], a[8:11], v[120:123]
    v_mfma_f32_16x16x32_bf16 v[136:139], a[72:75], a[12:15], v[136:139]
    v_mfma_f32_16x16x32_bf16 v[152:155], a[72:75], a[16:19], v[152:155]
    s_waitcnt lgkmcnt(4)
    v_mfma_f32_16x16x32_bf16 v[44:47], a[76:79], a[44:47], v[44:47]
    s_waitcnt vmcnt(12)
    v_mfma_f32_16x16x32_bf16 v[60:63], a[76:79], a[60:63], v[60:63]
    ds_read_b64_tr_b16 a[72:73], v16 offset:4096
    v_mfma_f32_16x16x32_bf16 v[76:79], a[76:79], a[64:67], v[76:79]
    ds_read_b64_tr_b16 a[74:75], v16 offset:4352
    v_mfma_f32_16x16x32_bf16 v[92:95], a[76:79], a[0:3], v[92:95]
    v_mfma_f32_16x16x32_bf16 v[108:111], a[76:79], a[4:7], v[108:111]
    ds_read_b128 a[36:39], v10 offset:37376
    v_mfma_f32_16x16x32_bf16 v[124:127], a[76:79], a[8:11], v[124:127]
    v_mfma_f32_16x16x32_bf16 v[140:143], a[76:79], a[12:15], v[140:143]
    ds_read_b128 a[40:43], v10 offset:37632
    v_mfma_f32_16x16x32_bf16 v[156:159], a[76:79], a[16:19], v[156:159]
    s_waitcnt lgkmcnt(6)
    v_mfma_f32_16x16x32_bf16 v[48:51], a[80:83], a[44:47], v[48:51]
    ds_read_b64_tr_b16 a[76:77], v17 offset:4096
    v_mfma_f32_16x16x32_bf16 v[64:67], a[80:83], a[60:63], v[64:67]
    ds_read_b64_tr_b16 a[78:79], v17 offset:4352
    v_mfma_f32_16x16x32_bf16 v[80:83], a[80:83], a[64:67], v[80:83]
    s_add_u32 m0, s34, 0
    s_add_u32 s36, s29, 2621440
    v_mfma_f32_16x16x32_bf16 v[96:99], a[80:83], a[0:3], v[96:99]
    s_waitcnt lgkmcnt(6)
    v_mfma_f32_16x16x32_bf16 v[112:115], a[80:83], a[4:7], v[112:115]
    buffer_load_dwordx4 v12, s[12:15], s36 offen offset:0 lds
    v_mfma_f32_16x16x32_bf16 v[128:131], a[80:83], a[8:11], v[128:131]
    v_mfma_f32_16x16x32_bf16 v[144:147], a[80:83], a[12:15], v[144:147]
    buffer_load_dwordx4 v13, s[12:15], s36 offen offset:1024 lds
    v_mfma_f32_16x16x32_bf16 v[160:163], a[80:83], a[16:19], v[160:163]
    v_mfma_f32_16x16x32_bf16 v[52:55], a[84:87], a[44:47], v[52:55]
    ds_read_b64_tr_b16 a[80:81], v18 offset:4096
    v_mfma_f32_16x16x32_bf16 v[68:71], a[84:87], a[60:63], v[68:71]
    ds_read_b64_tr_b16 a[82:83], v18 offset:4352
    v_mfma_f32_16x16x32_bf16 v[84:87], a[84:87], a[64:67], v[84:87]
    buffer_load_dwordx4 v14, s[12:15], s36 offen offset:2048 lds
    v_mfma_f32_16x16x32_bf16 v[100:103], a[84:87], a[0:3], v[100:103]
    v_mfma_f32_16x16x32_bf16 v[116:119], a[84:87], a[4:7], v[116:119]
    buffer_load_dwordx4 v15, s[12:15], s36 offen offset:3072 lds
    v_mfma_f32_16x16x32_bf16 v[132:135], a[84:87], a[8:11], v[132:135]
    v_mfma_f32_16x16x32_bf16 v[148:151], a[84:87], a[12:15], v[148:151]
    v_mfma_f32_16x16x32_bf16 v[164:167], a[84:87], a[16:19], v[164:167]
    s_waitcnt lgkmcnt(6)
    v_mfma_f32_16x16x32_bf16 v[40:43], a[72:75], a[60:63], v[40:43]
    ds_read_b64_tr_b16 a[84:85], v19 offset:4096
    v_mfma_f32_16x16x32_bf16 v[56:59], a[72:75], a[64:67], v[56:59]
    ds_read_b64_tr_b16 a[86:87], v19 offset:4352
    v_mfma_f32_16x16x32_bf16 v[72:75], a[72:75], a[0:3], v[72:75]
    v_mfma_f32_16x16x32_bf16 v[88:91], a[72:75], a[4:7], v[88:91]
    v_mfma_f32_16x16x32_bf16 v[104:107], a[72:75], a[8:11], v[104:107]
    v_mfma_f32_16x16x32_bf16 v[120:123], a[72:75], a[12:15], v[120:123]
    v_mfma_f32_16x16x32_bf16 v[136:139], a[72:75], a[16:19], v[136:139]
    v_mfma_f32_16x16x32_bf16 v[152:155], a[72:75], a[20:23], v[152:155]
    s_waitcnt lgkmcnt(4)
    v_mfma_f32_16x16x32_bf16 v[44:47], a[76:79], a[60:63], v[44:47]
    s_waitcnt vmcnt(12)
    v_mfma_f32_16x16x32_bf16 v[60:63], a[76:79], a[64:67], v[60:63]
    ds_read_b64_tr_b16 a[72:73], v16 offset:8192
    v_mfma_f32_16x16x32_bf16 v[76:79], a[76:79], a[0:3], v[76:79]
    ds_read_b64_tr_b16 a[74:75], v16 offset:8448
    v_mfma_f32_16x16x32_bf16 v[92:95], a[76:79], a[4:7], v[92:95]
    v_mfma_f32_16x16x32_bf16 v[108:111], a[76:79], a[8:11], v[108:111]
    ds_read_b128 a[44:47], v10 offset:37888
    v_mfma_f32_16x16x32_bf16 v[124:127], a[76:79], a[12:15], v[124:127]
    v_mfma_f32_16x16x32_bf16 v[140:143], a[76:79], a[16:19], v[140:143]
    ds_read_b128 a[48:51], v10 offset:38144
    v_mfma_f32_16x16x32_bf16 v[156:159], a[76:79], a[20:23], v[156:159]
    s_waitcnt lgkmcnt(6)
    v_mfma_f32_16x16x32_bf16 v[48:51], a[80:83], a[60:63], v[48:51]
    ds_read_b64_tr_b16 a[76:77], v17 offset:8192
    v_mfma_f32_16x16x32_bf16 v[64:67], a[80:83], a[64:67], v[64:67]
    ds_read_b64_tr_b16 a[78:79], v17 offset:8448
    v_mfma_f32_16x16x32_bf16 v[80:83], a[80:83], a[0:3], v[80:83]
    s_add_u32 m0, s34, 4096
    s_add_u32 s36, s29, 3670016
    v_mfma_f32_16x16x32_bf16 v[96:99], a[80:83], a[4:7], v[96:99]
    s_waitcnt lgkmcnt(6)
    v_mfma_f32_16x16x32_bf16 v[112:115], a[80:83], a[8:11], v[112:115]
    buffer_load_dwordx4 v12, s[12:15], s36 offen offset:0 lds
    v_mfma_f32_16x16x32_bf16 v[128:131], a[80:83], a[12:15], v[128:131]
    v_mfma_f32_16x16x32_bf16 v[144:147], a[80:83], a[16:19], v[144:147]
    buffer_load_dwordx4 v13, s[12:15], s36 offen offset:1024 lds
    v_mfma_f32_16x16x32_bf16 v[160:163], a[80:83], a[20:23], v[160:163]
    v_mfma_f32_16x16x32_bf16 v[52:55], a[84:87], a[60:63], v[52:55]
    ds_read_b64_tr_b16 a[80:81], v18 offset:8192
    v_mfma_f32_16x16x32_bf16 v[68:71], a[84:87], a[64:67], v[68:71]
    ds_read_b64_tr_b16 a[82:83], v18 offset:8448
    v_mfma_f32_16x16x32_bf16 v[84:87], a[84:87], a[0:3], v[84:87]
    buffer_load_dwordx4 v14, s[12:15], s36 offen offset:2048 lds
    v_mfma_f32_16x16x32_bf16 v[100:103], a[84:87], a[4:7], v[100:103]
    v_mfma_f32_16x16x32_bf16 v[116:119], a[84:87], a[8:11], v[116:119]
    buffer_load_dwordx4 v15, s[12:15], s36 offen offset:3072 lds
    v_mfma_f32_16x16x32_bf16 v[132:135], a[84:87], a[12:15], v[132:135]
    v_mfma_f32_16x16x32_bf16 v[148:151], a[84:87], a[16:19], v[148:151]
    v_mfma_f32_16x16x32_bf16 v[164:167], a[84:87], a[20:23], v[164:167]
    s_waitcnt lgkmcnt(6)
    v_mfma_f32_16x16x32_bf16 v[40:43], a[72:75], a[64:67], v[40:43]
    ds_read_b64_tr_b16 a[84:85], v19 offset:8192
    v_mfma_f32_16x16x32_bf16 v[56:59], a[72:75], a[0:3], v[56:59]
    ds_read_b64_tr_b16 a[86:87], v19 offset:8448
    v_mfma_f32_16x16x32_bf16 v[72:75], a[72:75], a[4:7], v[72:75]
    v_mfma_f32_16x16x32_bf16 v[88:91], a[72:75], a[8:11], v[88:91]
    v_mfma_f32_16x16x32_bf16 v[104:107], a[72:75], a[12:15], v[104:107]
    v_mfma_f32_16x16x32_bf16 v[120:123], a[72:75], a[16:19], v[120:123]
    v_mfma_f32_16x16x32_bf16 v[136:139], a[72:75], a[20:23], v[136:139]
    v_mfma_f32_16x16x32_bf16 v[152:155], a[72:75], a[24:27], v[152:155]
    s_waitcnt lgkmcnt(4)
    v_mfma_f32_16x16x32_bf16 v[44:47], a[76:79], a[64:67], v[44:47]
    s_waitcnt vmcnt(12)
    v_mfma_f32_16x16x32_bf16 v[60:63], a[76:79], a[0:3], v[60:63]
    ds_read_b64_tr_b16 a[72:73], v16 offset:12288
    v_mfma_f32_16x16x32_bf16 v[76:79], a[76:79], a[4:7], v[76:79]
    ds_read_b64_tr_b16 a[74:75], v16 offset:12544
    v_mfma_f32_16x16x32_bf16 v[92:95], a[76:79], a[8:11], v[92:95]
    v_mfma_f32_16x16x32_bf16 v[108:111], a[76:79], a[12:15], v[108:111]
    ds_read_b128 a[52:55], v10 offset:38400
    v_mfma_f32_16x16x32_bf16 v[124:127], a[76:79], a[16:19], v[124:127]
    v_mfma_f32_16x16x32_bf16 v[140:143], a[76:79], a[20:23], v[140:143]
    ds_read_b128 a[56:59], v10 offset:38656
    v_mfma_f32_16x16x32_bf16 v[156:159], a[76:79], a[24:27], v[156:159]
    s_waitcnt lgkmcnt(6)
    v_mfma_f32_16x16x32_bf16 v[48:51], a[80:83], a[64:67], v[48:51]
    ds_read_b64_tr_b16 a[76:77], v17 offset:12288
    v_mfma_f32_16x16x32_bf16 v[64:67], a[80:83], a[0:3], v[64:67]
    ds_read_b64_tr_b16 a[78:79], v17 offset:12544
    v_mfma_f32_16x16x32_bf16 v[80:83], a[80:83], a[4:7], v[80:83]
    s_add_u32 m0, s34, 8192
    s_add_u32 s36, s29, 4718592
    v_mfma_f32_16x16x32_bf16 v[96:99], a[80:83], a[8:11], v[96:99]
    s_waitcnt lgkmcnt(6)
    v_mfma_f32_16x16x32_bf16 v[112:115], a[80:83], a[12:15], v[112:115]
    buffer_load_dwordx4 v12, s[12:15], s36 offen offset:0 lds
    v_mfma_f32_16x16x32_bf16 v[128:131], a[80:83], a[16:19], v[128:131]
    v_mfma_f32_16x16x32_bf16 v[144:147], a[80:83], a[20:23], v[144:147]
    buffer_load_dwordx4 v13, s[12:15], s36 offen offset:1024 lds
    v_mfma_f32_16x16x32_bf16 v[160:163], a[80:83], a[24:27], v[160:163]
    v_mfma_f32_16x16x32_bf16 v[52:55], a[84:87], a[64:67], v[52:55]
    ds_read_b64_tr_b16 a[80:81], v18 offset:12288
    v_mfma_f32_16x16x32_bf16 v[68:71], a[84:87], a[0:3], v[68:71]
    ds_read_b64_tr_b16 a[82:83], v18 offset:12544
    v_mfma_f32_16x16x32_bf16 v[84:87], a[84:87], a[4:7], v[84:87]
    buffer_load_dwordx4 v14, s[12:15], s36 offen offset:2048 lds
    v_mfma_f32_16x16x32_bf16 v[100:103], a[84:87], a[8:11], v[100:103]
    v_mfma_f32_16x16x32_bf16 v[116:119], a[84:87], a[12:15], v[116:119]
    buffer_load_dwordx4 v15, s[12:15], s36 offen offset:3072 lds
    v_mfma_f32_16x16x32_bf16 v[132:135], a[84:87], a[16:19], v[132:135]
    v_mfma_f32_16x16x32_bf16 v[148:151], a[84:87], a[20:23], v[148:151]
    v_mfma_f32_16x16x32_bf16 v[164:167], a[84:87], a[24:27], v[164:167]
    s_waitcnt lgkmcnt(6)
    v_mfma_f32_16x16x32_bf16 v[40:43], a[72:75], a[28:31], v[40:43]
    ds_read_b64_tr_b16 a[84:85], v19 offset:12288
    v_mfma_f32_16x16x32_bf16 v[56:59], a[72:75], a[32:35], v[56:59]
    ds_read_b64_tr_b16 a[86:87], v19 offset:12544
    v_mfma_f32_16x16x32_bf16 v[72:75], a[72:75], a[36:39], v[72:75]
    v_mfma_f32_16x16x32_bf16 v[88:91], a[72:75], a[40:43], v[88:91]
    v_mfma_f32_16x16x32_bf16 v[104:107], a[72:75], a[44:47], v[104:107]
    v_mfma_f32_16x16x32_bf16 v[120:123], a[72:75], a[48:51], v[120:123]
    s_waitcnt lgkmcnt(7)
    v_mfma_f32_16x16x32_bf16 v[136:139], a[72:75], a[52:55], v[136:139]
    s_waitcnt lgkmcnt(6)
    v_mfma_f32_16x16x32_bf16 v[152:155], a[72:75], a[56:59], v[152:155]
    s_waitcnt lgkmcnt(4)
    v_mfma_f32_16x16x32_bf16 v[44:47], a[76:79], a[28:31], v[44:47]
    s_waitcnt vmcnt(12)
    v_mfma_f32_16x16x32_bf16 v[60:63], a[76:79], a[32:35], v[60:63]
    ds_read_b64_tr_b16 a[72:73], v16 offset:16384
    v_mfma_f32_16x16x32_bf16 v[76:79], a[76:79], a[36:39], v[76:79]
    ds_read_b64_tr_b16 a[74:75], v16 offset:16640
    v_mfma_f32_16x16x32_bf16 v[92:95], a[76:79], a[40:43], v[92:95]
    v_mfma_f32_16x16x32_bf16 v[108:111], a[76:79], a[44:47], v[108:111]
    ds_read_b128 a[0:3], v11 offset:38912
    v_mfma_f32_16x16x32_bf16 v[124:127], a[76:79], a[48:51], v[124:127]
    v_mfma_f32_16x16x32_bf16 v[140:143], a[76:79], a[52:55], v[140:143]
    ds_read_b128 a[4:7], v11 offset:39168
    v_mfma_f32_16x16x32_bf16 v[156:159], a[76:79], a[56:59], v[156:159]
    s_waitcnt lgkmcnt(6)
    v_mfma_f32_16x16x32_bf16 v[48:51], a[80:83], a[28:31], v[48:51]
    ds_read_b64_tr_b16 a[76:77], v17 offset:16384
    v_mfma_f32_16x16x32_bf16 v[64:67], a[80:83], a[32:35], v[64:67]
    ds_read_b64_tr_b16 a[78:79], v17 offset:16640
    v_mfma_f32_16x16x32_bf16 v[80:83], a[80:83], a[36:39], v[80:83]
    s_add_u32 m0, s34, 12288
    s_add_u32 s36, s29, 5767168
    v_mfma_f32_16x16x32_bf16 v[96:99], a[80:83], a[40:43], v[96:99]
    s_waitcnt lgkmcnt(6)
    v_mfma_f32_16x16x32_bf16 v[112:115], a[80:83], a[44:47], v[112:115]
    buffer_load_dwordx4 v12, s[12:15], s36 offen offset:0 lds
    v_mfma_f32_16x16x32_bf16 v[128:131], a[80:83], a[48:51], v[128:131]
    v_mfma_f32_16x16x32_bf16 v[144:147], a[80:83], a[52:55], v[144:147]
    buffer_load_dwordx4 v13, s[12:15], s36 offen offset:1024 lds
    v_mfma_f32_16x16x32_bf16 v[160:163], a[80:83], a[56:59], v[160:163]
    v_mfma_f32_16x16x32_bf16 v[52:55], a[84:87], a[28:31], v[52:55]
    ds_read_b64_tr_b16 a[80:81], v18 offset:16384
    v_mfma_f32_16x16x32_bf16 v[68:71], a[84:87], a[32:35], v[68:71]
    ds_read_b64_tr_b16 a[82:83], v18 offset:16640
    v_mfma_f32_16x16x32_bf16 v[84:87], a[84:87], a[36:39], v[84:87]
    buffer_load_dwordx4 v14, s[12:15], s36 offen offset:2048 lds
    v_mfma_f32_16x16x32_bf16 v[100:103], a[84:87], a[40:43], v[100:103]
    v_mfma_f32_16x16x32_bf16 v[116:119], a[84:87], a[44:47], v[116:119]
    buffer_load_dwordx4 v15, s[12:15], s36 offen offset:3072 lds
    v_mfma_f32_16x16x32_bf16 v[132:135], a[84:87], a[48:51], v[132:135]
    v_mfma_f32_16x16x32_bf16 v[148:151], a[84:87], a[52:55], v[148:151]
    v_mfma_f32_16x16x32_bf16 v[164:167], a[84:87], a[56:59], v[164:167]
    s_waitcnt lgkmcnt(6)
    v_mfma_f32_16x16x32_bf16 v[40:43], a[72:75], a[32:35], v[40:43]
    ds_read_b64_tr_b16 a[84:85], v19 offset:16384
    v_mfma_f32_16x16x32_bf16 v[56:59], a[72:75], a[36:39], v[56:59]
    ds_read_b64_tr_b16 a[86:87], v19 offset:16640
    v_mfma_f32_16x16x32_bf16 v[72:75], a[72:75], a[40:43], v[72:75]
    v_mfma_f32_16x16x32_bf16 v[88:91], a[72:75], a[44:47], v[88:91]
    v_mfma_f32_16x16x32_bf16 v[104:107], a[72:75], a[48:51], v[104:107]
    v_mfma_f32_16x16x32_bf16 v[120:123], a[72:75], a[52:55], v[120:123]
    v_mfma_f32_16x16x32_bf16 v[136:139], a[72:75], a[56:59], v[136:139]
    s_waitcnt lgkmcnt(7)
    v_mfma_f32_16x16x32_bf16 v[152:155], a[72:75], a[0:3], v[152:155]
    s_waitcnt lgkmcnt(4)
    v_mfma_f32_16x16x32_bf16 v[44:47], a[76:79], a[32:35], v[44:47]
    s_waitcnt vmcnt(12)
    v_mfma_f32_16x16x32_bf16 v[60:63], a[76:79], a[36:39], v[60:63]
    ds_read_b64_tr_b16 a[72:73], v16 offset:0
    v_mfma_f32_16x16x32_bf16 v[76:79], a[76:79], a[40:43], v[76:79]
    ds_read_b64_tr_b16 a[74:75], v16 offset:256
    v_mfma_f32_16x16x32_bf16 v[92:95], a[76:79], a[44:47], v[92:95]
    v_mfma_f32_16x16x32_bf16 v[108:111], a[76:79], a[48:51], v[108:111]
    ds_read_b128 a[8:11], v11 offset:39424
    v_mfma_f32_16x16x32_bf16 v[124:127], a[76:79], a[52:55], v[124:127]
    v_mfma_f32_16x16x32_bf16 v[140:143], a[76:79], a[56:59], v[140:143]
    ds_read_b128 a[12:15], v11 offset:39680
    v_mfma_f32_16x16x32_bf16 v[156:159], a[76:79], a[0:3], v[156:159]
    s_waitcnt lgkmcnt(6)
    v_mfma_f32_16x16x32_bf16 v[48:51], a[80:83], a[32:35], v[48:51]
    ds_read_b64_tr_b16 a[76:77], v17 offset:0
    v_mfma_f32_16x16x32_bf16 v[64:67], a[80:83], a[36:39], v[64:67]
    ds_read_b64_tr_b16 a[78:79], v17 offset:256
    v_mfma_f32_16x16x32_bf16 v[80:83], a[80:83], a[40:43], v[80:83]
    s_add_u32 m0, s34, 16384
    s_add_u32 s36, s29, 6815744
    v_mfma_f32_16x16x32_bf16 v[96:99], a[80:83], a[44:47], v[96:99]
    s_waitcnt lgkmcnt(6)
    v_mfma_f32_16x16x32_bf16 v[112:115], a[80:83], a[48:51], v[112:115]
    buffer_load_dwordx4 v12, s[12:15], s36 offen offset:0 lds
    v_mfma_f32_16x16x32_bf16 v[128:131], a[80:83], a[52:55], v[128:131]
    v_mfma_f32_16x16x32_bf16 v[144:147], a[80:83], a[56:59], v[144:147]
    buffer_load_dwordx4 v13, s[12:15], s36 offen offset:1024 lds
    v_mfma_f32_16x16x32_bf16 v[160:163], a[80:83], a[0:3], v[160:163]
    v_mfma_f32_16x16x32_bf16 v[52:55], a[84:87], a[32:35], v[52:55]
    ds_read_b64_tr_b16 a[80:81], v18 offset:0
    v_mfma_f32_16x16x32_bf16 v[68:71], a[84:87], a[36:39], v[68:71]
    ds_read_b64_tr_b16 a[82:83], v18 offset:256
    v_mfma_f32_16x16x32_bf16 v[84:87], a[84:87], a[40:43], v[84:87]
    buffer_load_dwordx4 v14, s[12:15], s36 offen offset:2048 lds
    v_mfma_f32_16x16x32_bf16 v[100:103], a[84:87], a[44:47], v[100:103]
    v_mfma_f32_16x16x32_bf16 v[116:119], a[84:87], a[48:51], v[116:119]
    buffer_load_dwordx4 v15, s[12:15], s36 offen offset:3072 lds
    v_mfma_f32_16x16x32_bf16 v[132:135], a[84:87], a[52:55], v[132:135]
    v_mfma_f32_16x16x32_bf16 v[148:151], a[84:87], a[56:59], v[148:151]
    v_mfma_f32_16x16x32_bf16 v[164:167], a[84:87], a[0:3], v[164:167]
    s_waitcnt lgkmcnt(6)
    v_mfma_f32_16x16x32_bf16 v[40:43], a[72:75], a[36:39], v[40:43]
    ds_read_b64_tr_b16 a[84:85], v19 offset:0
    v_mfma_f32_16x16x32_bf16 v[56:59], a[72:75], a[40:43], v[56:59]
    ds_read_b64_tr_b16 a[86:87], v19 offset:256
    v_mfma_f32_16x16x32_bf16 v[72:75], a[72:75], a[44:47], v[72:75]
    v_mfma_f32_16x16x32_bf16 v[88:91], a[72:75], a[48:51], v[88:91]
    v_mfma_f32_16x16x32_bf16 v[104:107], a[72:75], a[52:55], v[104:107]
    v_mfma_f32_16x16x32_bf16 v[120:123], a[72:75], a[56:59], v[120:123]
    v_mfma_f32_16x16x32_bf16 v[136:139], a[72:75], a[0:3], v[136:139]
    v_mfma_f32_16x16x32_bf16 v[152:155], a[72:75], a[4:7], v[152:155]
    s_waitcnt lgkmcnt(4)
    v_mfma_f32_16x16x32_bf16 v[44:47], a[76:79], a[36:39], v[44:47]
    s_waitcnt vmcnt(12)
    v_mfma_f32_16x16x32_bf16 v[60:63], a[76:79], a[40:43], v[60:63]
    ds_read_b64_tr_b16 a[72:73], v16 offset:4096
    v_mfma_f32_16x16x32_bf16 v[76:79], a[76:79], a[44:47], v[76:79]
    ds_read_b64_tr_b16 a[74:75], v16 offset:4352
    v_mfma_f32_16x16x32_bf16 v[92:95], a[76:79], a[48:51], v[92:95]
    v_mfma_f32_16x16x32_bf16 v[108:111], a[76:79], a[52:55], v[108:111]
    ds_read_b128 a[16:19], v11 offset:39936
    v_mfma_f32_16x16x32_bf16 v[124:127], a[76:79], a[56:59], v[124:127]
    v_mfma_f32_16x16x32_bf16 v[140:143], a[76:79], a[0:3], v[140:143]
    ds_read_b128 a[20:23], v11 offset:40192
    v_mfma_f32_16x16x32_bf16 v[156:159], a[76:79], a[4:7], v[156:159]
    s_waitcnt lgkmcnt(6)
    v_mfma_f32_16x16x32_bf16 v[48:51], a[80:83], a[36:39], v[48:51]
    ds_read_b64_tr_b16 a[76:77], v17 offset:4096
    v_mfma_f32_16x16x32_bf16 v[64:67], a[80:83], a[40:43], v[64:67]
    ds_read_b64_tr_b16 a[78:79], v17 offset:4352
    v_mfma_f32_16x16x32_bf16 v[80:83], a[80:83], a[44:47], v[80:83]
    v_mfma_f32_16x16x32_bf16 v[96:99], a[80:83], a[48:51], v[96:99]
    v_mfma_f32_16x16x32_bf16 v[112:115], a[80:83], a[52:55], v[112:115]
    v_mfma_f32_16x16x32_bf16 v[128:131], a[80:83], a[56:59], v[128:131]
    v_mfma_f32_16x16x32_bf16 v[144:147], a[80:83], a[0:3], v[144:147]
    v_mfma_f32_16x16x32_bf16 v[160:163], a[80:83], a[4:7], v[160:163]
    s_waitcnt lgkmcnt(6)
    v_mfma_f32_16x16x32_bf16 v[52:55], a[84:87], a[36:39], v[52:55]
    ds_read_b64_tr_b16 a[80:81], v18 offset:4096
    v_mfma_f32_16x16x32_bf16 v[68:71], a[84:87], a[40:43], v[68:71]
    ds_read_b64_tr_b16 a[82:83], v18 offset:4352
    v_mfma_f32_16x16x32_bf16 v[84:87], a[84:87], a[44:47], v[84:87]
    v_mfma_f32_16x16x32_bf16 v[100:103], a[84:87], a[48:51], v[100:103]
    v_mfma_f32_16x16x32_bf16 v[116:119], a[84:87], a[52:55], v[116:119]
    v_mfma_f32_16x16x32_bf16 v[132:135], a[84:87], a[56:59], v[132:135]
    v_mfma_f32_16x16x32_bf16 v[148:151], a[84:87], a[0:3], v[148:151]
    v_mfma_f32_16x16x32_bf16 v[164:167], a[84:87], a[4:7], v[164:167]
    s_waitcnt lgkmcnt(0)
    s_barrier
    v_mfma_f32_16x16x32_bf16 v[40:43], a[72:75], a[40:43], v[40:43]
    ds_read_b64_tr_b16 a[84:85], v19 offset:4096
    v_mfma_f32_16x16x32_bf16 v[56:59], a[72:75], a[44:47], v[56:59]
    ds_read_b64_tr_b16 a[86:87], v19 offset:4352
    v_mfma_f32_16x16x32_bf16 v[72:75], a[72:75], a[48:51], v[72:75]
    v_lshlrev_b32 v20, 4, v2
    v_mfma_f32_16x16x32_bf16 v[88:91], a[72:75], a[52:55], v[88:91]
    v_add_u32 v21, 0x10000, v20
    v_mfma_f32_16x16x32_bf16 v[104:107], a[72:75], a[56:59], v[104:107]
    s_mul_i32 s41, s28, 24576
    v_mfma_f32_16x16x32_bf16 v[120:123], a[72:75], a[0:3], v[120:123]
    v_add_u32 v22, s41, v20
    v_mfma_f32_16x16x32_bf16 v[136:139], a[72:75], a[4:7], v[136:139]
    v_mov_b32 v24, 0xc0135761
    v_mfma_f32_16x16x32_bf16 v[152:155], a[72:75], a[8:11], v[152:155]
    v_mov_b32 v25, 0xc0135761
    v_mfma_f32_16x16x32_bf16 v[44:47], a[76:79], a[40:43], v[44:47]
    s_waitcnt vmcnt(8)
    v_mfma_f32_16x16x32_bf16 v[60:63], a[76:79], a[44:47], v[60:63]
    ds_read_b64_tr_b16 a[72:73], v16 offset:8192
    v_mfma_f32_16x16x32_bf16 v[76:79], a[76:79], a[48:51], v[76:79]
    ds_read_b64_tr_b16 a[74:75], v16 offset:8448
    v_mfma_f32_16x16x32_bf16 v[92:95], a[76:79], a[52:55], v[92:95]
    v_mov_b32 v26, 0xbdd2d3e8
    v_mfma_f32_16x16x32_bf16 v[108:111], a[76:79], a[56:59], v[108:111]
    v_mov_b32 v27, 0xbdd2d3e8
    v_mfma_f32_16x16x32_bf16 v[124:127], a[76:79], a[0:3], v[124:127]
    v_mov_b32 v28, 1.0
    v_mfma_f32_16x16x32_bf16 v[140:143], a[76:79], a[4:7], v[140:143]
    v_mov_b32 v29, 1.0
    v_mfma_f32_16x16x32_bf16 v[156:159], a[76:79], a[8:11], v[156:159]
    v_and_b32 v30, 15, v2
    v_mfma_f32_16x16x32_bf16 v[48:51], a[80:83], a[40:43], v[48:51]
    ds_read_b64_tr_b16 a[76:77], v17 offset:8192
    v_mfma_f32_16x16x32_bf16 v[64:67], a[80:83], a[44:47], v[64:67]
    ds_read_b64_tr_b16 a[78:79], v17 offset:8448
    v_mfma_f32_16x16x32_bf16 v[80:83], a[80:83], a[48:51], v[80:83]
    v_lshrrev_b32 v31, 4, v2
    v_mfma_f32_16x16x32_bf16 v[96:99], a[80:83], a[52:55], v[96:99]
    v_and_b32 v32, 7, v30
    v_mfma_f32_16x16x32_bf16 v[112:115], a[80:83], a[56:59], v[112:115]
    v_mfma_f32_16x16x32_bf16 v[128:131], a[80:83], a[0:3], v[128:131]
    v_mfma_f32_16x16x32_bf16 v[144:147], a[80:83], a[4:7], v[144:147]
    v_mfma_f32_16x16x32_bf16 v[160:163], a[80:83], a[8:11], v[160:163]
    s_waitcnt lgkmcnt(4)
    v_mfma_f32_16x16x32_bf16 v[52:55], a[84:87], a[40:43], v[52:55]
    ds_read_b64_tr_b16 a[80:81], v18 offset:8192
    v_mfma_f32_16x16x32_bf16 v[68:71], a[84:87], a[44:47], v[68:71]
    ds_read_b64_tr_b16 a[82:83], v18 offset:8448
    v_mfma_f32_16x16x32_bf16 v[84:87], a[84:87], a[48:51], v[84:87]
    v_mfma_f32_16x16x32_bf16 v[100:103], a[84:87], a[52:55], v[100:103]
    v_mfma_f32_16x16x32_bf16 v[116:119], a[84:87], a[56:59], v[116:119]
    v_mfma_f32_16x16x32_bf16 v[132:135], a[84:87], a[0:3], v[132:135]
    v_mfma_f32_16x16x32_bf16 v[148:151], a[84:87], a[4:7], v[148:151]
    v_mfma_f32_16x16x32_bf16 v[164:167], a[84:87], a[8:11], v[164:167]
    s_waitcnt lgkmcnt(4)
    v_mfma_f32_16x16x32_bf16 v[40:43], a[72:75], a[44:47], v[40:43]
    ds_read_b64_tr_b16 a[84:85], v19 offset:8192
    v_mfma_f32_16x16x32_bf16 v[56:59], a[72:75], a[48:51], v[56:59]
    ds_read_b64_tr_b16 a[86:87], v19 offset:8448
    v_mfma_f32_16x16x32_bf16 v[72:75], a[72:75], a[52:55], v[72:75]
    v_lshlrev_b32 v32, 1, v32
    v_mfma_f32_16x16x32_bf16 v[88:91], a[72:75], a[56:59], v[88:91]
    v_mul_u32_u24 v33, 128, v30
    v_mfma_f32_16x16x32_bf16 v[104:107], a[72:75], a[0:3], v[104:107]
    v_add_u32 v33, s41, v33
    v_mfma_f32_16x16x32_bf16 v[120:123], a[72:75], a[4:7], v[120:123]
    v_add_u32 v34, 0, v31
    v_mfma_f32_16x16x32_bf16 v[136:139], a[72:75], a[8:11], v[136:139]
    v_xor_b32 v34, v34, v32
    v_mfma_f32_16x16x32_bf16 v[152:155], a[72:75], a[12:15], v[152:155]
    v_lshl_add_u32 v4, v34, 3, v33
    s_waitcnt lgkmcnt(4)
    v_mfma_f32_16x16x32_bf16 v[44:47], a[76:79], a[44:47], v[44:47]
    s_waitcnt vmcnt(4)
    v_mfma_f32_16x16x32_bf16 v[60:63], a[76:79], a[48:51], v[60:63]
    ds_read_b64_tr_b16 a[72:73], v16 offset:12288
    v_mfma_f32_16x16x32_bf16 v[76:79], a[76:79], a[52:55], v[76:79]
    ds_read_b64_tr_b16 a[74:75], v16 offset:12544
    v_mfma_f32_16x16x32_bf16 v[92:95], a[76:79], a[56:59], v[92:95]
    v_add_u32 v34, 4, v31
    v_mfma_f32_16x16x32_bf16 v[108:111], a[76:79], a[0:3], v[108:111]
    v_xor_b32 v34, v34, v32
    v_mfma_f32_16x16x32_bf16 v[124:127], a[76:79], a[4:7], v[124:127]
    v_lshl_add_u32 v5, v34, 3, v33
    v_mfma_f32_16x16x32_bf16 v[140:143], a[76:79], a[8:11], v[140:143]
    v_add_u32 v34, 8, v31
    v_mfma_f32_16x16x32_bf16 v[156:159], a[76:79], a[12:15], v[156:159]
    v_xor_b32 v34, v34, v32
    s_waitcnt lgkmcnt(4)
    v_mfma_f32_16x16x32_bf16 v[48:51], a[80:83], a[44:47], v[48:51]
    ds_read_b64_tr_b16 a[76:77], v17 offset:12288
    v_mfma_f32_16x16x32_bf16 v[64:67], a[80:83], a[48:51], v[64:67]
    ds_read_b64_tr_b16 a[78:79], v17 offset:12544
    v_mfma_f32_16x16x32_bf16 v[80:83], a[80:83], a[52:55], v[80:83]
    v_lshl_add_u32 v6, v34, 3, v33
    v_mfma_f32_16x16x32_bf16 v[96:99], a[80:83], a[56:59], v[96:99]
    v_mfma_f32_16x16x32_bf16 v[112:115], a[80:83], a[0:3], v[112:115]
    v_mfma_f32_16x16x32_bf16 v[128:131], a[80:83], a[4:7], v[128:131]
    v_mfma_f32_16x16x32_bf16 v[144:147], a[80:83], a[8:11], v[144:147]
    v_mfma_f32_16x16x32_bf16 v[160:163], a[80:83], a[12:15], v[160:163]
    s_waitcnt lgkmcnt(4)
    v_mfma_f32_16x16x32_bf16 v[52:55], a[84:87], a[44:47], v[52:55]
    ds_read_b64_tr_b16 a[80:81], v18 offset:12288
    v_mfma_f32_16x16x32_bf16 v[68:71], a[84:87], a[48:51], v[68:71]
    ds_read_b64_tr_b16 a[82:83], v18 offset:12544
    v_mfma_f32_16x16x32_bf16 v[84:87], a[84:87], a[52:55], v[84:87]
    v_mfma_f32_16x16x32_bf16 v[100:103], a[84:87], a[56:59], v[100:103]
    v_mfma_f32_16x16x32_bf16 v[116:119], a[84:87], a[0:3], v[116:119]
    v_mfma_f32_16x16x32_bf16 v[132:135], a[84:87], a[4:7], v[132:135]
    v_mfma_f32_16x16x32_bf16 v[148:151], a[84:87], a[8:11], v[148:151]
    v_mfma_f32_16x16x32_bf16 v[164:167], a[84:87], a[12:15], v[164:167]
    s_waitcnt lgkmcnt(4)
    v_mfma_f32_16x16x32_bf16 v[40:43], a[72:75], a[48:51], v[40:43]
    ds_read_b64_tr_b16 a[84:85], v19 offset:12288
    v_mfma_f32_16x16x32_bf16 v[56:59], a[72:75], a[52:55], v[56:59]
    ds_read_b64_tr_b16 a[86:87], v19 offset:12544
    v_mfma_f32_16x16x32_bf16 v[72:75], a[72:75], a[56:59], v[72:75]
    v_add_u32 v34, 12, v31
    v_mfma_f32_16x16x32_bf16 v[88:91], a[72:75], a[0:3], v[88:91]
    v_xor_b32 v34, v34, v32
    v_mfma_f32_16x16x32_bf16 v[104:107], a[72:75], a[4:7], v[104:107]
    v_lshl_add_u32 v7, v34, 3, v33
    v_mfma_f32_16x16x32_bf16 v[120:123], a[72:75], a[8:11], v[120:123]
    v_lshrrev_b32 v30, 3, v2
    v_mfma_f32_16x16x32_bf16 v[136:139], a[72:75], a[12:15], v[136:139]
    v_and_b32 v31, 7, v2
    v_mfma_f32_16x16x32_bf16 v[152:155], a[72:75], a[16:19], v[152:155]
    v_xor_b32 v31, v31, v30
    s_waitcnt lgkmcnt(4)
    v_mfma_f32_16x16x32_bf16 v[44:47], a[76:79], a[48:51], v[44:47]
    s_waitcnt vmcnt(0)
    v_mfma_f32_16x16x32_bf16 v[60:63], a[76:79], a[52:55], v[60:63]
    ds_read_b64_tr_b16 a[72:73], v16 offset:16384
    v_mfma_f32_16x16x32_bf16 v[76:79], a[76:79], a[56:59], v[76:79]
    ds_read_b64_tr_b16 a[74:75], v16 offset:16640
    v_mfma_f32_16x16x32_bf16 v[92:95], a[76:79], a[0:3], v[92:95]
    v_lshlrev_b32 v31, 4, v31
    v_mfma_f32_16x16x32_bf16 v[108:111], a[76:79], a[4:7], v[108:111]
    v_lshl_add_u32 v8, v30, 13, v31
    v_mfma_f32_16x16x32_bf16 v[124:127], a[76:79], a[8:11], v[124:127]
    s_lshl_b32 s42, s28, 1
    v_mfma_f32_16x16x32_bf16 v[140:143], a[76:79], a[12:15], v[140:143]
    s_add_u32 s42, s42, s38
    v_mfma_f32_16x16x32_bf16 v[156:159], a[76:79], a[16:19], v[156:159]
    s_lshl_b32 s42, s42, 10
    s_waitcnt lgkmcnt(4)
    v_mfma_f32_16x16x32_bf16 v[48:51], a[80:83], a[48:51], v[48:51]
    ds_read_b64_tr_b16 a[76:77], v17 offset:16384
    v_mfma_f32_16x16x32_bf16 v[64:67], a[80:83], a[52:55], v[64:67]
    ds_read_b64_tr_b16 a[78:79], v17 offset:16640
    v_mfma_f32_16x16x32_bf16 v[80:83], a[80:83], a[56:59], v[80:83]
    s_add_u32 s42, s42, s39
    v_mfma_f32_16x16x32_bf16 v[96:99], a[80:83], a[0:3], v[96:99]
    v_mfma_f32_16x16x32_bf16 v[112:115], a[80:83], a[4:7], v[112:115]
    v_mfma_f32_16x16x32_bf16 v[128:131], a[80:83], a[8:11], v[128:131]
    v_mfma_f32_16x16x32_bf16 v[144:147], a[80:83], a[12:15], v[144:147]
    v_mfma_f32_16x16x32_bf16 v[160:163], a[80:83], a[16:19], v[160:163]
    s_waitcnt lgkmcnt(4)
    v_mfma_f32_16x16x32_bf16 v[52:55], a[84:87], a[48:51], v[52:55]
    ds_read_b64_tr_b16 a[80:81], v18 offset:16384
    v_mfma_f32_16x16x32_bf16 v[68:71], a[84:87], a[52:55], v[68:71]
    ds_read_b64_tr_b16 a[82:83], v18 offset:16640
    v_mfma_f32_16x16x32_bf16 v[84:87], a[84:87], a[56:59], v[84:87]
    v_mfma_f32_16x16x32_bf16 v[100:103], a[84:87], a[0:3], v[100:103]
    v_mfma_f32_16x16x32_bf16 v[116:119], a[84:87], a[4:7], v[116:119]
    v_mfma_f32_16x16x32_bf16 v[132:135], a[84:87], a[8:11], v[132:135]
    v_mfma_f32_16x16x32_bf16 v[148:151], a[84:87], a[12:15], v[148:151]
    v_mfma_f32_16x16x32_bf16 v[164:167], a[84:87], a[16:19], v[164:167]
    s_cmp_lg_u32 s28, 0
    s_cbranch_scc1 conv1_kernel_red0
    s_waitcnt lgkmcnt(4)
    v_mfma_f32_16x16x32_bf16 v[40:43], a[72:75], a[52:55], v[40:43]
    ds_read_b64_tr_b16 a[84:85], v19 offset:16384
    v_mfma_f32_16x16x32_bf16 v[56:59], a[72:75], a[56:59], v[56:59]
    ds_read_b64_tr_b16 a[86:87], v19 offset:16640
    s_waitcnt lgkmcnt(4)
    v_mfma_f32_16x16x32_bf16 v[44:47], a[76:79], a[52:55], v[44:47]
    v_mfma_f32_16x16x32_bf16 v[60:63], a[76:79], a[56:59], v[60:63]
    s_waitcnt lgkmcnt(2)
    v_mfma_f32_16x16x32_bf16 v[48:51], a[80:83], a[52:55], v[48:51]
    v_mfma_f32_16x16x32_bf16 v[64:67], a[80:83], a[56:59], v[64:67]
    s_waitcnt lgkmcnt(0)
    v_mfma_f32_16x16x32_bf16 v[52:55], a[84:87], a[52:55], v[52:55]
    v_mfma_f32_16x16x32_bf16 v[68:71], a[84:87], a[56:59], v[68:71]
    v_mfma_f32_16x16x32_bf16 v[72:75], a[72:75], a[0:3], v[72:75]
    s_barrier
    v_mfma_f32_16x16x32_bf16 v[88:91], a[72:75], a[4:7], v[88:91]
    v_mfma_f32_16x16x32_bf16 v[76:79], a[76:79], a[0:3], v[76:79]
    v_mfma_f32_16x16x32_bf16 v[92:95], a[76:79], a[4:7], v[92:95]
    v_mfma_f32_16x16x32_bf16 v[80:83], a[80:83], a[0:3], v[80:83]
    v_mfma_f32_16x16x32_bf16 v[96:99], a[80:83], a[4:7], v[96:99]
    v_mfma_f32_16x16x32_bf16 v[84:87], a[84:87], a[0:3], v[84:87]
    v_mfma_f32_16x16x32_bf16 v[100:103], a[84:87], a[4:7], v[100:103]
    v_mfma_f32_16x16x32_bf16 v[104:107], a[72:75], a[8:11], v[104:107]
    ds_write_b128 v20, v[72:75] offset:24576
    v_mfma_f32_16x16x32_bf16 v[120:123], a[72:75], a[12:15], v[120:123]
    ds_write_b128 v20, v[88:91] offset:28672
    v_mfma_f32_16x16x32_bf16 v[108:111], a[76:79], a[8:11], v[108:111]
    ds_write_b128 v20, v[76:79] offset:25600
    v_mfma_f32_16x16x32_bf16 v[124:127], a[76:79], a[12:15], v[124:127]
    ds_write_b128 v20, v[92:95] offset:29696
    v_mfma_f32_16x16x32_bf16 v[112:115], a[80:83], a[8:11], v[112:115]
    ds_write_b128 v20, v[80:83] offset:26624
    v_mfma_f32_16x16x32_bf16 v[128:131], a[80:83], a[12:15], v[128:131]
    ds_write_b128 v20, v[96:99] offset:30720
    v_mfma_f32_16x16x32_bf16 v[116:119], a[84:87], a[8:11], v[116:119]
    ds_write_b128 v20, v[84:87] offset:27648
    v_mfma_f32_16x16x32_bf16 v[132:135], a[84:87], a[12:15], v[132:135]
    ds_write_b128 v20, v[100:103] offset:31744
    v_mfma_f32_16x16x32_bf16 v[136:139], a[72:75], a[16:19], v[136:139]
    ds_write_b128 v20, v[104:107] offset:57344
    v_mfma_f32_16x16x32_bf16 v[152:155], a[72:75], a[20:23], v[152:155]
    ds_write_b128 v20, v[120:123] offset:61440
    v_mfma_f32_16x16x32_bf16 v[140:143], a[76:79], a[16:19], v[140:143]
    ds_write_b128 v20, v[108:111] offset:58368
    v_mfma_f32_16x16x32_bf16 v[156:159], a[76:79], a[20:23], v[156:159]
    ds_write_b128 v20, v[124:127] offset:62464
    v_mfma_f32_16x16x32_bf16 v[144:147], a[80:83], a[16:19], v[144:147]
    ds_write_b128 v20, v[112:115] offset:59392
    v_mfma_f32_16x16x32_bf16 v[160:163], a[80:83], a[20:23], v[160:163]
    ds_write_b128 v20, v[128:131] offset:63488
    v_mfma_f32_16x16x32_bf16 v[148:151], a[84:87], a[16:19], v[148:151]
    ds_write_b128 v20, v[116:119] offset:60416
    v_mfma_f32_16x16x32_bf16 v[164:167], a[84:87], a[20:23], v[164:167]
    ds_write_b128 v20, v[132:135] offset:64512
    s_nop 7
    ds_write_b128 v21, v[136:139] offset:24576
    ds_write_b128 v21, v[152:155] offset:28672
    ds_write_b128 v21, v[140:143] offset:25600
    ds_write_b128 v21, v[156:159] offset:29696
    ds_write_b128 v21, v[144:147] offset:26624
    ds_write_b128 v21, v[160:163] offset:30720
    ds_write_b128 v21, v[148:151] offset:27648
    ds_write_b128 v21, v[164:167] offset:31744
    s_waitcnt lgkmcnt(0)
    s_barrier
    ds_read_b128 v[72:75], v22 offset:0
    ds_read_b128 v[76:79], v22 offset:1024
    ds_read_b128 v[80:83], v22 offset:2048
    ds_read_b128 v[84:87], v22 offset:3072
    ds_read_b128 v[104:107], v22 offset:8192
    ds_read_b128 v[108:111], v22 offset:9216
    ds_read_b128 v[112:115], v22 offset:10240
    ds_read_b128 v[116:119], v22 offset:11264
    ds_read_b128 v[136:139], v22 offset:16384
    ds_read_b128 v[140:143], v22 offset:17408
    ds_read_b128 v[144:147], v22 offset:18432
    ds_read_b128 v[148:151], v22 offset:19456
    ds_read_b128 v[88:91], v22 offset:4096
    ds_read_b128 v[92:95], v22 offset:5120
    ds_read_b128 v[96:99], v22 offset:6144
    ds_read_b128 v[100:103], v22 offset:7168
    ds_read_b128 v[120:123], v22 offset:12288
    ds_read_b128 v[124:127], v22 offset:13312
    ds_read_b128 v[128:131], v22 offset:14336
    ds_read_b128 v[132:135], v22 offset:15360
    ds_read_b128 v[152:155], v22 offset:20480
    ds_read_b128 v[156:159], v22 offset:21504
    ds_read_b128 v[160:163], v22 offset:22528
    ds_read_b128 v[164:167], v22 offset:23552
    s_branch conv1_kernel_redd
conv1_kernel_red0:
    s_cmp_lg_u32 s28, 1
    s_cbranch_scc1 conv1_kernel_red1
    s_waitcnt lgkmcnt(4)
    v_mfma_f32_16x16x32_bf16 v[40:43], a[72:75], a[52:55], v[40:43]
    ds_read_b64_tr_b16 a[84:85], v19 offset:16384
    v_mfma_f32_16x16x32_bf16 v[56:59], a[72:75], a[56:59], v[56:59]
    ds_read_b64_tr_b16 a[86:87], v19 offset:16640
    s_waitcnt lgkmcnt(4)
    v_mfma_f32_16x16x32_bf16 v[44:47], a[76:79], a[52:55], v[44:47]
    v_mfma_f32_16x16x32_bf16 v[60:63], a[76:79], a[56:59], v[60:63]
    s_waitcnt lgkmcnt(2)
    v_mfma_f32_16x16x32_bf16 v[48:51], a[80:83], a[52:55], v[48:51]
    v_mfma_f32_16x16x32_bf16 v[64:67], a[80:83], a[56:59], v[64:67]
    s_waitcnt lgkmcnt(0)
    v_mfma_f32_16x16x32_bf16 v[52:55], a[84:87], a[52:55], v[52:55]
    v_mfma_f32_16x16x32_bf16 v[68:71], a[84:87], a[56:59], v[68:71]
    v_mfma_f32_16x16x32_bf16 v[72:75], a[72:75], a[0:3], v[72:75]
    s_barrier
    ds_write_b128 v20, v[40:43] offset:0
    v_mfma_f32_16x16x32_bf16 v[88:91], a[72:75], a[4:7], v[88:91]
    ds_write_b128 v20, v[56:59] offset:4096
    v_mfma_f32_16x16x32_bf16 v[76:79], a[76:79], a[0:3], v[76:79]
    ds_write_b128 v20, v[44:47] offset:1024
    v_mfma_f32_16x16x32_bf16 v[92:95], a[76:79], a[4:7], v[92:95]
    ds_write_b128 v20, v[60:63] offset:5120
    v_mfma_f32_16x16x32_bf16 v[80:83], a[80:83], a[0:3], v[80:83]
    ds_write_b128 v20, v[48:51] offset:2048
    v_mfma_f32_16x16x32_bf16 v[96:99], a[80:83], a[4:7], v[96:99]
    ds_write_b128 v20, v[64:67] offset:6144
    v_mfma_f32_16x16x32_bf16 v[84:87], a[84:87], a[0:3], v[84:87]
    ds_write_b128 v20, v[52:55] offset:3072
    v_mfma_f32_16x16x32_bf16 v[100:103], a[84:87], a[4:7], v[100:103]
    ds_write_b128 v20, v[68:71] offset:7168
    v_mfma_f32_16x16x32_bf16 v[104:107], a[72:75], a[8:11], v[104:107]
    v_mfma_f32_16x16x32_bf16 v[120:123], a[72:75], a[12:15], v[120:123]
    v_mfma_f32_16x16x32_bf16 v[108:111], a[76:79], a[8:11], v[108:111]
    v_mfma_f32_16x16x32_bf16 v[124:127], a[76:79], a[12:15], v[124:127]
    v_mfma_f32_16x16x32_bf16 v[112:115], a[80:83], a[8:11], v[112:115]
    v_mfma_f32_16x16x32_bf16 v[128:131], a[80:83], a[12:15], v[128:131]
    v_mfma_f32_16x16x32_bf16 v[116:119], a[84:87], a[8:11], v[116:119]
    v_mfma_f32_16x16x32_bf16 v[132:135], a[84:87], a[12:15], v[132:135]
    v_mfma_f32_16x16x32_bf16 v[136:139], a[72:75], a[16:19], v[136:139]
    ds_write_b128 v21, v[104:107] offset:0
    v_mfma_f32_16x16x32_bf16 v[152:155], a[72:75], a[20:23], v[152:155]
    ds_write_b128 v21, v[120:123] offset:4096
    v_mfma_f32_16x16x32_bf16 v[140:143], a[76:79], a[16:19], v[140:143]
    ds_write_b128 v21, v[108:111] offset:1024
    v_mfma_f32_16x16x32_bf16 v[156:159], a[76:79], a[20:23], v[156:159]
    ds_write_b128 v21, v[124:127] offset:5120
    v_mfma_f32_16x16x32_bf16 v[144:147], a[80:83], a[16:19], v[144:147]
    ds_write_b128 v21, v[112:115] offset:2048
    v_mfma_f32_16x16x32_bf16 v[160:163], a[80:83], a[20:23], v[160:163]
    ds_write_b128 v21, v[128:131] offset:6144
    v_mfma_f32_16x16x32_bf16 v[148:151], a[84:87], a[16:19], v[148:151]
    ds_write_b128 v21, v[116:119] offset:3072
    v_mfma_f32_16x16x32_bf16 v[164:167], a[84:87], a[20:23], v[164:167]
    ds_write_b128 v21, v[132:135] offset:7168
    s_nop 7
    ds_write_b128 v21, v[136:139] offset:16384
    ds_write_b128 v21, v[152:155] offset:20480
    ds_write_b128 v21, v[140:143] offset:17408
    ds_write_b128 v21, v[156:159] offset:21504
    ds_write_b128 v21, v[144:147] offset:18432
    ds_write_b128 v21, v[160:163] offset:22528
    ds_write_b128 v21, v[148:151] offset:19456
    ds_write_b128 v21, v[164:167] offset:23552
    s_waitcnt lgkmcnt(0)
    s_barrier
    ds_read_b128 v[40:43], v22 offset:0
    ds_read_b128 v[44:47], v22 offset:1024
    ds_read_b128 v[48:51], v22 offset:2048
    ds_read_b128 v[52:55], v22 offset:3072
    ds_read_b128 v[136:139], v22 offset:8192
    ds_read_b128 v[140:143], v22 offset:9216
    ds_read_b128 v[144:147], v22 offset:10240
    ds_read_b128 v[148:151], v22 offset:11264
    ds_read_b128 v[104:107], v22 offset:16384
    ds_read_b128 v[108:111], v22 offset:17408
    ds_read_b128 v[112:115], v22 offset:18432
    ds_read_b128 v[116:119], v22 offset:19456
    ds_read_b128 v[56:59], v22 offset:4096
    ds_read_b128 v[60:63], v22 offset:5120
    ds_read_b128 v[64:67], v22 offset:6144
    ds_read_b128 v[68:71], v22 offset:7168
    ds_read_b128 v[152:155], v22 offset:12288
    ds_read_b128 v[156:159], v22 offset:13312
    ds_read_b128 v[160:163], v22 offset:14336
    ds_read_b128 v[164:167], v22 offset:15360
    ds_read_b128 v[120:123], v22 offset:20480
    ds_read_b128 v[124:127], v22 offset:21504
    ds_read_b128 v[128:131], v22 offset:22528
    ds_read_b128 v[132:135], v22 offset:23552
    s_branch conv1_kernel_redd
conv1_kernel_red1:
    s_cmp_lg_u32 s28, 2
    s_cbranch_scc1 conv1_kernel_red2
    s_waitcnt lgkmcnt(4)
    v_mfma_f32_16x16x32_bf16 v[40:43], a[72:75], a[52:55], v[40:43]
    ds_read_b64_tr_b16 a[84:85], v19 offset:16384
    v_mfma_f32_16x16x32_bf16 v[56:59], a[72:75], a[56:59], v[56:59]
    ds_read_b64_tr_b16 a[86:87], v19 offset:16640
    s_waitcnt lgkmcnt(4)
    v_mfma_f32_16x16x32_bf16 v[44:47], a[76:79], a[52:55], v[44:47]
    v_mfma_f32_16x16x32_bf16 v[60:63], a[76:79], a[56:59], v[60:63]
    s_waitcnt lgkmcnt(2)
    v_mfma_f32_16x16x32_bf16 v[48:51], a[80:83], a[52:55], v[48:51]
    v_mfma_f32_16x16x32_bf16 v[64:67], a[80:83], a[56:59], v[64:67]
    s_waitcnt lgkmcnt(0)
    v_mfma_f32_16x16x32_bf16 v[52:55], a[84:87], a[52:55], v[52:55]
    v_mfma_f32_16x16x32_bf16 v[68:71], a[84:87], a[56:59], v[68:71]
    v_mfma_f32_16x16x32_bf16 v[72:75], a[72:75], a[0:3], v[72:75]
    s_barrier
    ds_write_b128 v20, v[40:43] offset:8192
    v_mfma_f32_16x16x32_bf16 v[88:91], a[72:75], a[4:7], v[88:91]
    ds_write_b128 v20, v[56:59] offset:12288
    v_mfma_f32_16x16x32_bf16 v[76:79], a[76:79], a[0:3], v[76:79]
    ds_write_b128 v20, v[44:47] offset:9216
    v_mfma_f32_16x16x32_bf16 v[92:95], a[76:79], a[4:7], v[92:95]
    ds_write_b128 v20, v[60:63] offset:13312
    v_mfma_f32_16x16x32_bf16 v[80:83], a[80:83], a[0:3], v[80:83]
    ds_write_b128 v20, v[48:51] offset:10240
    v_mfma_f32_16x16x32_bf16 v[96:99], a[80:83], a[4:7], v[96:99]
    ds_write_b128 v20, v[64:67] offset:14336
    v_mfma_f32_16x16x32_bf16 v[84:87], a[84:87], a[0:3], v[84:87]
    ds_write_b128 v20, v[52:55] offset:11264
    v_mfma_f32_16x16x32_bf16 v[100:103], a[84:87], a[4:7], v[100:103]
    ds_write_b128 v20, v[68:71] offset:15360
    v_mfma_f32_16x16x32_bf16 v[104:107], a[72:75], a[8:11], v[104:107]
    ds_write_b128 v20, v[72:75] offset:40960
    v_mfma_f32_16x16x32_bf16 v[120:123], a[72:75], a[12:15], v[120:123]
    ds_write_b128 v20, v[88:91] offset:45056
    v_mfma_f32_16x16x32_bf16 v[108:111], a[76:79], a[8:11], v[108:111]
    ds_write_b128 v20, v[76:79] offset:41984
    v_mfma_f32_16x16x32_bf16 v[124:127], a[76:79], a[12:15], v[124:127]
    ds_write_b128 v20, v[92:95] offset:46080
    v_mfma_f32_16x16x32_bf16 v[112:115], a[80:83], a[8:11], v[112:115]
    ds_write_b128 v20, v[80:83] offset:43008
    v_mfma_f32_16x16x32_bf16 v[128:131], a[80:83], a[12:15], v[128:131]
    ds_write_b128 v20, v[96:99] offset:47104
    v_mfma_f32_16x16x32_bf16 v[116:119], a[84:87], a[8:11], v[116:119]
    ds_write_b128 v20, v[84:87] offset:44032
    v_mfma_f32_16x16x32_bf16 v[132:135], a[84:87], a[12:15], v[132:135]
    ds_write_b128 v20, v[100:103] offset:48128
    v_mfma_f32_16x16x32_bf16 v[136:139], a[72:75], a[16:19], v[136:139]
    v_mfma_f32_16x16x32_bf16 v[152:155], a[72:75], a[20:23], v[152:155]
    v_mfma_f32_16x16x32_bf16 v[140:143], a[76:79], a[16:19], v[140:143]
    v_mfma_f32_16x16x32_bf16 v[156:159], a[76:79], a[20:23], v[156:159]
    v_mfma_f32_16x16x32_bf16 v[144:147], a[80:83], a[16:19], v[144:147]
    v_mfma_f32_16x16x32_bf16 v[160:163], a[80:83], a[20:23], v[160:163]
    v_mfma_f32_16x16x32_bf16 v[148:151], a[84:87], a[16:19], v[148:151]
    v_mfma_f32_16x16x32_bf16 v[164:167], a[84:87], a[20:23], v[164:167]
    s_nop 7
    ds_write_b128 v21, v[136:139] offset:8192
    ds_write_b128 v21, v[152:155] offset:12288
    ds_write_b128 v21, v[140:143] offset:9216
    ds_write_b128 v21, v[156:159] offset:13312
    ds_write_b128 v21, v[144:147] offset:10240
    ds_write_b128 v21, v[160:163] offset:14336
    ds_write_b128 v21, v[148:151] offset:11264
    ds_write_b128 v21, v[164:167] offset:15360
    s_waitcnt lgkmcnt(0)
    s_barrier
    ds_read_b128 v[136:139], v22 offset:0
    ds_read_b128 v[140:143], v22 offset:1024
    ds_read_b128 v[144:147], v22 offset:2048
    ds_read_b128 v[148:151], v22 offset:3072
    ds_read_b128 v[40:43], v22 offset:8192
    ds_read_b128 v[44:47], v22 offset:9216
    ds_read_b128 v[48:51], v22 offset:10240
    ds_read_b128 v[52:55], v22 offset:11264
    ds_read_b128 v[72:75], v22 offset:16384
    ds_read_b128 v[76:79], v22 offset:17408
    ds_read_b128 v[80:83], v22 offset:18432
    ds_read_b128 v[84:87], v22 offset:19456
    ds_read_b128 v[152:155], v22 offset:4096
    ds_read_b128 v[156:159], v22 offset:5120
    ds_read_b128 v[160:163], v22 offset:6144
    ds_read_b128 v[164:167], v22 offset:7168
    ds_read_b128 v[56:59], v22 offset:12288
    ds_read_b128 v[60:63], v22 offset:13312
    ds_read_b128 v[64:67], v22 offset:14336
    ds_read_b128 v[68:71], v22 offset:15360
    ds_read_b128 v[88:91], v22 offset:20480
    ds_read_b128 v[92:95], v22 offset:21504
    ds_read_b128 v[96:99], v22 offset:22528
    ds_read_b128 v[100:103], v22 offset:23552
    s_branch conv1_kernel_redd
conv1_kernel_red2:
    s_cmp_lg_u32 s28, 3
    s_cbranch_scc1 conv1_kernel_red3
    s_waitcnt lgkmcnt(4)
    v_mfma_f32_16x16x32_bf16 v[40:43], a[72:75], a[52:55], v[40:43]
    ds_read_b64_tr_b16 a[84:85], v19 offset:16384
    v_mfma_f32_16x16x32_bf16 v[56:59], a[72:75], a[56:59], v[56:59]
    ds_read_b64_tr_b16 a[86:87], v19 offset:16640
    s_waitcnt lgkmcnt(4)
    v_mfma_f32_16x16x32_bf16 v[44:47], a[76:79], a[52:55], v[44:47]
    v_mfma_f32_16x16x32_bf16 v[60:63], a[76:79], a[56:59], v[60:63]
    s_waitcnt lgkmcnt(2)
    v_mfma_f32_16x16x32_bf16 v[48:51], a[80:83], a[52:55], v[48:51]
    v_mfma_f32_16x16x32_bf16 v[64:67], a[80:83], a[56:59], v[64:67]
    s_waitcnt lgkmcnt(0)
    v_mfma_f32_16x16x32_bf16 v[52:55], a[84:87], a[52:55], v[52:55]
    v_mfma_f32_16x16x32_bf16 v[68:71], a[84:87], a[56:59], v[68:71]
    v_mfma_f32_16x16x32_bf16 v[72:75], a[72:75], a[0:3], v[72:75]
    s_barrier
    ds_write_b128 v20, v[40:43] offset:16384
    v_mfma_f32_16x16x32_bf16 v[88:91], a[72:75], a[4:7], v[88:91]
    ds_write_b128 v20, v[56:59] offset:20480
    v_mfma_f32_16x16x32_bf16 v[76:79], a[76:79], a[0:3], v[76:79]
    ds_write_b128 v20, v[44:47] offset:17408
    v_mfma_f32_16x16x32_bf16 v[92:95], a[76:79], a[4:7], v[92:95]
    ds_write_b128 v20, v[60:63] offset:21504
    v_mfma_f32_16x16x32_bf16 v[80:83], a[80:83], a[0:3], v[80:83]
    ds_write_b128 v20, v[48:51] offset:18432
    v_mfma_f32_16x16x32_bf16 v[96:99], a[80:83], a[4:7], v[96:99]
    ds_write_b128 v20, v[64:67] offset:22528
    v_mfma_f32_16x16x32_bf16 v[84:87], a[84:87], a[0:3], v[84:87]
    ds_write_b128 v20, v[52:55] offset:19456
    v_mfma_f32_16x16x32_bf16 v[100:103], a[84:87], a[4:7], v[100:103]
    ds_write_b128 v20, v[68:71] offset:23552
    v_mfma_f32_16x16x32_bf16 v[104:107], a[72:75], a[8:11], v[104:107]
    ds_write_b128 v20, v[72:75] offset:32768
    v_mfma_f32_16x16x32_bf16 v[120:123], a[72:75], a[12:15], v[120:123]
    ds_write_b128 v20, v[88:91] offset:36864
    v_mfma_f32_16x16x32_bf16 v[108:111], a[76:79], a[8:11], v[108:111]
    ds_write_b128 v20, v[76:79] offset:33792
    v_mfma_f32_16x16x32_bf16 v[124:127], a[76:79], a[12:15], v[124:127]
    ds_write_b128 v20, v[92:95] offset:37888
    v_mfma_f32_16x16x32_bf16 v[112:115], a[80:83], a[8:11], v[112:115]
    ds_write_b128 v20, v[80:83] offset:34816
    v_mfma_f32_16x16x32_bf16 v[128:131], a[80:83], a[12:15], v[128:131]
    ds_write_b128 v20, v[96:99] offset:38912
    v_mfma_f32_16x16x32_bf16 v[116:119], a[84:87], a[8:11], v[116:119]
    ds_write_b128 v20, v[84:87] offset:35840
    v_mfma_f32_16x16x32_bf16 v[132:135], a[84:87], a[12:15], v[132:135]
    ds_write_b128 v20, v[100:103] offset:39936
    v_mfma_f32_16x16x32_bf16 v[136:139], a[72:75], a[16:19], v[136:139]
    ds_write_b128 v20, v[104:107] offset:49152
    v_mfma_f32_16x16x32_bf16 v[152:155], a[72:75], a[20:23], v[152:155]
    ds_write_b128 v20, v[120:123] offset:53248
    v_mfma_f32_16x16x32_bf16 v[140:143], a[76:79], a[16:19], v[140:143]
    ds_write_b128 v20, v[108:111] offset:50176
    v_mfma_f32_16x16x32_bf16 v[156:159], a[76:79], a[20:23], v[156:159]
    ds_write_b128 v20, v[124:127] offset:54272
    v_mfma_f32_16x16x32_bf16 v[144:147], a[80:83], a[16:19], v[144:147]
    ds_write_b128 v20, v[112:115] offset:51200
    v_mfma_f32_16x16x32_bf16 v[160:163], a[80:83], a[20:23], v[160:163]
    ds_write_b128 v20, v[128:131] offset:55296
    v_mfma_f32_16x16x32_bf16 v[148:151], a[84:87], a[16:19], v[148:151]
    ds_write_b128 v20, v[116:119] offset:52224
    v_mfma_f32_16x16x32_bf16 v[164:167], a[84:87], a[20:23], v[164:167]
    ds_write_b128 v20, v[132:135] offset:56320
    s_nop 7
    s_waitcnt lgkmcnt(0)
    s_barrier
    ds_read_b128 v[104:107], v22 offset:0
    ds_read_b128 v[108:111], v22 offset:1024
    ds_read_b128 v[112:115], v22 offset:2048
    ds_read_b128 v[116:119], v22 offset:3072
    ds_read_b128 v[72:75], v22 offset:8192
    ds_read_b128 v[76:79], v22 offset:9216
    ds_read_b128 v[80:83], v22 offset:10240
    ds_read_b128 v[84:87], v22 offset:11264
    ds_read_b128 v[40:43], v22 offset:16384
    ds_read_b128 v[44:47], v22 offset:17408
    ds_read_b128 v[48:51], v22 offset:18432
    ds_read_b128 v[52:55], v22 offset:19456
    ds_read_b128 v[120:123], v22 offset:4096
    ds_read_b128 v[124:127], v22 offset:5120
    ds_read_b128 v[128:131], v22 offset:6144
    ds_read_b128 v[132:135], v22 offset:7168
    ds_read_b128 v[88:91], v22 offset:12288
    ds_read_b128 v[92:95], v22 offset:13312
    ds_read_b128 v[96:99], v22 offset:14336
    ds_read_b128 v[100:103], v22 offset:15360
    ds_read_b128 v[56:59], v22 offset:20480
    ds_read_b128 v[60:63], v22 offset:21504
    ds_read_b128 v[64:67], v22 offset:22528
    ds_read_b128 v[68:71], v22 offset:23552
    s_branch conv1_kernel_redd
conv1_kernel_red3:
conv1_kernel_redd:
    s_waitcnt lgkmcnt(12)
    v_pk_add_f32 v[40:41], v[40:41], v[72:73]
    v_pk_add_f32 v[42:43], v[42:43], v[74:75]
    v_pk_add_f32 v[44:45], v[44:45], v[76:77]
    v_pk_add_f32 v[46:47], v[46:47], v[78:79]
    v_pk_add_f32 v[48:49], v[48:49], v[80:81]
    v_pk_add_f32 v[50:51], v[50:51], v[82:83]
    v_pk_add_f32 v[52:53], v[52:53], v[84:85]
    v_pk_add_f32 v[54:55], v[54:55], v[86:87]
    v_pk_add_f32 v[104:105], v[104:105], v[136:137]
    v_pk_add_f32 v[106:107], v[106:107], v[138:139]
    v_pk_add_f32 v[108:109], v[108:109], v[140:141]
    v_pk_add_f32 v[110:111], v[110:111], v[142:143]
    v_pk_add_f32 v[112:113], v[112:113], v[144:145]
    v_pk_add_f32 v[114:115], v[114:115], v[146:147]
    v_pk_add_f32 v[116:117], v[116:117], v[148:149]
    v_pk_add_f32 v[118:119], v[118:119], v[150:151]
    v_pk_add_f32 v[40:41], v[40:41], v[104:105]
    v_pk_add_f32 v[42:43], v[42:43], v[106:107]
    v_pk_add_f32 v[44:45], v[44:45], v[108:109]
    v_pk_add_f32 v[46:47], v[46:47], v[110:111]
    v_pk_add_f32 v[48:49], v[48:49], v[112:113]
    v_pk_add_f32 v[50:51], v[50:51], v[114:115]
    v_pk_add_f32 v[52:53], v[52:53], v[116:117]
    v_pk_add_f32 v[54:55], v[54:55], v[118:119]
    v_pk_mul_f32 v[72:73], v[40:41], v[40:41]
    v_pk_mul_f32 v[74:75], v[42:43], v[42:43]
    v_pk_mul_f32 v[76:77], v[44:45], v[44:45]
    v_pk_mul_f32 v[78:79], v[46:47], v[46:47]
    v_pk_mul_f32 v[80:81], v[48:49], v[48:49]
    v_pk_mul_f32 v[82:83], v[50:51], v[50:51]
    v_pk_mul_f32 v[84:85], v[52:53], v[52:53]
    v_pk_mul_f32 v[86:87], v[54:55], v[54:55]
    v_pk_fma_f32 v[72:73], v[72:73], v[26:27], v[24:25]
    v_pk_fma_f32 v[74:75], v[74:75], v[26:27], v[24:25]
    v_pk_fma_f32 v[76:77], v[76:77], v[26:27], v[24:25]
    v_pk_fma_f32 v[78:79], v[78:79], v[26:27], v[24:25]
    v_pk_fma_f32 v[80:81], v[80:81], v[26:27], v[24:25]
    v_pk_fma_f32 v[82:83], v[82:83], v[26:27], v[24:25]
    v_pk_fma_f32 v[84:85], v[84:85], v[26:27], v[24:25]
    v_pk_fma_f32 v[86:87], v[86:87], v[26:27], v[24:25]
    v_pk_mul_f32 v[72:73], v[72:73], v[40:41]
    v_pk_mul_f32 v[74:75], v[74:75], v[42:43]
    v_pk_mul_f32 v[76:77], v[76:77], v[44:45]
    v_pk_mul_f32 v[78:79], v[78:79], v[46:47]
    v_pk_mul_f32 v[80:81], v[80:81], v[48:49]
    v_pk_mul_f32 v[82:83], v[82:83], v[50:51]
    v_pk_mul_f32 v[84:85], v[84:85], v[52:53]
    v_pk_mul_f32 v[86:87], v[86:87], v[54:55]
    v_exp_f32 v72, v72
    v_exp_f32 v73, v73
    v_exp_f32 v74, v74
    v_exp_f32 v75, v75
    v_exp_f32 v76, v76
    v_exp_f32 v77, v77
    v_exp_f32 v78, v78
    v_exp_f32 v79, v79
    v_exp_f32 v80, v80
    v_exp_f32 v81, v81
    v_exp_f32 v82, v82
    v_exp_f32 v83, v83
    v_exp_f32 v84, v84
    v_exp_f32 v85, v85
    v_exp_f32 v86, v86
    v_exp_f32 v87, v87
    v_pk_add_f32 v[72:73], v[72:73], v[28:29]
    v_pk_add_f32 v[74:75], v[74:75], v[28:29]
    v_pk_add_f32 v[76:77], v[76:77], v[28:29]
    v_pk_add_f32 v[78:79], v[78:79], v[28:29]
    v_pk_add_f32 v[80:81], v[80:81], v[28:29]
    v_pk_add_f32 v[82:83], v[82:83], v[28:29]
    v_pk_add_f32 v[84:85], v[84:85], v[28:29]
    v_pk_add_f32 v[86:87], v[86:87], v[28:29]
    v_rcp_f32 v72, v72
    v_rcp_f32 v73, v73
    v_rcp_f32 v74, v74
    v_rcp_f32 v75, v75
    v_rcp_f32 v76, v76
    v_rcp_f32 v77, v77
    v_rcp_f32 v78, v78
    v_rcp_f32 v79, v79
    v_rcp_f32 v80, v80
    v_rcp_f32 v81, v81
    v_rcp_f32 v82, v82
    v_rcp_f32 v83, v83
    v_rcp_f32 v84, v84
    v_rcp_f32 v85, v85
    v_rcp_f32 v86, v86
    v_rcp_f32 v87, v87
    v_pk_mul_f32 v[40:41], v[40:41], v[72:73]
    v_pk_mul_f32 v[42:43], v[42:43], v[74:75]
    v_pk_mul_f32 v[44:45], v[44:45], v[76:77]
    v_pk_mul_f32 v[46:47], v[46:47], v[78:79]
    v_pk_mul_f32 v[48:49], v[48:49], v[80:81]
    v_pk_mul_f32 v[50:51], v[50:51], v[82:83]
    v_pk_mul_f32 v[52:53], v[52:53], v[84:85]
    v_pk_mul_f32 v[54:55], v[54:55], v[86:87]
    s_waitcnt lgkmcnt(0)
    v_pk_add_f32 v[56:57], v[56:57], v[88:89]
    v_pk_add_f32 v[58:59], v[58:59], v[90:91]
    v_pk_add_f32 v[60:61], v[60:61], v[92:93]
    v_pk_add_f32 v[62:63], v[62:63], v[94:95]
    v_pk_add_f32 v[64:65], v[64:65], v[96:97]
    v_pk_add_f32 v[66:67], v[66:67], v[98:99]
    v_pk_add_f32 v[68:69], v[68:69], v[100:101]
    v_pk_add_f32 v[70:71], v[70:71], v[102:103]
    v_pk_add_f32 v[120:121], v[120:121], v[152:153]
    v_pk_add_f32 v[122:123], v[122:123], v[154:155]
    v_pk_add_f32 v[124:125], v[124:125], v[156:157]
    v_pk_add_f32 v[126:127], v[126:127], v[158:159]
    v_pk_add_f32 v[128:129], v[128:129], v[160:161]
    v_pk_add_f32 v[130:131], v[130:131], v[162:163]
    v_pk_add_f32 v[132:133], v[132:133], v[164:165]
    v_pk_add_f32 v[134:135], v[134:135], v[166:167]
    v_pk_add_f32 v[56:57], v[56:57], v[120:121]
    v_pk_add_f32 v[58:59], v[58:59], v[122:123]
    v_pk_add_f32 v[60:61], v[60:61], v[124:125]
    v_pk_add_f32 v[62:63], v[62:63], v[126:127]
    v_pk_add_f32 v[64:65], v[64:65], v[128:129]
    v_pk_add_f32 v[66:67], v[66:67], v[130:131]
    v_pk_add_f32 v[68:69], v[68:69], v[132:133]
    v_pk_add_f32 v[70:71], v[70:71], v[134:135]
    v_pk_mul_f32 v[88:89], v[56:57], v[56:57]
    v_pk_mul_f32 v[90:91], v[58:59], v[58:59]
    v_pk_mul_f32 v[92:93], v[60:61], v[60:61]
    v_pk_mul_f32 v[94:95], v[62:63], v[62:63]
    v_pk_mul_f32 v[96:97], v[64:65], v[64:65]
    v_pk_mul_f32 v[98:99], v[66:67], v[66:67]
    v_pk_mul_f32 v[100:101], v[68:69], v[68:69]
    v_pk_mul_f32 v[102:103], v[70:71], v[70:71]
    v_pk_fma_f32 v[88:89], v[88:89], v[26:27], v[24:25]
    v_pk_fma_f32 v[90:91], v[90:91], v[26:27], v[24:25]
    v_pk_fma_f32 v[92:93], v[92:93], v[26:27], v[24:25]
    v_pk_fma_f32 v[94:95], v[94:95], v[26:27], v[24:25]
    v_pk_fma_f32 v[96:97], v[96:97], v[26:27], v[24:25]
    v_pk_fma_f32 v[98:99], v[98:99], v[26:27], v[24:25]
    v_pk_fma_f32 v[100:101], v[100:101], v[26:27], v[24:25]
    v_pk_fma_f32 v[102:103], v[102:103], v[26:27], v[24:25]
    v_pk_mul_f32 v[88:89], v[88:89], v[56:57]
    v_pk_mul_f32 v[90:91], v[90:91], v[58:59]
    v_pk_mul_f32 v[92:93], v[92:93], v[60:61]
    v_pk_mul_f32 v[94:95], v[94:95], v[62:63]
    v_pk_mul_f32 v[96:97], v[96:97], v[64:65]
    v_pk_mul_f32 v[98:99], v[98:99], v[66:67]
    v_pk_mul_f32 v[100:101], v[100:101], v[68:69]
    v_pk_mul_f32 v[102:103], v[102:103], v[70:71]
    v_exp_f32 v88, v88
    v_exp_f32 v89, v89
    v_exp_f32 v90, v90
    v_exp_f32 v91, v91
    v_exp_f32 v92, v92
    v_exp_f32 v93, v93
    v_exp_f32 v94, v94
    v_exp_f32 v95, v95
    v_exp_f32 v96, v96
    v_exp_f32 v97, v97
    v_exp_f32 v98, v98
    v_exp_f32 v99, v99
    v_exp_f32 v100, v100
    v_exp_f32 v101, v101
    v_exp_f32 v102, v102
    v_exp_f32 v103, v103
    v_pk_add_f32 v[88:89], v[88:89], v[28:29]
    v_pk_add_f32 v[90:91], v[90:91], v[28:29]
    v_pk_add_f32 v[92:93], v[92:93], v[28:29]
    v_pk_add_f32 v[94:95], v[94:95], v[28:29]
    v_pk_add_f32 v[96:97], v[96:97], v[28:29]
    v_pk_add_f32 v[98:99], v[98:99], v[28:29]
    v_pk_add_f32 v[100:101], v[100:101], v[28:29]
    v_pk_add_f32 v[102:103], v[102:103], v[28:29]
    v_rcp_f32 v88, v88
    v_rcp_f32 v89, v89
    v_rcp_f32 v90, v90
    v_rcp_f32 v91, v91
    v_rcp_f32 v92, v92
    v_rcp_f32 v93, v93
    v_rcp_f32 v94, v94
    v_rcp_f32 v95, v95
    v_rcp_f32 v96, v96
    v_rcp_f32 v97, v97
    v_rcp_f32 v98, v98
    v_rcp_f32 v99, v99
    v_rcp_f32 v100, v100
    v_rcp_f32 v101, v101
    v_rcp_f32 v102, v102
    v_rcp_f32 v103, v103
    v_pk_mul_f32 v[56:57], v[56:57], v[88:89]
    v_pk_mul_f32 v[58:59], v[58:59], v[90:91]
    v_pk_mul_f32 v[60:61], v[60:61], v[92:93]
    v_pk_mul_f32 v[62:63], v[62:63], v[94:95]
    v_pk_mul_f32 v[64:65], v[64:65], v[96:97]
    v_pk_mul_f32 v[66:67], v[66:67], v[98:99]
    v_pk_mul_f32 v[68:69], v[68:69], v[100:101]
    v_pk_mul_f32 v[70:71], v[70:71], v[102:103]
    v_cvt_pk_bf16_f32 v104, v40, v41
    v_cvt_pk_bf16_f32 v105, v42, v43
    v_cvt_pk_bf16_f32 v106, v44, v45
    v_cvt_pk_bf16_f32 v107, v46, v47
    v_cvt_pk_bf16_f32 v108, v48, v49
    v_cvt_pk_bf16_f32 v109, v50, v51
    v_cvt_pk_bf16_f32 v110, v52, v53
    v_cvt_pk_bf16_f32 v111, v54, v55
    v_cvt_pk_bf16_f32 v112, v56, v57
    v_cvt_pk_bf16_f32 v113, v58, v59
    v_cvt_pk_bf16_f32 v114, v60, v61
    v_cvt_pk_bf16_f32 v115, v62, v63
    v_cvt_pk_bf16_f32 v116, v64, v65
    v_cvt_pk_bf16_f32 v117, v66, v67
    v_cvt_pk_bf16_f32 v118, v68, v69
    v_cvt_pk_bf16_f32 v119, v70, v71
    ds_write_b64 v4, v[104:105] offset:0
    ds_write_b64 v5, v[106:107] offset:0
    ds_write_b64 v6, v[108:109] offset:0
    ds_write_b64 v7, v[110:111] offset:0
    ds_write_b64 v4, v[112:113] offset:2048
    ds_write_b64 v5, v[114:115] offset:2048
    ds_write_b64 v6, v[116:117] offset:2048
    ds_write_b64 v7, v[118:119] offset:2048
    s_waitcnt lgkmcnt(0)
    ds_read_b128 v[72:75], v22 offset:0
    ds_read_b128 v[76:79], v22 offset:1024
    ds_read_b128 v[80:83], v22 offset:2048
    ds_read_b128 v[84:87], v22 offset:3072
    s_add_u32 s36, s42, 0
    s_waitcnt lgkmcnt(3)
    buffer_store_dwordx4 v[72:75], v8, s[16:19], s36 offen sc1
    s_add_u32 s36, s42, 65536
    s_waitcnt lgkmcnt(2)
    buffer_store_dwordx4 v[76:79], v8, s[16:19], s36 offen sc1
    s_add_u32 s36, s42, 1024
    s_waitcnt lgkmcnt(1)
    buffer_store_dwordx4 v[80:83], v8, s[16:19], s36 offen sc1
    s_add_u32 s36, s42, 66560
    s_waitcnt lgkmcnt(0)
    buffer_store_dwordx4 v[84:87], v8, s[16:19], s36 offen sc1
    s_waitcnt vmcnt(0)
conv1_kernel_end:
    s_endpgm
conv1_kernel_helper:
    s_load_dwordx2 s[44:45], s[0:1], 16
    s_load_dwordx4 s[48:51], s[0:1], 32
    s_load_dwordx2 s[46:47], s[0:1], 48
    s_lshl_b32 s56, s2, 6
    v_add_u32 v20, s56, v2
    v_lshrrev_b32 v21, 10, v20
    v_lshlrev_b32 v21, 19, v21
    v_bfe_u32 v22, v20, 3, 7
    v_lshl_add_u32 v21, v22, 10, v21
    v_and_b32 v22, 7, v20
    v_lshl_add_u32 v14, v22, 7, v21
    v_lshrrev_b32 v21, 1, v20
    v_lshlrev_b32 v21, 10, v21
    v_and_b32 v22, 1, v20
    v_lshl_add_u32 v15, v22, 7, v21
    s_mov_b32 s8, s4
    s_mov_b32 s9, s5
    s_mov_b32 s10, 8192000
    s_mov_b32 s11, 0x20000
    s_mov_b32 s12, s6
    s_mov_b32 s13, s7
    s_mov_b32 s14, 7864320
    s_mov_b32 s15, 0x20000
    s_mov_b32 s36, 0
    buffer_load_dword v16, v14, s[12:15], s36 offen
    s_mov_b32 s36, 0
    buffer_load_dword v16, v15, s[8:11], s36 offen
    v_lshrrev_b32 v22, 3, v2
    v_and_b32 v23, 1, v22
    v_lshlrev_b32 v23, 3, v23
    v_bfe_u32 v24, v22, 1, 1
    v_lshl_add_u32 v23, v24, 2, v23
    v_lshrrev_b32 v24, 2, v22
    v_lshl_add_u32 v23, v24, 4, v23
    v_lshlrev_b32 v23, 10, v23
    v_and_b32 v24, 7, v2
    v_xor_b32 v25, 0, v24
    v_lshl_add_u32 v4, v25, 4, v23
    v_xor_b32 v25, 2, v24
    v_lshl_add_u32 v5, v25, 4, v23
    v_xor_b32 v25, 4, v24
    v_lshl_add_u32 v6, v25, 4, v23
    v_xor_b32 v25, 6, v24
    v_lshl_add_u32 v7, v25, 4, v23
    v_lshrrev_b32 v3, 4, v2
    v_and_b32 v20, 15, v2
    v_lshrrev_b32 v22, 2, v20
    v_and_b32 v23, 3, v20
    v_and_b32 v24, 1, v3
    v_lshrrev_b32 v25, 1, v3
    v_lshl_add_u32 v24, v25, 2, v24
    v_lshlrev_b32 v24, 7, v24
    v_lshl_add_u32 v24, v22, 10, v24
    v_lshl_add_u32 v24, v23, 3, v24
    v_add_u32 v24, 98304, v24
    v_xor_b32 v25, 0, v22
    v_lshl_add_u32 v8, v25, 5, v24
    v_xor_b32 v25, 1, v22
    v_lshl_add_u32 v9, v25, 5, v24
    v_xor_b32 v25, 2, v22
    v_lshl_add_u32 v10, v25, 5, v24
    v_xor_b32 v25, 3, v22
    v_lshl_add_u32 v11, v25, 5, v24
    v_lshlrev_b32 v12, 4, v2
    v_mov_b32 v17, v12
    v_lshrrev_b32 v21, 1, v3
    v_lshlrev_b32 v21, 11, v21
    v_and_b32 v24, 1, v3
    v_lshl_add_u32 v21, v24, 9, v21
    v_lshl_add_u32 v13, v20, 4, v21
    s_waitcnt lgkmcnt(0)
    s_mov_b32 s52, s20
    s_mov_b32 s53, s21
    s_mov_b32 s54, 14680064
    s_mov_b32 s55, 0x20000
    s_mov_b32 s24, s44
    s_mov_b32 s25, s45
    s_mov_b32 s26, 7864320
    s_mov_b32 s27, 0x20000
    s_lshr_b32 s43, s2, 7
    s_bfe_u32 s57, s2, 0x40003
    s_and_b32 s58, s2, 7
    s_lshl_b32 s59, s43, 19
    s_lshl_b32 s60, s57, 15
    s_add_u32 s59, s59, s60
    s_lshl_b32 s60, s58, 7
    s_add_u32 s41, s59, s60
    s_lshl_b32 s60, s58, 3
    s_and_b32 s61, s57, 3
    s_add_u32 s60, s60, s61
    s_lshl_b32 s60, s60, 2
    s_lshr_b32 s61, s57, 2
    s_add_u32 s60, s60, s61
    s_mul_i32 s60, s60, 15
    s_lshl_b32 s61, s43, 3
    s_add_u32 s60, s60, s61
    s_lshl_b32 s60, s60, 11
    s_add_u32 s42, s60, 4194304
    s_lshl_b32 s56, s2, 6
    v_add_u32 v20, s56, v2
    v_lshlrev_b32 v18, 7, v20
    s_lshl_b32 s56, s2, 4
    v_and_b32 v20, 15, v2
    v_add_u32 v20, s56, v20
    v_lshlrev_b32 v19, 7, v20
    s_mov_b32 s72, s44
    s_mov_b32 s73, s45
    s_mov_b32 s74, 7864320
    s_mov_b32 s75, 0x20000
    s_barrier
    s_mov_b32 s36, 256
    buffer_load_dword v16, v15, s[8:11], s36 offen
    s_barrier
    s_mov_b32 s36, 131072
    buffer_load_dword v16, v14, s[12:15], s36 offen
    s_barrier
    s_mov_b32 s36, 512
    buffer_load_dword v16, v15, s[8:11], s36 offen
    s_barrier
    s_mov_b32 s36, 262144
    buffer_load_dword v16, v14, s[12:15], s36 offen
    s_barrier
    s_mov_b32 s36, 768
    buffer_load_dword v16, v15, s[8:11], s36 offen
    s_barrier
    s_mov_b32 s36, 393216
    buffer_load_dword v16, v14, s[12:15], s36 offen
    s_barrier
    s_mov_b32 s36, 0
    buffer_load_dword v16, v18, s[72:75], s36 offen
    s_mov_b32 s36, 2097152
    buffer_load_dword v16, v18, s[72:75], s36 offen
    s_getpc_b64 s[60:61]
conv1_kernel_h2_pc:
    s_sub_u32 s60, s60, conv1_kernel_h2_pc-conv1_kernel_last
    s_subb_u32 s61, s61, 0
    s_mov_b32 s62, conv2_kernel-conv1_kernel_last
    s_mov_b32 s63, 0x20000
    v_lshlrev_b32 v20, 7, v2
    s_mov_b32 s64, 0
    buffer_load_dword v16, v20, s[60:63], s64 offen
    s_mov_b32 s64, 8192
    buffer_load_dword v16, v20, s[60:63], s64 offen
    s_barrier
    s_mov_b32 s36, 4194304
    buffer_load_dword v16, v18, s[72:75], s36 offen
    s_mov_b32 s36, 6291456
    buffer_load_dword v16, v18, s[72:75], s36 offen
    s_mov_b32 s76, s48
    s_mov_b32 s77, s49
    s_mov_b32 s78, 524288
    s_mov_b32 s79, 0x20000
    buffer_load_dword v16, v19, s[76:79], 0 offen
    s_mov_b32 s76, s50
    s_mov_b32 s77, s51
    s_mov_b32 s78, 524288
    s_mov_b32 s79, 0x20000
    buffer_load_dword v16, v19, s[76:79], 0 offen
    s_mov_b32 s76, s46
    s_mov_b32 s77, s47
    s_mov_b32 s78, 524288
    s_mov_b32 s79, 0x20000
    buffer_load_dword v16, v19, s[76:79], 0 offen
    s_barrier
    s_cmp_ge_u32 s2, 8
    s_cbranch_scc1 conv1_kernel_h_nocode
    s_getpc_b64 s[60:61]
conv1_kernel_h1_pc:
    s_add_u32 s60, s60, conv2_kernel-conv1_kernel_h1_pc
    s_addc_u32 s61, s61, 0
    s_mov_b32 s62, joint_kernel_slow-conv2_kernel
    s_mov_b32 s63, 0x20000
    v_lshlrev_b32 v20, 7, v2
    s_mov_b32 s64, 0
    buffer_load_dword v16, v20, s[60:63], s64 offen
    s_mov_b32 s64, 8192
    buffer_load_dword v16, v20, s[60:63], s64 offen
    s_mov_b32 s64, 16384
    buffer_load_dword v16, v20, s[60:63], s64 offen
    s_mov_b32 s64, 24576
    buffer_load_dword v16, v20, s[60:63], s64 offen
conv1_kernel_h_nocode:
    s_mov_b32 s64, s42
    s_add_u32 s65, s42, 1024
    s_add_u32 s66, s42, 491520
    s_add_u32 s67, s42, 492544
    s_mov_b32 s36, s41
    s_add_u32 s41, s41, 1048576
    s_add_u32 s42, s42, 2048
    s_mov_b32 m0, 155648
    s_nop 0
    buffer_load_dwordx4 v4, s[24:27], s36 offen offset:0 lds
    buffer_load_dwordx4 v5, s[24:27], s36 offen offset:1024 lds
    buffer_load_dwordx4 v6, s[24:27], s36 offen offset:2048 lds
    buffer_load_dwordx4 v7, s[24:27], s36 offen offset:3072 lds
    s_mov_b32 s68, s42
    s_add_u32 s69, s42, 1024
    s_add_u32 s70, s42, 491520
    s_add_u32 s71, s42, 492544
    s_mov_b32 s36, s41
    s_add_u32 s41, s41, 1048576
    s_add_u32 s42, s42, 2048
    s_mov_b32 m0, 159744
    s_nop 0
    buffer_load_dwordx4 v4, s[24:27], s36 offen offset:0 lds
    buffer_load_dwordx4 v5, s[24:27], s36 offen offset:1024 lds
    buffer_load_dwordx4 v6, s[24:27], s36 offen offset:2048 lds
    buffer_load_dwordx4 v7, s[24:27], s36 offen offset:3072 lds
    s_barrier
    s_barrier
    s_mov_b32 s80, s42
    s_add_u32 s81, s42, 1024
    s_add_u32 s82, s42, 491520
    s_add_u32 s83, s42, 492544
    s_mov_b32 s36, s41
    s_add_u32 s41, s41, 1048576
    s_add_u32 s42, s42, 2048
    s_mov_b32 m0, 98304
    s_nop 0
    buffer_load_dwordx4 v4, s[24:27], s36 offen offset:0 lds
    buffer_load_dwordx4 v5, s[24:27], s36 offen offset:1024 lds
    buffer_load_dwordx4 v6, s[24:27], s36 offen offset:2048 lds
    buffer_load_dwordx4 v7, s[24:27], s36 offen offset:3072 lds
    s_mov_b32 s84, s42
    s_add_u32 s85, s42, 1024
    s_add_u32 s86, s42, 491520
    s_add_u32 s87, s42, 492544
    s_mov_b32 s36, s41
    s_add_u32 s41, s41, 1048576
    s_add_u32 s42, s42, 2048
    s_mov_b32 m0, 102400
    s_nop 0
    buffer_load_dwordx4 v4, s[24:27], s36 offen offset:0 lds
    buffer_load_dwordx4 v5, s[24:27], s36 offen offset:1024 lds
    buffer_load_dwordx4 v6, s[24:27], s36 offen offset:2048 lds
    buffer_load_dwordx4 v7, s[24:27], s36 offen offset:3072 lds
    s_mov_b32 s88, s42
    s_add_u32 s89, s42, 1024
    s_add_u32 s90, s42, 491520
    s_add_u32 s91, s42, 492544
    s_mov_b32 s36, s41
    s_add_u32 s41, s41, 1048576
    s_add_u32 s42, s42, 2048
    s_mov_b32 m0, 106496
    s_nop 0
    buffer_load_dwordx4 v4, s[24:27], s36 offen offset:0 lds
    buffer_load_dwordx4 v5, s[24:27], s36 offen offset:1024 lds
    buffer_load_dwordx4 v6, s[24:27], s36 offen offset:2048 lds
    buffer_load_dwordx4 v7, s[24:27], s36 offen offset:3072 lds
    s_mov_b32 s92, s42
    s_add_u32 s93, s42, 1024
    s_add_u32 s94, s42, 491520
    s_add_u32 s95, s42, 492544
    s_mov_b32 s36, s41
    s_add_u32 s41, s41, 1048576
    s_add_u32 s42, s42, 2048
    s_mov_b32 m0, 110592
    s_nop 0
    buffer_load_dwordx4 v4, s[24:27], s36 offen offset:0 lds
    buffer_load_dwordx4 v5, s[24:27], s36 offen offset:1024 lds
    buffer_load_dwordx4 v6, s[24:27], s36 offen offset:2048 lds
    buffer_load_dwordx4 v7, s[24:27], s36 offen offset:3072 lds
    s_mov_b32 s96, s42
    s_add_u32 s97, s42, 1024
    s_add_u32 s98, s42, 491520
    s_add_u32 s99, s42, 492544
    s_mov_b32 s36, s41
    s_add_u32 s41, s41, 1048576
    s_add_u32 s42, s42, 2048
    s_mov_b32 m0, 114688
    s_nop 0
    buffer_load_dwordx4 v4, s[24:27], s36 offen offset:0 lds
    buffer_load_dwordx4 v5, s[24:27], s36 offen offset:1024 lds
    buffer_load_dwordx4 v6, s[24:27], s36 offen offset:2048 lds
    buffer_load_dwordx4 v7, s[24:27], s36 offen offset:3072 lds
    s_cmp_ge_u32 s2, 128
    s_cbranch_scc1 conv1_kernel_h7a
    s_mov_b32 s28, s42
    s_add_u32 s29, s42, 1024
    s_add_u32 s30, s42, 491520
    s_add_u32 s31, s42, 492544
    s_mov_b32 s36, s41
    s_branch conv1_kernel_h7b
conv1_kernel_h7a:
    s_mov_b32 s24, s48
    s_mov_b32 s25, s49
    s_mov_b32 s26, 524288
    s_bfe_u32 s56, s2, 0x40003
    s_and_b32 s58, s2, 7
    s_lshl_b32 s59, s56, 15
    s_lshl_b32 s60, s58, 7
    s_add_u32 s36, s59, s60
    s_lshl_b32 s59, s58, 16
    s_lshl_b32 s60, s56, 10
    s_add_u32 s59, s59, s60
    s_add_u32 s28, s59, 12582912
    s_add_u32 s29, s28, 16384
    s_add_u32 s30, s28, 32768
    s_add_u32 s31, s28, 49152
conv1_kernel_h7b:
    s_mov_b32 m0, 118784
    s_nop 0
    buffer_load_dwordx4 v4, s[24:27], s36 offen offset:0 lds
    buffer_load_dwordx4 v5, s[24:27], s36 offen offset:1024 lds
    buffer_load_dwordx4 v6, s[24:27], s36 offen offset:2048 lds
    buffer_load_dwordx4 v7, s[24:27], s36 offen offset:3072 lds
    s_bfe_u32 s56, s2, 0x40003
    s_and_b32 s58, s2, 7
    s_lshl_b32 s59, s56, 15
    s_lshl_b32 s60, s58, 7
    s_add_u32 s36, s59, s60
    s_lshl_b32 s59, s58, 16
    s_mov_b32 s26, 524288
    s_cmp_ge_u32 s2, 128
    s_cbranch_scc1 conv1_kernel_h8a
    s_mov_b32 s24, s50
    s_mov_b32 s25, s51
    s_lshl_b32 s60, s56, 10
    s_add_u32 s59, s59, s60
    s_add_u32 s32, s59, 13107200
    s_add_u32 s33, s32, 16384
    s_add_u32 s34, s32, 32768
    s_add_u32 s35, s32, 49152
    s_branch conv1_kernel_h8b
conv1_kernel_h8a:
    s_mov_b32 s24, s46
    s_mov_b32 s25, s47
    s_lshl_b32 s60, s56, 12
    s_add_u32 s59, s59, s60
    s_add_u32 s32, s59, 13631488
    s_add_u32 s33, s32, 256
    s_add_u32 s34, s32, 1024
    s_add_u32 s35, s32, 1280
    v_mov_b32 v17, v13
conv1_kernel_h8b:
    s_mov_b32 m0, 122880
    s_nop 0
    buffer_load_dwordx4 v4, s[24:27], s36 offen offset:0 lds
    buffer_load_dwordx4 v5, s[24:27], s36 offen offset:1024 lds
    buffer_load_dwordx4 v6, s[24:27], s36 offen offset:2048 lds
    buffer_load_dwordx4 v7, s[24:27], s36 offen offset:3072 lds
    s_waitcnt vmcnt(32)
    ds_read_b64_tr_b16 a[0:1], v8 offset:57344
    ds_read_b64_tr_b16 a[2:3], v8 offset:57600
    ds_read_b64_tr_b16 a[4:5], v9 offset:57344
    ds_read_b64_tr_b16 a[6:7], v9 offset:57600
    ds_read_b64_tr_b16 a[8:9], v10 offset:57344
    ds_read_b64_tr_b16 a[10:11], v10 offset:57600
    ds_read_b64_tr_b16 a[12:13], v11 offset:57344
    ds_read_b64_tr_b16 a[14:15], v11 offset:57600
    s_waitcnt vmcnt(28)
    ds_read_b64_tr_b16 a[16:17], v8 offset:61440
    ds_read_b64_tr_b16 a[18:19], v8 offset:61696
    ds_read_b64_tr_b16 a[20:21], v9 offset:61440
    ds_read_b64_tr_b16 a[22:23], v9 offset:61696
    ds_read_b64_tr_b16 a[24:25], v10 offset:61440
    ds_read_b64_tr_b16 a[26:27], v10 offset:61696
    ds_read_b64_tr_b16 a[28:29], v11 offset:61440
    ds_read_b64_tr_b16 a[30:31], v11 offset:61696
    s_waitcnt lgkmcnt(14)
    buffer_store_dwordx4 a[0:3], v12, s[52:55], s64 offen sc1
    s_waitcnt lgkmcnt(12)
    buffer_store_dwordx4 a[4:7], v12, s[52:55], s65 offen sc1
    s_waitcnt lgkmcnt(10)
    buffer_store_dwordx4 a[8:11], v12, s[52:55], s66 offen sc1
    s_waitcnt lgkmcnt(8)
    buffer_store_dwordx4 a[12:15], v12, s[52:55], s67 offen sc1
    s_waitcnt vmcnt(28)
    ds_read_b64_tr_b16 a[32:33], v8 offset:0
    ds_read_b64_tr_b16 a[34:35], v8 offset:256
    ds_read_b64_tr_b16 a[36:37], v9 offset:0
    ds_read_b64_tr_b16 a[38:39], v9 offset:256
    ds_read_b64_tr_b16 a[40:41], v10 offset:0
    ds_read_b64_tr_b16 a[42:43], v10 offset:256
    ds_read_b64_tr_b16 a[44:45], v11 offset:0
    ds_read_b64_tr_b16 a[46:47], v11 offset:256
    s_waitcnt lgkmcnt(14)
    buffer_store_dwordx4 a[16:19], v12, s[52:55], s68 offen sc1
    s_waitcnt lgkmcnt(12)
    buffer_store_dwordx4 a[20:23], v12, s[52:55], s69 offen sc1
    s_waitcnt lgkmcnt(10)
    buffer_store_dwordx4 a[24:27], v12, s[52:55], s70 offen sc1
    s_waitcnt lgkmcnt(8)
    buffer_store_dwordx4 a[28:31], v12, s[52:55], s71 offen sc1
    s_waitcnt vmcnt(28)
    ds_read_b64_tr_b16 a[48:49], v8 offset:4096
    ds_read_b64_tr_b16 a[50:51], v8 offset:4352
    ds_read_b64_tr_b16 a[52:53], v9 offset:4096
    ds_read_b64_tr_b16 a[54:55], v9 offset:4352
    ds_read_b64_tr_b16 a[56:57], v10 offset:4096
    ds_read_b64_tr_b16 a[58:59], v10 offset:4352
    ds_read_b64_tr_b16 a[60:61], v11 offset:4096
    ds_read_b64_tr_b16 a[62:63], v11 offset:4352
    s_waitcnt lgkmcnt(14)
    buffer_store_dwordx4 a[32:35], v12, s[52:55], s80 offen sc1
    s_waitcnt lgkmcnt(12)
    buffer_store_dwordx4 a[36:39], v12, s[52:55], s81 offen sc1
    s_waitcnt lgkmcnt(10)
    buffer_store_dwordx4 a[40:43], v12, s[52:55], s82 offen sc1
    s_waitcnt lgkmcnt(8)
    buffer_store_dwordx4 a[44:47], v12, s[52:55], s83 offen sc1
    s_waitcnt vmcnt(28)
    ds_read_b64_tr_b16 a[64:65], v8 offset:8192
    ds_read_b64_tr_b16 a[66:67], v8 offset:8448
    ds_read_b64_tr_b16 a[68:69], v9 offset:8192
    ds_read_b64_tr_b16 a[70:71], v9 offset:8448
    ds_read_b64_tr_b16 a[72:73], v10 offset:8192
    ds_read_b64_tr_b16 a[74:75], v10 offset:8448
    ds_read_b64_tr_b16 a[76:77], v11 offset:8192
    ds_read_b64_tr_b16 a[78:79], v11 offset:8448
    s_waitcnt lgkmcnt(14)
    buffer_store_dwordx4 a[48:51], v12, s[52:55], s84 offen sc1
    s_waitcnt lgkmcnt(12)
    buffer_store_dwordx4 a[52:55], v12, s[52:55], s85 offen sc1
    s_waitcnt lgkmcnt(10)
    buffer_store_dwordx4 a[56:59], v12, s[52:55], s86 offen sc1
    s_waitcnt lgkmcnt(8)
    buffer_store_dwordx4 a[60:63], v12, s[52:55], s87 offen sc1
    s_waitcnt vmcnt(28)
    ds_read_b64_tr_b16 v[32:33], v8 offset:12288
    ds_read_b64_tr_b16 v[34:35], v8 offset:12544
    ds_read_b64_tr_b16 v[36:37], v9 offset:12288
    ds_read_b64_tr_b16 v[38:39], v9 offset:12544
    ds_read_b64_tr_b16 v[40:41], v10 offset:12288
    ds_read_b64_tr_b16 v[42:43], v10 offset:12544
    ds_read_b64_tr_b16 v[44:45], v11 offset:12288
    ds_read_b64_tr_b16 v[46:47], v11 offset:12544
    s_waitcnt lgkmcnt(14)
    buffer_store_dwordx4 a[64:67], v12, s[52:55], s88 offen sc1
    s_waitcnt lgkmcnt(12)
    buffer_store_dwordx4 a[68:71], v12, s[52:55], s89 offen sc1
    s_waitcnt lgkmcnt(10)
    buffer_store_dwordx4 a[72:75], v12, s[52:55], s90 offen sc1
    s_waitcnt lgkmcnt(8)
    buffer_store_dwordx4 a[76:79], v12, s[52:55], s91 offen sc1
    s_waitcnt vmcnt(28)
    ds_read_b64_tr_b16 v[48:49], v8 offset:16384
    ds_read_b64_tr_b16 v[50:51], v8 offset:16640
    ds_read_b64_tr_b16 v[52:53], v9 offset:16384
    ds_read_b64_tr_b16 v[54:55], v9 offset:16640
    ds_read_b64_tr_b16 v[56:57], v10 offset:16384
    ds_read_b64_tr_b16 v[58:59], v10 offset:16640
    ds_read_b64_tr_b16 v[60:61], v11 offset:16384
    ds_read_b64_tr_b16 v[62:63], v11 offset:16640
    s_waitcnt lgkmcnt(14)
    buffer_store_dwordx4 v[32:35], v12, s[52:55], s92 offen sc1
    s_waitcnt lgkmcnt(12)
    buffer_store_dwordx4 v[36:39], v12, s[52:55], s93 offen sc1
    s_waitcnt lgkmcnt(10)
    buffer_store_dwordx4 v[40:43], v12, s[52:55], s94 offen sc1
    s_waitcnt lgkmcnt(8)
    buffer_store_dwordx4 v[44:47], v12, s[52:55], s95 offen sc1
    s_waitcnt vmcnt(28)
    ds_read_b64_tr_b16 v[64:65], v8 offset:20480
    ds_read_b64_tr_b16 v[66:67], v8 offset:20736
    ds_read_b64_tr_b16 v[68:69], v9 offset:20480
    ds_read_b64_tr_b16 v[70:71], v9 offset:20736
    ds_read_b64_tr_b16 v[72:73], v10 offset:20480
    ds_read_b64_tr_b16 v[74:75], v10 offset:20736
    ds_read_b64_tr_b16 v[76:77], v11 offset:20480
    ds_read_b64_tr_b16 v[78:79], v11 offset:20736
    s_waitcnt lgkmcnt(14)
    buffer_store_dwordx4 v[48:51], v12, s[52:55], s96 offen sc1
    s_waitcnt lgkmcnt(12)
    buffer_store_dwordx4 v[52:55], v12, s[52:55], s97 offen sc1
    s_waitcnt lgkmcnt(10)
    buffer_store_dwordx4 v[56:59], v12, s[52:55], s98 offen sc1
    s_waitcnt lgkmcnt(8)
    buffer_store_dwordx4 v[60:63], v12, s[52:55], s99 offen sc1
    s_waitcnt vmcnt(28)
    ds_read_b64_tr_b16 v[80:81], v8 offset:24576
    ds_read_b64_tr_b16 v[82:83], v8 offset:24832
    ds_read_b64_tr_b16 v[84:85], v9 offset:24576
    ds_read_b64_tr_b16 v[86:87], v9 offset:24832
    ds_read_b64_tr_b16 v[88:89], v10 offset:24576
    ds_read_b64_tr_b16 v[90:91], v10 offset:24832
    ds_read_b64_tr_b16 v[92:93], v11 offset:24576
    ds_read_b64_tr_b16 v[94:95], v11 offset:24832
    s_waitcnt lgkmcnt(14)
    buffer_store_dwordx4 v[64:67], v12, s[52:55], s28 offen sc1
    s_waitcnt lgkmcnt(12)
    buffer_store_dwordx4 v[68:71], v12, s[52:55], s29 offen sc1
    s_waitcnt lgkmcnt(10)
    buffer_store_dwordx4 v[72:75], v12, s[52:55], s30 offen sc1
    s_waitcnt lgkmcnt(8)
    buffer_store_dwordx4 v[76:79], v12, s[52:55], s31 offen sc1
    s_waitcnt lgkmcnt(6)
    buffer_store_dwordx4 v[80:83], v17, s[52:55], s32 offen sc1
    s_waitcnt lgkmcnt(4)
    buffer_store_dwordx4 v[84:87], v17, s[52:55], s33 offen sc1
    s_waitcnt lgkmcnt(2)
    buffer_store_dwordx4 v[88:91], v17, s[52:55], s34 offen sc1
    s_waitcnt lgkmcnt(0)
    buffer_store_dwordx4 v[92:95], v17, s[52:55], s35 offen sc1
    s_cmp_lt_u32 s2, 128
    s_cbranch_scc1 conv1_kernel_h_done
    v_mov_b32 v96, 0x3f803f80
    v_mov_b32 v97, 0x3f803f80
    v_mov_b32 v98, 0x3f803f80
    v_mov_b32 v99, 0x3f803f80
    s_add_u32 s72, s20, 21102592
    s_addc_u32 s73, s21, 0
    s_mov_b32 s74, 32768
    s_mov_b32 s75, 0x20000
    s_bfe_u32 s56, s2, 0x40003
    s_and_b32 s58, s2, 7
    s_lshl_b32 s56, s56, 11
    s_lshl_b32 s58, s58, 8
    s_add_u32 s56, s56, s58
    v_lshrrev_b32 v20, 4, v2
    v_lshlrev_b32 v20, 4, v20
    v_and_b32 v21, 15, v2
    v_cmp_eq_u32 vcc, 0, v21
    v_mfma_f32_16x16x32_bf16 v[100:103], v[80:83], v[96:99], 0
    v_mfma_f32_16x16x32_bf16 v[104:107], v[84:87], v[96:99], 0
    v_mfma_f32_16x16x32_bf16 v[108:111], v[88:91], v[96:99], 0
    v_mfma_f32_16x16x32_bf16 v[112:115], v[92:95], v[96:99], 0
    s_nop 7
    s_nop 1
    s_and_saveexec_b64 s[60:61], vcc
    buffer_store_dwordx4 v[100:103], v20, s[72:75], s56 offen offset:0
    buffer_store_dwordx4 v[104:107], v20, s[72:75], s56 offen offset:64
    buffer_store_dwordx4 v[108:111], v20, s[72:75], s56 offen offset:128
    buffer_store_dwordx4 v[112:115], v20, s[72:75], s56 offen offset:192
    s_mov_b64 exec, s[60:61]
conv1_kernel_h_done:
    s_waitcnt vmcnt(0)
    s_endpgm
.globl conv2_kernel
.p2align 8
.type conv2_kernel,@function
conv2_kernel:
    s_cmp_ge_u32 s2, 256
    s_cbranch_scc1 conv2_kernel_end
    s_getpc_b64 s[56:57]
conv2_kernel_pc:
    s_mov_b32 s58, conv2_kernel_end-conv2_kernel_pc
    s_mov_b32 s59, 0x20000
    v_lshlrev_b32 v5, 7, v0
    buffer_load_dword v33, v5, s[56:59], 0 offen
    s_load_dwordx2 s[20:21], s[0:1], 72
    v_lshrrev_b32 v1, 6, v0
    v_and_b32 v2, 63, v0
    s_and_b32 s41, s2, 7
    s_lshr_b32 s42, s2, 3
    v_readfirstlane_b32 s28, v1
    s_lshr_b32 s43, s41, 1
    s_lshl_b32 s43, s43, 2
    s_and_b32 s44, s42, 3
    s_add_u32 s43, s43, s44
    s_and_b32 s40, s41, 1
    s_lshr_b32 s45, s42, 2
    s_mul_i32 s38, s45, 125
    s_lshl_b32 s39, s43, 6
    s_mov_b32 s37, 1073741824
    s_waitcnt lgkmcnt(0)
    s_cmp_eq_u32 s28, 4
    s_cbranch_scc1 conv2_kernel_helper
    s_mul_i32 s46, s40, 2048000
    s_add_u32 s46, s46, 0
    s_add_u32 s8, s20, s46
    s_addc_u32 s9, s21, 0
    s_mov_b32 s10, 2048000
    s_mov_b32 s11, 0x20000
    s_lshl_b32 s46, s43, 2
    s_add_u32 s46, s46, s28
    s_mul_i32 s46, s46, 122880
    s_add_u32 s46, s46, 4194304
    s_add_u32 s12, s20, s46
    s_addc_u32 s13, s21, 0
    s_mov_b32 s14, 122880
    s_mov_b32 s15, 0x20000
    s_mul_i32 s46, s40, 1024000
    s_add_u32 s46, s46, 14680064
    s_add_u32 s16, s20, s46
    s_addc_u32 s17, s21, 0
    s_mov_b32 s18, 1024000
    s_mov_b32 s19, 0x20000
    s_lshl_b32 s46, s38, 11
    s_lshl_b32 s47, s28, 13
    s_add_u32 s46, s46, s47
    s_sub_u32 s31, s46, 8192
    s_cmp_eq_u32 s46, 0
    s_cselect_b32 s32, 0, s31
    s_cselect_b32 s48, 1, 0
    s_lshl_b32 s33, s28, 10
    v_lshrrev_b32 v3, 4, v2
    v_and_b32 v20, 15, v2
    v_lshlrev_b32 v21, 11, v3
    v_add_u32 v21, 1024, v21
    s_lshr_b32 s49, s28, 1
    s_add_u32 s50, s49, 0
    s_and_b32 s50, s50, 7
    s_lshl_b32 s50, s50, 1
    v_xor_b32 v22, s50, v20
    v_lshl_add_u32 v4, v22, 4, v21
    s_add_u32 s50, s49, 2
    s_and_b32 s50, s50, 7
    s_lshl_b32 s50, s50, 1
    v_xor_b32 v22, s50, v20
    v_lshl_add_u32 v5, v22, 4, v21
    s_add_u32 s50, s49, 4
    s_and_b32 s50, s50, 7
    s_lshl_b32 s50, s50, 1
    v_xor_b32 v22, s50, v20
    v_lshl_add_u32 v6, v22, 4, v21
    s_add_u32 s50, s49, 6
    s_and_b32 s50, s50, 7
    s_lshl_b32 s50, s50, 1
    v_xor_b32 v22, s50, v20
    v_lshl_add_u32 v7, v22, 4, v21
    v_mov_b32 v8, v4
    v_add_u32 v9, 1024, v4
    s_cmp_eq_u32 s48, 0
    s_cbranch_scc1 conv2_kernel_nospecial
    v_mov_b32 v8, s37
    v_lshlrev_b32 v22, 4, v20
    v_mov_b32 v23, s37
    v_cmp_eq_u32 vcc, 3, v3
    s_nop 1
    v_cndmask_b32 v9, v23, v22, vcc
conv2_kernel_nospecial:
    s_add_u32 m0, s33, 0
    s_nop 0
    buffer_load_dwordx4 v8, s[8:11], s32 offen lds
    s_add_u32 m0, s33, 4096
    s_add_u32 s36, s31, 32768
    buffer_load_dwordx4 v5, s[8:11], s36 offen lds
    s_add_u32 m0, s33, 8192
    s_add_u32 s36, s31, 65536
    buffer_load_dwordx4 v6, s[8:11], s36 offen lds
    s_add_u32 m0, s33, 12288
    s_add_u32 s36, s31, 98304
    buffer_load_dwordx4 v7, s[8:11], s36 offen lds
    s_add_u32 m0, s33, 16384
    s_add_u32 s36, s31, 131072
    buffer_load_dwordx4 v4, s[8:11], s36 offen lds
    s_add_u32 m0, s33, 20480
    s_add_u32 s36, s31, 163840
    buffer_load_dwordx4 v5, s[8:11], s36 offen lds
    s_add_u32 m0, s33, 24576
    s_add_u32 s36, s31, 196608
    buffer_load_dwordx4 v6, s[8:11], s36 offen lds
    s_add_u32 m0, s33, 28672
    s_add_u32 s36, s31, 229376
    buffer_load_dwordx4 v7, s[8:11], s36 offen lds
    s_add_u32 m0, s33, 32768
    s_add_u32 s36, s31, 262144
    buffer_load_dwordx4 v4, s[8:11], s36 offen lds
    v_lshlrev_b32 v12, 4, v2
    s_mov_b32 s29, 0
    buffer_load_dwordx4 a[72:75], v12, s[12:15], s29 offen offset:0
    s_add_u32 m0, s33, 36864
    s_nop 0
    buffer_load_dwordx4 v9, s[8:11], s32 offen lds
    s_add_u32 m0, s33, 45056
    s_add_u32 s36, s31, 66560
    buffer_load_dwordx4 v6, s[8:11], s36 offen lds
    buffer_load_dwordx4 a[76:79], v12, s[12:15], s29 offen offset:1024
    s_add_u32 s29, s29, 2048
    s_add_u32 m0, s33, 40960
    s_add_u32 s36, s31, 33792
    buffer_load_dwordx4 v5, s[8:11], s36 offen lds
    buffer_load_dwordx4 a[80:83], v12, s[12:15], s29 offen offset:0
    s_add_u32 m0, s33, 49152
    s_add_u32 s36, s31, 99328
    buffer_load_dwordx4 v7, s[8:11], s36 offen lds
    buffer_load_dwordx4 a[84:87], v12, s[12:15], s29 offen offset:1024
    s_add_u32 s29, s29, 2048
    s_add_u32 m0, s33, 53248
    s_add_u32 s36, s31, 132096
    buffer_load_dwordx4 v4, s[8:11], s36 offen lds
    buffer_load_dwordx4 a[88:91], v12, s[12:15], s29 offen offset:0
    s_add_u32 m0, s33, 57344
    s_add_u32 s36, s31, 164864
    buffer_load_dwordx4 v5, s[8:11], s36 offen lds
    buffer_load_dwordx4 a[92:95], v12, s[12:15], s29 offen offset:1024
    s_add_u32 s29, s29, 2048
    s_add_u32 m0, s33, 61440
    s_add_u32 s36, s31, 197632
    buffer_load_dwordx4 v6, s[8:11], s36 offen lds
    buffer_load_dwordx4 a[96:99], v12, s[12:15], s29 offen offset:0
    s_add_u32 m0, s33, 65536
    s_add_u32 s36, s31, 230400
    buffer_load_dwordx4 v7, s[8:11], s36 offen lds
    buffer_load_dwordx4 a[100:103], v12, s[12:15], s29 offen offset:1024
    s_add_u32 s29, s29, 2048
    s_add_u32 m0, s33, 69632
    s_add_u32 s36, s31, 263168
    buffer_load_dwordx4 v4, s[8:11], s36 offen lds
    s_add_u32 s31, s31, 256
    s_add_u32 s32, s32, 256
    s_mov_b32 s35, 0
    s_lshl_b32 s50, s28, 2
    v_add_u32 v22, s50, v3
    v_add_u32 v23, 0, v20
    v_and_b32 v23, 7, v23
    v_lshlrev_b32 v23, 1, v23
    v_xor_b32 v23, v23, v22
    v_lshlrev_b32 v23, 4, v23
    v_lshl_add_u32 v10, v20, 11, v23
    v_add_u32 v23, 1, v20
    v_and_b32 v23, 7, v23
    v_lshlrev_b32 v23, 1, v23
    v_xor_b32 v23, v23, v22
    v_lshlrev_b32 v23, 4, v23
    v_lshl_add_u32 v11, v20, 11, v23
    v_mov_b32 v40, 0
    v_mov_b32 v41, 0
    v_mov_b32 v42, 0
    v_mov_b32 v43, 0
    v_mov_b32 v44, 0
    v_mov_b32 v45, 0
    v_mov_b32 v46, 0
    v_mov_b32 v47, 0
    v_mov_b32 v48, 0
    v_mov_b32 v49, 0
    v_mov_b32 v50, 0
    v_mov_b32 v51, 0
    v_mov_b32 v52, 0
    v_mov_b32 v53, 0
    v_mov_b32 v54, 0
    v_mov_b32 v55, 0
    v_mov_b32 v56, 0
    v_mov_b32 v57, 0
    v_mov_b32 v58, 0
    v_mov_b32 v59, 0
    v_mov_b32 v60, 0
    v_mov_b32 v61, 0
    v_mov_b32 v62, 0
    v_mov_b32 v63, 0
    v_mov_b32 v64, 0
    v_mov_b32 v65, 0
    v_mov_b32 v66, 0
    v_mov_b32 v67, 0
    v_mov_b32 v68, 0
    v_mov_b32 v69, 0
    v_mov_b32 v70, 0
    v_mov_b32 v71, 0
    v_mov_b32 v72, 0
    v_mov_b32 v73, 0
    v_mov_b32 v74, 0
    v_mov_b32 v75, 0
    v_mov_b32 v76, 0
    v_mov_b32 v77, 0
    v_mov_b32 v78, 0
    v_mov_b32 v79, 0
    v_mov_b32 v80, 0
    v_mov_b32 v81, 0
    v_mov_b32 v82, 0
    v_mov_b32 v83, 0
    v_mov_b32 v84, 0
    v_mov_b32 v85, 0
    v_mov_b32 v86, 0
    v_mov_b32 v87, 0
    v_mov_b32 v88, 0
    v_mov_b32 v89, 0
    v_mov_b32 v90, 0
    v_mov_b32 v91, 0
    v_mov_b32 v92, 0
    v_mov_b32 v93, 0
    v_mov_b32 v94, 0
    v_mov_b32 v95, 0
    v_mov_b32 v96, 0
    v_mov_b32 v97, 0
    v_mov_b32 v98, 0
    v_mov_b32 v99, 0
    v_mov_b32 v100, 0
    v_mov_b32 v101, 0
    v_mov_b32 v102, 0
    v_mov_b32 v103, 0
    s_waitcnt vmcnt(17)
    s_barrier
    ds_read_b128 a[24:27], v10 offset:0
    ds_read_b128 a[28:31], v10 offset:256
    ds_read_b128 a[32:35], v10 offset:512
    ds_read_b128 a[36:39], v10 offset:768
    ds_read_b128 a[40:43], v10 offset:1024
    ds_read_b128 a[44:47], v10 offset:1280
    ds_read_b128 a[60:63], v10 offset:1536
    ds_read_b128 a[64:67], v10 offset:1792
    s_waitcnt lgkmcnt(0)
conv2_kernel_loop:
    s_waitcnt vmcnt(16)
    s_waitcnt lgkmcnt(7)
    v_mfma_f32_16x16x32_bf16 v[40:43], a[72:75], a[24:27], v[40:43]
    s_waitcnt lgkmcnt(6)
    v_mfma_f32_16x16x32_bf16 v[48:51], a[72:75], a[28:31], v[48:51]
    buffer_load_dwordx4 a[104:107], v12, s[12:15], s29 offen offset:0
    s_waitcnt lgkmcnt(5)
    v_mfma_f32_16x16x32_bf16 v[56:59], a[72:75], a[32:35], v[56:59]
    s_waitcnt lgkmcnt(4)
    v_mfma_f32_16x16x32_bf16 v[64:67], a[72:75], a[36:39], v[64:67]
    ds_read_b128 a[0:3], v11 offset:2048
    s_waitcnt lgkmcnt(4)
    v_mfma_f32_16x16x32_bf16 v[72:75], a[72:75], a[40:43], v[72:75]
    s_waitcnt lgkmcnt(3)
    v_mfma_f32_16x16x32_bf16 v[80:83], a[72:75], a[44:47], v[80:83]
    s_waitcnt lgkmcnt(2)
    v_mfma_f32_16x16x32_bf16 v[88:91], a[72:75], a[60:63], v[88:91]
    s_waitcnt lgkmcnt(1)
    v_mfma_f32_16x16x32_bf16 v[96:99], a[72:75], a[64:67], v[96:99]
    s_waitcnt vmcnt(14)
    v_mfma_f32_16x16x32_bf16 v[44:47], a[76:79], a[24:27], v[44:47]
    v_mfma_f32_16x16x32_bf16 v[52:55], a[76:79], a[28:31], v[52:55]
    buffer_load_dwordx4 a[108:111], v12, s[12:15], s29 offen offset:1024
    s_add_u32 s29, s29, 2048
    v_mfma_f32_16x16x32_bf16 v[60:63], a[76:79], a[32:35], v[60:63]
    v_mfma_f32_16x16x32_bf16 v[68:71], a[76:79], a[36:39], v[68:71]
    ds_read_b128 a[4:7], v11 offset:2304
    v_mfma_f32_16x16x32_bf16 v[76:79], a[76:79], a[40:43], v[76:79]
    v_mfma_f32_16x16x32_bf16 v[84:87], a[76:79], a[44:47], v[84:87]
    v_mfma_f32_16x16x32_bf16 v[92:95], a[76:79], a[60:63], v[92:95]
    v_mfma_f32_16x16x32_bf16 v[100:103], a[76:79], a[64:67], v[100:103]
    s_waitcnt vmcnt(13)
    v_mfma_f32_16x16x32_bf16 v[40:43], a[80:83], a[28:31], v[40:43]
    v_mfma_f32_16x16x32_bf16 v[48:51], a[80:83], a[32:35], v[48:51]
    buffer_load_dwordx4 a[72:75], v12, s[12:15], s29 offen offset:0
    v_mfma_f32_16x16x32_bf16 v[56:59], a[80:83], a[36:39], v[56:59]
    v_mfma_f32_16x16x32_bf16 v[64:67], a[80:83], a[40:43], v[64:67]
    ds_read_b128 a[8:11], v11 offset:2560
    v_mfma_f32_16x16x32_bf16 v[72:75], a[80:83], a[44:47], v[72:75]
    v_mfma_f32_16x16x32_bf16 v[80:83], a[80:83], a[60:63], v[80:83]
    v_mfma_f32_16x16x32_bf16 v[88:91], a[80:83], a[64:67], v[88:91]
    s_waitcnt lgkmcnt(2)
    v_mfma_f32_16x16x32_bf16 v[96:99], a[80:83], a[0:3], v[96:99]
    s_waitcnt vmcnt(12)
    v_mfma_f32_16x16x32_bf16 v[44:47], a[84:87], a[28:31], v[44:47]
    v_mfma_f32_16x16x32_bf16 v[52:55], a[84:87], a[32:35], v[52:55]
    buffer_load_dwordx4 a[76:79], v12, s[12:15], s29 offen offset:1024
    s_add_u32 s29, s29, 2048
    v_mfma_f32_16x16x32_bf16 v[60:63], a[84:87], a[36:39], v[60:63]
    v_mfma_f32_16x16x32_bf16 v[68:71], a[84:87], a[40:43], v[68:71]
    ds_read_b128 a[12:15], v11 offset:2816
    v_mfma_f32_16x16x32_bf16 v[76:79], a[84:87], a[44:47], v[76:79]
    v_mfma_f32_16x16x32_bf16 v[84:87], a[84:87], a[60:63], v[84:87]
    v_mfma_f32_16x16x32_bf16 v[92:95], a[84:87], a[64:67], v[92:95]
    v_mfma_f32_16x16x32_bf16 v[100:103], a[84:87], a[0:3], v[100:103]
    s_waitcnt vmcnt(11)
    v_mfma_f32_16x16x32_bf16 v[40:43], a[88:91], a[32:35], v[40:43]
    v_mfma_f32_16x16x32_bf16 v[48:51], a[88:91], a[36:39], v[48:51]
    buffer_load_dwordx4 a[80:83], v12, s[12:15], s29 offen offset:0
    v_mfma_f32_16x16x32_bf16 v[56:59], a[88:91], a[40:43], v[56:59]
    v_mfma_f32_16x16x32_bf16 v[64:67], a[88:91], a[44:47], v[64:67]
    ds_read_b128 a[16:19], v11 offset:3072
    v_mfma_f32_16x16x32_bf16 v[72:75], a[88:91], a[60:63], v[72:75]
    v_mfma_f32_16x16x32_bf16 v[80:83], a[88:91], a[64:67], v[80:83]
    v_mfma_f32_16x16x32_bf16 v[88:91], a[88:91], a[0:3], v[88:91]
    s_waitcnt lgkmcnt(3)
    v_mfma_f32_16x16x32_bf16 v[96:99], a[88:91], a[4:7], v[96:99]
    s_waitcnt vmcnt(10)
    v_mfma_f32_16x16x32_bf16 v[44:47], a[92:95], a[32:35], v[44:47]
    v_mfma_f32_16x16x32_bf16 v[52:55], a[92:95], a[36:39], v[52:55]
    buffer_load_dwordx4 a[84:87], v12, s[12:15], s29 offen offset:1024
    s_add_u32 s29, s29, 2048
    v_mfma_f32_16x16x32_bf16 v[60:63], a[92:95], a[40:43], v[60:63]
    v_mfma_f32_16x16x32_bf16 v[68:71], a[92:95], a[44:47], v[68:71]
    ds_read_b128 a[20:23], v11 offset:3328
    v_mfma_f32_16x16x32_bf16 v[76:79], a[92:95], a[60:63], v[76:79]
    v_mfma_f32_16x16x32_bf16 v[84:87], a[92:95], a[64:67], v[84:87]
    v_mfma_f32_16x16x32_bf16 v[92:95], a[92:95], a[0:3], v[92:95]
    v_mfma_f32_16x16x32_bf16 v[100:103], a[92:95], a[4:7], v[100:103]
    s_waitcnt vmcnt(9)
    v_mfma_f32_16x16x32_bf16 v[40:43], a[96:99], a[36:39], v[40:43]
    v_mfma_f32_16x16x32_bf16 v[48:51], a[96:99], a[40:43], v[48:51]
    buffer_load_dwordx4 a[88:91], v12, s[12:15], s29 offen offset:0
    v_mfma_f32_16x16x32_bf16 v[56:59], a[96:99], a[44:47], v[56:59]
    v_mfma_f32_16x16x32_bf16 v[64:67], a[96:99], a[60:63], v[64:67]
    ds_read_b128 a[24:27], v11 offset:3584
    v_mfma_f32_16x16x32_bf16 v[72:75], a[96:99], a[64:67], v[72:75]
    v_mfma_f32_16x16x32_bf16 v[80:83], a[96:99], a[0:3], v[80:83]
    v_mfma_f32_16x16x32_bf16 v[88:91], a[96:99], a[4:7], v[88:91]
    s_waitcnt lgkmcnt(4)
    v_mfma_f32_16x16x32_bf16 v[96:99], a[96:99], a[8:11], v[96:99]
    s_waitcnt vmcnt(8)
    v_mfma_f32_16x16x32_bf16 v[44:47], a[100:103], a[36:39], v[44:47]
    v_mfma_f32_16x16x32_bf16 v[52:55], a[100:103], a[40:43], v[52:55]
    buffer_load_dwordx4 a[92:95], v12, s[12:15], s29 offen offset:1024
    s_add_u32 s29, s29, 2048
    v_mfma_f32_16x16x32_bf16 v[60:63], a[100:103], a[44:47], v[60:63]
    v_mfma_f32_16x16x32_bf16 v[68:71], a[100:103], a[60:63], v[68:71]
    v_mfma_f32_16x16x32_bf16 v[76:79], a[100:103], a[64:67], v[76:79]
    v_mfma_f32_16x16x32_bf16 v[84:87], a[100:103], a[0:3], v[84:87]
    v_mfma_f32_16x16x32_bf16 v[92:95], a[100:103], a[4:7], v[92:95]
    v_mfma_f32_16x16x32_bf16 v[100:103], a[100:103], a[8:11], v[100:103]
    s_waitcnt lgkmcnt(0)
    s_waitcnt vmcnt(8)
    s_barrier
    s_waitcnt vmcnt(7)
    v_mfma_f32_16x16x32_bf16 v[40:43], a[104:107], a[40:43], v[40:43]
    v_mfma_f32_16x16x32_bf16 v[48:51], a[104:107], a[44:47], v[48:51]
    buffer_load_dwordx4 a[96:99], v12, s[12:15], s29 offen offset:0
    v_mfma_f32_16x16x32_bf16 v[56:59], a[104:107], a[60:63], v[56:59]
    v_mfma_f32_16x16x32_bf16 v[64:67], a[104:107], a[64:67], v[64:67]
    ds_read_b128 a[28:31], v10 offset:36864
    v_mfma_f32_16x16x32_bf16 v[72:75], a[104:107], a[0:3], v[72:75]
    s_add_u32 m0, s33, 0
    s_nop 0
    v_mfma_f32_16x16x32_bf16 v[80:83], a[104:107], a[4:7], v[80:83]
    buffer_load_dwordx4 v8, s[8:11], s32 offen lds
    v_mfma_f32_16x16x32_bf16 v[88:91], a[104:107], a[8:11], v[88:91]
    v_mfma_f32_16x16x32_bf16 v[96:99], a[104:107], a[12:15], v[96:99]
    s_waitcnt vmcnt(8)
    v_mfma_f32_16x16x32_bf16 v[44:47], a[108:111], a[40:43], v[44:47]
    v_mfma_f32_16x16x32_bf16 v[52:55], a[108:111], a[44:47], v[52:55]
    buffer_load_dwordx4 a[100:103], v12, s[12:15], s29 offen offset:1024
    s_add_u32 s29, s29, 2048
    v_mfma_f32_16x16x32_bf16 v[60:63], a[108:111], a[60:63], v[60:63]
    v_mfma_f32_16x16x32_bf16 v[68:71], a[108:111], a[64:67], v[68:71]
    ds_read_b128 a[32:35], v10 offset:37120
    v_mfma_f32_16x16x32_bf16 v[76:79], a[108:111], a[0:3], v[76:79]
    s_add_u32 m0, s33, 4096
    s_add_u32 s36, s31, 32768
    v_mfma_f32_16x16x32_bf16 v[84:87], a[108:111], a[4:7], v[84:87]
    buffer_load_dwordx4 v5, s[8:11], s36 offen lds
    v_mfma_f32_16x16x32_bf16 v[92:95], a[108:111], a[8:11], v[92:95]
    v_mfma_f32_16x16x32_bf16 v[100:103], a[108:111], a[12:15], v[100:103]
    s_waitcnt vmcnt(9)
    v_mfma_f32_16x16x32_bf16 v[40:43], a[72:75], a[44:47], v[40:43]
    v_mfma_f32_16x16x32_bf16 v[48:51], a[72:75], a[60:63], v[48:51]
    buffer_load_dwordx4 a[104:107], v12, s[12:15], s29 offen offset:0
    v_mfma_f32_16x16x32_bf16 v[56:59], a[72:75], a[64:67], v[56:59]
    v_mfma_f32_16x16x32_bf16 v[64:67], a[72:75], a[0:3], v[64:67]
    ds_read_b128 a[36:39], v10 offset:37376
    v_mfma_f32_16x16x32_bf16 v[72:75], a[72:75], a[4:7], v[72:75]
    s_add_u32 m0, s33, 8192
    s_add_u32 s36, s31, 65536
    v_mfma_f32_16x16x32_bf16 v[80:83], a[72:75], a[8:11], v[80:83]
    buffer_load_dwordx4 v6, s[8:11], s36 offen lds
    v_mfma_f32_16x16x32_bf16 v[88:91], a[72:75], a[12:15], v[88:91]
    v_mfma_f32_16x16x32_bf16 v[96:99], a[72:75], a[16:19], v[96:99]
    s_waitcnt vmcnt(10)
    v_mfma_f32_16x16x32_bf16 v[44:47], a[76:79], a[44:47], v[44:47]
    v_mfma_f32_16x16x32_bf16 v[52:55], a[76:79], a[60:63], v[52:55]
    buffer_load_dwordx4 a[108:111], v12, s[12:15], s29 offen offset:1024
    s_add_u32 s29, s29, 2048
    v_mfma_f32_16x16x32_bf16 v[60:63], a[76:79], a[64:67], v[60:63]
    v_mfma_f32_16x16x32_bf16 v[68:71], a[76:79], a[0:3], v[68:71]
    ds_read_b128 a[40:43], v10 offset:37632
    v_mfma_f32_16x16x32_bf16 v[76:79], a[76:79], a[4:7], v[76:79]
    s_add_u32 m0, s33, 12288
    s_add_u32 s36, s31, 98304
    v_mfma_f32_16x16x32_bf16 v[84:87], a[76:79], a[8:11], v[84:87]
    buffer_load_dwordx4 v7, s[8:11], s36 offen lds
    v_mfma_f32_16x16x32_bf16 v[92:95], a[76:79], a[12:15], v[92:95]
    v_mfma_f32_16x16x32_bf16 v[100:103], a[76:79], a[16:19], v[100:103]
    s_waitcnt vmcnt(11)
    v_mfma_f32_16x16x32_bf16 v[40:43], a[80:83], a[60:63], v[40:43]
    v_mfma_f32_16x16x32_bf16 v[48:51], a[80:83], a[64:67], v[48:51]
    buffer_load_dwordx4 a[72:75], v12, s[12:15], s29 offen offset:0
    v_mfma_f32_16x16x32_bf16 v[56:59], a[80:83], a[0:3], v[56:59]
    v_mfma_f32_16x16x32_bf16 v[64:67], a[80:83], a[4:7], v[64:67]
    ds_read_b128 a[44:47], v10 offset:37888
    v_mfma_f32_16x16x32_bf16 v[72:75], a[80:83], a[8:11], v[72:75]
    s_add_u32 m0, s33, 16384
    s_add_u32 s36, s31, 131072
    v_mfma_f32_16x16x32_bf16 v[80:83], a[80:83], a[12:15], v[80:83]
    buffer_load_dwordx4 v4, s[8:11], s36 offen lds
    v_mfma_f32_16x16x32_bf16 v[88:91], a[80:83], a[16:19], v[88:91]
    v_mfma_f32_16x16x32_bf16 v[96:99], a[80:83], a[20:23], v[96:99]
    s_waitcnt vmcnt(12)
    v_mfma_f32_16x16x32_bf16 v[44:47], a[84:87], a[60:63], v[44:47]
    v_mfma_f32_16x16x32_bf16 v[52:55], a[84:87], a[64:67], v[52:55]
    buffer_load_dwordx4 a[76:79], v12, s[12:15], s29 offen offset:1024
    s_add_u32 s29, s29, 2048
    v_mfma_f32_16x16x32_bf16 v[60:63], a[84:87], a[0:3], v[60:63]
    v_mfma_f32_16x16x32_bf16 v[68:71], a[84:87], a[4:7], v[68:71]
    ds_read_b128 a[48:51], v10 offset:38144
    v_mfma_f32_16x16x32_bf16 v[76:79], a[84:87], a[8:11], v[76:79]
    s_add_u32 m0, s33, 20480
    s_add_u32 s36, s31, 163840
    v_mfma_f32_16x16x32_bf16 v[84:87], a[84:87], a[12:15], v[84:87]
    buffer_load_dwordx4 v5, s[8:11], s36 offen lds
    v_mfma_f32_16x16x32_bf16 v[92:95], a[84:87], a[16:19], v[92:95]
    v_mfma_f32_16x16x32_bf16 v[100:103], a[84:87], a[20:23], v[100:103]
    s_waitcnt vmcnt(13)
    v_mfma_f32_16x16x32_bf16 v[40:43], a[88:91], a[64:67], v[40:43]
    v_mfma_f32_16x16x32_bf16 v[48:51], a[88:91], a[0:3], v[48:51]
    buffer_load_dwordx4 a[80:83], v12, s[12:15], s29 offen offset:0
    v_mfma_f32_16x16x32_bf16 v[56:59], a[88:91], a[4:7], v[56:59]
    v_mfma_f32_16x16x32_bf16 v[64:67], a[88:91], a[8:11], v[64:67]
    ds_read_b128 a[52:55], v10 offset:38400
    v_mfma_f32_16x16x32_bf16 v[72:75], a[88:91], a[12:15], v[72:75]
    s_add_u32 m0, s33, 24576
    s_add_u32 s36, s31, 196608
    v_mfma_f32_16x16x32_bf16 v[80:83], a[88:91], a[16:19], v[80:83]
    buffer_load_dwordx4 v6, s[8:11], s36 offen lds
    v_mfma_f32_16x16x32_bf16 v[88:91], a[88:91], a[20:23], v[88:91]
    v_mfma_f32_16x16x32_bf16 v[96:99], a[88:91], a[24:27], v[96:99]
    s_waitcnt vmcnt(14)
    v_mfma_f32_16x16x32_bf16 v[44:47], a[92:95], a[64:67], v[44:47]
    v_mfma_f32_16x16x32_bf16 v[52:55], a[92:95], a[0:3], v[52:55]
    buffer_load_dwordx4 a[84:87], v12, s[12:15], s29 offen offset:1024
    s_add_u32 s29, s29, 2048
    v_mfma_f32_16x16x32_bf16 v[60:63], a[92:95], a[4:7], v[60:63]
    v_mfma_f32_16x16x32_bf16 v[68:71], a[92:95], a[8:11], v[68:71]
    ds_read_b128 a[56:59], v10 offset:38656
    v_mfma_f32_16x16x32_bf16 v[76:79], a[92:95], a[12:15], v[76:79]
    s_add_u32 m0, s33, 28672
    s_add_u32 s36, s31, 229376
    v_mfma_f32_16x16x32_bf16 v[84:87], a[92:95], a[16:19], v[84:87]
    buffer_load_dwordx4 v7, s[8:11], s36 offen lds
    v_mfma_f32_16x16x32_bf16 v[92:95], a[92:95], a[20:23], v[92:95]
    v_mfma_f32_16x16x32_bf16 v[100:103], a[92:95], a[24:27], v[100:103]
    s_waitcnt vmcnt(15)
    s_waitcnt lgkmcnt(7)
    v_mfma_f32_16x16x32_bf16 v[40:43], a[96:99], a[28:31], v[40:43]
    s_waitcnt lgkmcnt(6)
    v_mfma_f32_16x16x32_bf16 v[48:51], a[96:99], a[32:35], v[48:51]
    buffer_load_dwordx4 a[88:91], v12, s[12:15], s29 offen offset:0
    s_waitcnt lgkmcnt(5)
    v_mfma_f32_16x16x32_bf16 v[56:59], a[96:99], a[36:39], v[56:59]
    s_waitcnt lgkmcnt(4)
    v_mfma_f32_16x16x32_bf16 v[64:67], a[96:99], a[40:43], v[64:67]
    ds_read_b128 a[0:3], v11 offset:38912
    s_waitcnt lgkmcnt(4)
    v_mfma_f32_16x16x32_bf16 v[72:75], a[96:99], a[44:47], v[72:75]
    s_add_u32 m0, s33, 32768
    s_add_u32 s36, s31, 262144
    s_waitcnt lgkmcnt(3)
    v_mfma_f32_16x16x32_bf16 v[80:83], a[96:99], a[48:51], v[80:83]
    buffer_load_dwordx4 v4, s[8:11], s36 offen lds
    s_waitcnt lgkmcnt(2)
    v_mfma_f32_16x16x32_bf16 v[88:91], a[96:99], a[52:55], v[88:91]
    s_waitcnt lgkmcnt(1)
    v_mfma_f32_16x16x32_bf16 v[96:99], a[96:99], a[56:59], v[96:99]
    s_waitcnt vmcnt(15)
    v_mfma_f32_16x16x32_bf16 v[44:47], a[100:103], a[28:31], v[44:47]
    v_mfma_f32_16x16x32_bf16 v[52:55], a[100:103], a[32:35], v[52:55]
    buffer_load_dwordx4 a[92:95], v12, s[12:15], s29 offen offset:1024
    s_add_u32 s29, s29, 2048
    v_mfma_f32_16x16x32_bf16 v[60:63], a[100:103], a[36:39], v[60:63]
    v_mfma_f32_16x16x32_bf16 v[68:71], a[100:103], a[40:43], v[68:71]
    ds_read_b128 a[4:7], v11 offset:39168
    v_mfma_f32_16x16x32_bf16 v[76:79], a[100:103], a[44:47], v[76:79]
    v_mfma_f32_16x16x32_bf16 v[84:87], a[100:103], a[48:51], v[84:87]
    v_mfma_f32_16x16x32_bf16 v[92:95], a[100:103], a[52:55], v[92:95]
    v_mfma_f32_16x16x32_bf16 v[100:103], a[100:103], a[56:59], v[100:103]
    s_waitcnt vmcnt(14)
    v_mfma_f32_16x16x32_bf16 v[40:43], a[104:107], a[32:35], v[40:43]
    v_mfma_f32_16x16x32_bf16 v[48:51], a[104:107], a[36:39], v[48:51]
    buffer_load_dwordx4 a[96:99], v12, s[12:15], s29 offen offset:0
    v_mfma_f32_16x16x32_bf16 v[56:59], a[104:107], a[40:43], v[56:59]
    v_mfma_f32_16x16x32_bf16 v[64:67], a[104:107], a[44:47], v[64:67]
    ds_read_b128 a[8:11], v11 offset:39424
    v_mfma_f32_16x16x32_bf16 v[72:75], a[104:107], a[48:51], v[72:75]
    v_mfma_f32_16x16x32_bf16 v[80:83], a[104:107], a[52:55], v[80:83]
    v_mfma_f32_16x16x32_bf16 v[88:91], a[104:107], a[56:59], v[88:91]
    s_waitcnt lgkmcnt(2)
    v_mfma_f32_16x16x32_bf16 v[96:99], a[104:107], a[0:3], v[96:99]
    s_waitcnt vmcnt(13)
    v_mfma_f32_16x16x32_bf16 v[44:47], a[108:111], a[32:35], v[44:47]
    v_mfma_f32_16x16x32_bf16 v[52:55], a[108:111], a[36:39], v[52:55]
    buffer_load_dwordx4 a[100:103], v12, s[12:15], s29 offen offset:1024
    s_add_u32 s29, s29, 2048
    v_mfma_f32_16x16x32_bf16 v[60:63], a[108:111], a[40:43], v[60:63]
    v_mfma_f32_16x16x32_bf16 v[68:71], a[108:111], a[44:47], v[68:71]
    ds_read_b128 a[12:15], v11 offset:39680
    v_mfma_f32_16x16x32_bf16 v[76:79], a[108:111], a[48:51], v[76:79]
    v_mfma_f32_16x16x32_bf16 v[84:87], a[108:111], a[52:55], v[84:87]
    v_mfma_f32_16x16x32_bf16 v[92:95], a[108:111], a[56:59], v[92:95]
    v_mfma_f32_16x16x32_bf16 v[100:103], a[108:111], a[0:3], v[100:103]
    s_waitcnt vmcnt(12)
    v_mfma_f32_16x16x32_bf16 v[40:43], a[72:75], a[36:39], v[40:43]
    v_mfma_f32_16x16x32_bf16 v[48:51], a[72:75], a[40:43], v[48:51]
    buffer_load_dwordx4 a[104:107], v12, s[12:15], s29 offen offset:0
    v_mfma_f32_16x16x32_bf16 v[56:59], a[72:75], a[44:47], v[56:59]
    v_mfma_f32_16x16x32_bf16 v[64:67], a[72:75], a[48:51], v[64:67]
    ds_read_b128 a[16:19], v11 offset:39936
    v_mfma_f32_16x16x32_bf16 v[72:75], a[72:75], a[52:55], v[72:75]
    v_mfma_f32_16x16x32_bf16 v[80:83], a[72:75], a[56:59], v[80:83]
    v_mfma_f32_16x16x32_bf16 v[88:91], a[72:75], a[0:3], v[88:91]
    s_waitcnt lgkmcnt(3)
    v_mfma_f32_16x16x32_bf16 v[96:99], a[72:75], a[4:7], v[96:99]
    s_waitcnt vmcnt(11)
    v_mfma_f32_16x16x32_bf16 v[44:47], a[76:79], a[36:39], v[44:47]
    v_mfma_f32_16x16x32_bf16 v[52:55], a[76:79], a[40:43], v[52:55]
    buffer_load_dwordx4 a[108:111], v12, s[12:15], s29 offen offset:1024
    s_add_u32 s29, s29, 2048
    v_mfma_f32_16x16x32_bf16 v[60:63], a[76:79], a[44:47], v[60:63]
    v_mfma_f32_16x16x32_bf16 v[68:71], a[76:79], a[48:51], v[68:71]
    ds_read_b128 a[20:23], v11 offset:40192
    v_mfma_f32_16x16x32_bf16 v[76:79], a[76:79], a[52:55], v[76:79]
    v_mfma_f32_16x16x32_bf16 v[84:87], a[76:79], a[56:59], v[84:87]
    v_mfma_f32_16x16x32_bf16 v[92:95], a[76:79], a[0:3], v[92:95]
    v_mfma_f32_16x16x32_bf16 v[100:103], a[76:79], a[4:7], v[100:103]
    s_waitcnt lgkmcnt(0)
    s_waitcnt vmcnt(5)
    s_barrier
    v_mfma_f32_16x16x32_bf16 v[40:43], a[80:83], a[40:43], v[40:43]
    v_mfma_f32_16x16x32_bf16 v[48:51], a[80:83], a[44:47], v[48:51]
    buffer_load_dwordx4 a[72:75], v12, s[12:15], s29 offen offset:0
    v_mfma_f32_16x16x32_bf16 v[56:59], a[80:83], a[48:51], v[56:59]
    v_mfma_f32_16x16x32_bf16 v[64:67], a[80:83], a[52:55], v[64:67]
    ds_read_b128 a[24:27], v10 offset:0
    v_mfma_f32_16x16x32_bf16 v[72:75], a[80:83], a[56:59], v[72:75]
    s_add_u32 m0, s33, 36864
    s_nop 0
    v_mfma_f32_16x16x32_bf16 v[80:83], a[80:83], a[0:3], v[80:83]
    buffer_load_dwordx4 v9, s[8:11], s32 offen lds
    v_mfma_f32_16x16x32_bf16 v[88:91], a[80:83], a[4:7], v[88:91]
    v_mfma_f32_16x16x32_bf16 v[96:99], a[80:83], a[8:11], v[96:99]
    s_add_u32 m0, s33, 45056
    s_add_u32 s36, s31, 66560
    v_mfma_f32_16x16x32_bf16 v[44:47], a[84:87], a[40:43], v[44:47]
    buffer_load_dwordx4 v6, s[8:11], s36 offen lds
    v_mfma_f32_16x16x32_bf16 v[52:55], a[84:87], a[44:47], v[52:55]
    buffer_load_dwordx4 a[76:79], v12, s[12:15], s29 offen offset:1024
    s_add_u32 s29, s29, 2048
    v_mfma_f32_16x16x32_bf16 v[60:63], a[84:87], a[48:51], v[60:63]
    v_mfma_f32_16x16x32_bf16 v[68:71], a[84:87], a[52:55], v[68:71]
    ds_read_b128 a[28:31], v10 offset:256
    v_mfma_f32_16x16x32_bf16 v[76:79], a[84:87], a[56:59], v[76:79]
    s_add_u32 m0, s33, 40960
    s_add_u32 s36, s31, 33792
    v_mfma_f32_16x16x32_bf16 v[84:87], a[84:87], a[0:3], v[84:87]
    buffer_load_dwordx4 v5, s[8:11], s36 offen lds
    v_mfma_f32_16x16x32_bf16 v[92:95], a[84:87], a[4:7], v[92:95]
    v_mfma_f32_16x16x32_bf16 v[100:103], a[84:87], a[8:11], v[100:103]
    v_mfma_f32_16x16x32_bf16 v[40:43], a[88:91], a[44:47], v[40:43]
    v_mfma_f32_16x16x32_bf16 v[48:51], a[88:91], a[48:51], v[48:51]
    buffer_load_dwordx4 a[80:83], v12, s[12:15], s29 offen offset:0
    v_mfma_f32_16x16x32_bf16 v[56:59], a[88:91], a[52:55], v[56:59]
    v_mfma_f32_16x16x32_bf16 v[64:67], a[88:91], a[56:59], v[64:67]
    ds_read_b128 a[32:35], v10 offset:512
    v_mfma_f32_16x16x32_bf16 v[72:75], a[88:91], a[0:3], v[72:75]
    s_add_u32 m0, s33, 49152
    s_add_u32 s36, s31, 99328
    v_mfma_f32_16x16x32_bf16 v[80:83], a[88:91], a[4:7], v[80:83]
    buffer_load_dwordx4 v7, s[8:11], s36 offen lds
    v_mfma_f32_16x16x32_bf16 v[88:91], a[88:91], a[8:11], v[88:91]
    v_mfma_f32_16x16x32_bf16 v[96:99], a[88:91], a[12:15], v[96:99]
    s_waitcnt vmcnt(11)
    v_mfma_f32_16x16x32_bf16 v[44:47], a[92:95], a[44:47], v[44:47]
    v_mfma_f32_16x16x32_bf16 v[52:55], a[92:95], a[48:51], v[52:55]
    buffer_load_dwordx4 a[84:87], v12, s[12:15], s29 offen offset:1024
    s_add_u32 s29, s29, 2048
    v_mfma_f32_16x16x32_bf16 v[60:63], a[92:95], a[52:55], v[60:63]
    v_mfma_f32_16x16x32_bf16 v[68:71], a[92:95], a[56:59], v[68:71]
    ds_read_b128 a[36:39], v10 offset:768
    v_mfma_f32_16x16x32_bf16 v[76:79], a[92:95], a[0:3], v[76:79]
    s_add_u32 m0, s33, 53248
    s_add_u32 s36, s31, 132096
    v_mfma_f32_16x16x32_bf16 v[84:87], a[92:95], a[4:7], v[84:87]
    buffer_load_dwordx4 v4, s[8:11], s36 offen lds
    v_mfma_f32_16x16x32_bf16 v[92:95], a[92:95], a[8:11], v[92:95]
    v_mfma_f32_16x16x32_bf16 v[100:103], a[92:95], a[12:15], v[100:103]
    s_waitcnt vmcnt(12)
    v_mfma_f32_16x16x32_bf16 v[40:43], a[96:99], a[48:51], v[40:43]
    v_mfma_f32_16x16x32_bf16 v[48:51], a[96:99], a[52:55], v[48:51]
    buffer_load_dwordx4 a[88:91], v12, s[12:15], s29 offen offset:0
    v_mfma_f32_16x16x32_bf16 v[56:59], a[96:99], a[56:59], v[56:59]
    v_mfma_f32_16x16x32_bf16 v[64:67], a[96:99], a[0:3], v[64:67]
    ds_read_b128 a[40:43], v10 offset:1024
    v_mfma_f32_16x16x32_bf16 v[72:75], a[96:99], a[4:7], v[72:75]
    s_add_u32 m0, s33, 57344
    s_add_u32 s36, s31, 164864
    v_mfma_f32_16x16x32_bf16 v[80:83], a[96:99], a[8:11], v[80:83]
    buffer_load_dwordx4 v5, s[8:11], s36 offen lds
    v_mfma_f32_16x16x32_bf16 v[88:91], a[96:99], a[12:15], v[88:91]
    v_mfma_f32_16x16x32_bf16 v[96:99], a[96:99], a[16:19], v[96:99]
    s_waitcnt vmcnt(13)
    v_mfma_f32_16x16x32_bf16 v[44:47], a[100:103], a[48:51], v[44:47]
    v_mfma_f32_16x16x32_bf16 v[52:55], a[100:103], a[52:55], v[52:55]
    buffer_load_dwordx4 a[92:95], v12, s[12:15], s29 offen offset:1024
    s_add_u32 s29, s29, 2048
    v_mfma_f32_16x16x32_bf16 v[60:63], a[100:103], a[56:59], v[60:63]
    v_mfma_f32_16x16x32_bf16 v[68:71], a[100:103], a[0:3], v[68:71]
    ds_read_b128 a[44:47], v10 offset:1280
    v_mfma_f32_16x16x32_bf16 v[76:79], a[100:103], a[4:7], v[76:79]
    s_add_u32 m0, s33, 61440
    s_add_u32 s36, s31, 197632
    v_mfma_f32_16x16x32_bf16 v[84:87], a[100:103], a[8:11], v[84:87]
    buffer_load_dwordx4 v6, s[8:11], s36 offen lds
    v_mfma_f32_16x16x32_bf16 v[92:95], a[100:103], a[12:15], v[92:95]
    v_mfma_f32_16x16x32_bf16 v[100:103], a[100:103], a[16:19], v[100:103]
    s_waitcnt vmcnt(14)
    v_mfma_f32_16x16x32_bf16 v[40:43], a[104:107], a[52:55], v[40:43]
    v_mfma_f32_16x16x32_bf16 v[48:51], a[104:107], a[56:59], v[48:51]
    buffer_load_dwordx4 a[96:99], v12, s[12:15], s29 offen offset:0
    v_mfma_f32_16x16x32_bf16 v[56:59], a[104:107], a[0:3], v[56:59]
    s_add_u32 s35, s35, 1
    v_mfma_f32_16x16x32_bf16 v[64:67], a[104:107], a[4:7], v[64:67]
    ds_read_b128 a[60:63], v10 offset:1536
    v_mfma_f32_16x16x32_bf16 v[72:75], a[104:107], a[8:11], v[72:75]
    s_add_u32 m0, s33, 65536
    s_add_u32 s36, s31, 230400
    v_mfma_f32_16x16x32_bf16 v[80:83], a[104:107], a[12:15], v[80:83]
    buffer_load_dwordx4 v7, s[8:11], s36 offen lds
    v_mfma_f32_16x16x32_bf16 v[88:91], a[104:107], a[16:19], v[88:91]
    v_mfma_f32_16x16x32_bf16 v[96:99], a[104:107], a[20:23], v[96:99]
    s_waitcnt vmcnt(15)
    v_mfma_f32_16x16x32_bf16 v[44:47], a[108:111], a[52:55], v[44:47]
    v_mfma_f32_16x16x32_bf16 v[52:55], a[108:111], a[56:59], v[52:55]
    buffer_load_dwordx4 a[100:103], v12, s[12:15], s29 offen offset:1024
    s_add_u32 s29, s29, 2048
    v_mfma_f32_16x16x32_bf16 v[60:63], a[108:111], a[0:3], v[60:63]
    v_mfma_f32_16x16x32_bf16 v[68:71], a[108:111], a[4:7], v[68:71]
    ds_read_b128 a[64:67], v10 offset:1792
    v_mfma_f32_16x16x32_bf16 v[76:79], a[108:111], a[8:11], v[76:79]
    s_add_u32 m0, s33, 69632
    s_add_u32 s36, s31, 263168
    v_mfma_f32_16x16x32_bf16 v[84:87], a[108:111], a[12:15], v[84:87]
    buffer_load_dwordx4 v4, s[8:11], s36 offen lds
    s_add_u32 s31, s31, 256
    s_add_u32 s32, s32, 256
    v_mfma_f32_16x16x32_bf16 v[92:95], a[108:111], a[16:19], v[92:95]
    v_mfma_f32_16x16x32_bf16 v[100:103], a[108:111], a[20:23], v[100:103]
    s_cmp_lt_u32 s35, 3
    s_cbranch_scc1 conv2_kernel_loop
conv2_kernel_last:
    s_waitcnt vmcnt(16)
    s_waitcnt lgkmcnt(7)
    v_mfma_f32_16x16x32_bf16 v[40:43], a[72:75], a[24:27], v[40:43]
    s_waitcnt lgkmcnt(6)
    v_mfma_f32_16x16x32_bf16 v[48:51], a[72:75], a[28:31], v[48:51]
    buffer_load_dwordx4 a[104:107], v12, s[12:15], s29 offen offset:0
    s_waitcnt lgkmcnt(5)
    v_mfma_f32_16x16x32_bf16 v[56:59], a[72:75], a[32:35], v[56:59]
    s_waitcnt lgkmcnt(4)
    v_mfma_f32_16x16x32_bf16 v[64:67], a[72:75], a[36:39], v[64:67]
    ds_read_b128 a[0:3], v11 offset:2048
    s_waitcnt lgkmcnt(4)
    v_mfma_f32_16x16x32_bf16 v[72:75], a[72:75], a[40:43], v[72:75]
    s_waitcnt lgkmcnt(3)
    v_mfma_f32_16x16x32_bf16 v[80:83], a[72:75], a[44:47], v[80:83]
    s_waitcnt lgkmcnt(2)
    v_mfma_f32_16x16x32_bf16 v[88:91], a[72:75], a[60:63], v[88:91]
    s_waitcnt lgkmcnt(1)
    v_mfma_f32_16x16x32_bf16 v[96:99], a[72:75], a[64:67], v[96:99]
    s_waitcnt vmcnt(14)
    v_mfma_f32_16x16x32_bf16 v[44:47], a[76:79], a[24:27], v[44:47]
    v_mfma_f32_16x16x32_bf16 v[52:55], a[76:79], a[28:31], v[52:55]
    buffer_load_dwordx4 a[108:111], v12, s[12:15], s29 offen offset:1024
    s_add_u32 s29, s29, 2048
    v_mfma_f32_16x16x32_bf16 v[60:63], a[76:79], a[32:35], v[60:63]
    v_mfma_f32_16x16x32_bf16 v[68:71], a[76:79], a[36:39], v[68:71]
    ds_read_b128 a[4:7], v11 offset:2304
    v_mfma_f32_16x16x32_bf16 v[76:79], a[76:79], a[40:43], v[76:79]
    v_mfma_f32_16x16x32_bf16 v[84:87], a[76:79], a[44:47], v[84:87]
    v_mfma_f32_16x16x32_bf16 v[92:95], a[76:79], a[60:63], v[92:95]
    v_mfma_f32_16x16x32_bf16 v[100:103], a[76:79], a[64:67], v[100:103]
    s_waitcnt vmcnt(13)
    v_mfma_f32_16x16x32_bf16 v[40:43], a[80:83], a[28:31], v[40:43]
    v_mfma_f32_16x16x32_bf16 v[48:51], a[80:83], a[32:35], v[48:51]
    buffer_load_dwordx4 a[72:75], v12, s[12:15], s29 offen offset:0
    v_mfma_f32_16x16x32_bf16 v[56:59], a[80:83], a[36:39], v[56:59]
    v_mfma_f32_16x16x32_bf16 v[64:67], a[80:83], a[40:43], v[64:67]
    ds_read_b128 a[8:11], v11 offset:2560
    v_mfma_f32_16x16x32_bf16 v[72:75], a[80:83], a[44:47], v[72:75]
    v_mfma_f32_16x16x32_bf16 v[80:83], a[80:83], a[60:63], v[80:83]
    v_mfma_f32_16x16x32_bf16 v[88:91], a[80:83], a[64:67], v[88:91]
    s_waitcnt lgkmcnt(2)
    v_mfma_f32_16x16x32_bf16 v[96:99], a[80:83], a[0:3], v[96:99]
    s_waitcnt vmcnt(12)
    v_mfma_f32_16x16x32_bf16 v[44:47], a[84:87], a[28:31], v[44:47]
    v_mfma_f32_16x16x32_bf16 v[52:55], a[84:87], a[32:35], v[52:55]
    buffer_load_dwordx4 a[76:79], v12, s[12:15], s29 offen offset:1024
    s_add_u32 s29, s29, 2048
    v_mfma_f32_16x16x32_bf16 v[60:63], a[84:87], a[36:39], v[60:63]
    v_mfma_f32_16x16x32_bf16 v[68:71], a[84:87], a[40:43], v[68:71]
    ds_read_b128 a[12:15], v11 offset:2816
    v_mfma_f32_16x16x32_bf16 v[76:79], a[84:87], a[44:47], v[76:79]
    v_mfma_f32_16x16x32_bf16 v[84:87], a[84:87], a[60:63], v[84:87]
    v_mfma_f32_16x16x32_bf16 v[92:95], a[84:87], a[64:67], v[92:95]
    v_mfma_f32_16x16x32_bf16 v[100:103], a[84:87], a[0:3], v[100:103]
    s_waitcnt vmcnt(11)
    v_mfma_f32_16x16x32_bf16 v[40:43], a[88:91], a[32:35], v[40:43]
    v_mfma_f32_16x16x32_bf16 v[48:51], a[88:91], a[36:39], v[48:51]
    buffer_load_dwordx4 a[80:83], v12, s[12:15], s29 offen offset:0
    v_mfma_f32_16x16x32_bf16 v[56:59], a[88:91], a[40:43], v[56:59]
    v_mfma_f32_16x16x32_bf16 v[64:67], a[88:91], a[44:47], v[64:67]
    ds_read_b128 a[16:19], v11 offset:3072
    v_mfma_f32_16x16x32_bf16 v[72:75], a[88:91], a[60:63], v[72:75]
    v_mfma_f32_16x16x32_bf16 v[80:83], a[88:91], a[64:67], v[80:83]
    v_mfma_f32_16x16x32_bf16 v[88:91], a[88:91], a[0:3], v[88:91]
    s_waitcnt lgkmcnt(3)
    v_mfma_f32_16x16x32_bf16 v[96:99], a[88:91], a[4:7], v[96:99]
    s_waitcnt vmcnt(10)
    v_mfma_f32_16x16x32_bf16 v[44:47], a[92:95], a[32:35], v[44:47]
    v_mfma_f32_16x16x32_bf16 v[52:55], a[92:95], a[36:39], v[52:55]
    buffer_load_dwordx4 a[84:87], v12, s[12:15], s29 offen offset:1024
    s_add_u32 s29, s29, 2048
    v_mfma_f32_16x16x32_bf16 v[60:63], a[92:95], a[40:43], v[60:63]
    v_mfma_f32_16x16x32_bf16 v[68:71], a[92:95], a[44:47], v[68:71]
    ds_read_b128 a[20:23], v11 offset:3328
    v_mfma_f32_16x16x32_bf16 v[76:79], a[92:95], a[60:63], v[76:79]
    v_mfma_f32_16x16x32_bf16 v[84:87], a[92:95], a[64:67], v[84:87]
    v_mfma_f32_16x16x32_bf16 v[92:95], a[92:95], a[0:3], v[92:95]
    v_mfma_f32_16x16x32_bf16 v[100:103], a[92:95], a[4:7], v[100:103]
    s_waitcnt vmcnt(9)
    v_mfma_f32_16x16x32_bf16 v[40:43], a[96:99], a[36:39], v[40:43]
    v_mfma_f32_16x16x32_bf16 v[48:51], a[96:99], a[40:43], v[48:51]
    buffer_load_dwordx4 a[88:91], v12, s[12:15], s29 offen offset:0
    v_mfma_f32_16x16x32_bf16 v[56:59], a[96:99], a[44:47], v[56:59]
    v_mfma_f32_16x16x32_bf16 v[64:67], a[96:99], a[60:63], v[64:67]
    ds_read_b128 a[24:27], v11 offset:3584
    v_mfma_f32_16x16x32_bf16 v[72:75], a[96:99], a[64:67], v[72:75]
    v_mfma_f32_16x16x32_bf16 v[80:83], a[96:99], a[0:3], v[80:83]
    v_mfma_f32_16x16x32_bf16 v[88:91], a[96:99], a[4:7], v[88:91]
    s_waitcnt lgkmcnt(4)
    v_mfma_f32_16x16x32_bf16 v[96:99], a[96:99], a[8:11], v[96:99]
    s_waitcnt vmcnt(8)
    v_mfma_f32_16x16x32_bf16 v[44:47], a[100:103], a[36:39], v[44:47]
    v_mfma_f32_16x16x32_bf16 v[52:55], a[100:103], a[40:43], v[52:55]
    buffer_load_dwordx4 a[92:95], v12, s[12:15], s29 offen offset:1024
    s_add_u32 s29, s29, 2048
    v_mfma_f32_16x16x32_bf16 v[60:63], a[100:103], a[44:47], v[60:63]
    v_mfma_f32_16x16x32_bf16 v[68:71], a[100:103], a[60:63], v[68:71]
    v_mfma_f32_16x16x32_bf16 v[76:79], a[100:103], a[64:67], v[76:79]
    v_mfma_f32_16x16x32_bf16 v[84:87], a[100:103], a[0:3], v[84:87]
    v_mfma_f32_16x16x32_bf16 v[92:95], a[100:103], a[4:7], v[92:95]
    v_mfma_f32_16x16x32_bf16 v[100:103], a[100:103], a[8:11], v[100:103]
    s_waitcnt lgkmcnt(0)
    s_waitcnt vmcnt(8)
    s_barrier
    s_waitcnt vmcnt(7)
    v_mfma_f32_16x16x32_bf16 v[40:43], a[104:107], a[40:43], v[40:43]
    v_mfma_f32_16x16x32_bf16 v[48:51], a[104:107], a[44:47], v[48:51]
    buffer_load_dwordx4 a[96:99], v12, s[12:15], s29 offen offset:0
    v_mfma_f32_16x16x32_bf16 v[56:59], a[104:107], a[60:63], v[56:59]
    v_mfma_f32_16x16x32_bf16 v[64:67], a[104:107], a[64:67], v[64:67]
    ds_read_b128 a[28:31], v10 offset:36864
    v_mfma_f32_16x16x32_bf16 v[72:75], a[104:107], a[0:3], v[72:75]
    v_mfma_f32_16x16x32_bf16 v[80:83], a[104:107], a[4:7], v[80:83]
    v_mfma_f32_16x16x32_bf16 v[88:91], a[104:107], a[8:11], v[88:91]
    v_mfma_f32_16x16x32_bf16 v[96:99], a[104:107], a[12:15], v[96:99]
    s_waitcnt vmcnt(7)
    v_mfma_f32_16x16x32_bf16 v[44:47], a[108:111], a[40:43], v[44:47]
    v_mfma_f32_16x16x32_bf16 v[52:55], a[108:111], a[44:47], v[52:55]
    buffer_load_dwordx4 a[100:103], v12, s[12:15], s29 offen offset:1024
    s_add_u32 s29, s29, 2048
    v_mfma_f32_16x16x32_bf16 v[60:63], a[108:111], a[60:63], v[60:63]
    v_mfma_f32_16x16x32_bf16 v[68:71], a[108:111], a[64:67], v[68:71]
    ds_read_b128 a[32:35], v10 offset:37120
    v_mfma_f32_16x16x32_bf16 v[76:79], a[108:111], a[0:3], v[76:79]
    v_mfma_f32_16x16x32_bf16 v[84:87], a[108:111], a[4:7], v[84:87]
    v_mfma_f32_16x16x32_bf16 v[92:95], a[108:111], a[8:11], v[92:95]
    v_mfma_f32_16x16x32_bf16 v[100:103], a[108:111], a[12:15], v[100:103]
    s_waitcnt vmcnt(7)
    v_mfma_f32_16x16x32_bf16 v[40:43], a[72:75], a[44:47], v[40:43]
    v_mfma_f32_16x16x32_bf16 v[48:51], a[72:75], a[60:63], v[48:51]
    buffer_load_dwordx4 a[104:107], v12, s[12:15], s29 offen offset:0
    v_mfma_f32_16x16x32_bf16 v[56:59], a[72:75], a[64:67], v[56:59]
    v_mfma_f32_16x16x32_bf16 v[64:67], a[72:75], a[0:3], v[64:67]
    ds_read_b128 a[36:39], v10 offset:37376
    v_mfma_f32_16x16x32_bf16 v[72:75], a[72:75], a[4:7], v[72:75]
    v_mfma_f32_16x16x32_bf16 v[80:83], a[72:75], a[8:11], v[80:83]
    v_mfma_f32_16x16x32_bf16 v[88:91], a[72:75], a[12:15], v[88:91]
    v_mfma_f32_16x16x32_bf16 v[96:99], a[72:75], a[16:19], v[96:99]
    s_waitcnt vmcnt(7)
    v_mfma_f32_16x16x32_bf16 v[44:47], a[76:79], a[44:47], v[44:47]
    v_mfma_f32_16x16x32_bf16 v[52:55], a[76:79], a[60:63], v[52:55]
    buffer_load_dwordx4 a[108:111], v12, s[12:15], s29 offen offset:1024
    s_add_u32 s29, s29, 2048
    v_mfma_f32_16x16x32_bf16 v[60:63], a[76:79], a[64:67], v[60:63]
    v_mfma_f32_16x16x32_bf16 v[68:71], a[76:79], a[0:3], v[68:71]
    ds_read_b128 a[40:43], v10 offset:37632
    v_mfma_f32_16x16x32_bf16 v[76:79], a[76:79], a[4:7], v[76:79]
    v_mfma_f32_16x16x32_bf16 v[84:87], a[76:79], a[8:11], v[84:87]
    v_mfma_f32_16x16x32_bf16 v[92:95], a[76:79], a[12:15], v[92:95]
    v_mfma_f32_16x16x32_bf16 v[100:103], a[76:79], a[16:19], v[100:103]
    s_waitcnt vmcnt(7)
    v_mfma_f32_16x16x32_bf16 v[40:43], a[80:83], a[60:63], v[40:43]
    v_mfma_f32_16x16x32_bf16 v[48:51], a[80:83], a[64:67], v[48:51]
    buffer_load_dwordx4 a[72:75], v12, s[12:15], s29 offen offset:0
    v_mfma_f32_16x16x32_bf16 v[56:59], a[80:83], a[0:3], v[56:59]
    v_mfma_f32_16x16x32_bf16 v[64:67], a[80:83], a[4:7], v[64:67]
    ds_read_b128 a[44:47], v10 offset:37888
    v_mfma_f32_16x16x32_bf16 v[72:75], a[80:83], a[8:11], v[72:75]
    v_mfma_f32_16x16x32_bf16 v[80:83], a[80:83], a[12:15], v[80:83]
    v_mfma_f32_16x16x32_bf16 v[88:91], a[80:83], a[16:19], v[88:91]
    v_mfma_f32_16x16x32_bf16 v[96:99], a[80:83], a[20:23], v[96:99]
    s_waitcnt vmcnt(7)
    v_mfma_f32_16x16x32_bf16 v[44:47], a[84:87], a[60:63], v[44:47]
    v_mfma_f32_16x16x32_bf16 v[52:55], a[84:87], a[64:67], v[52:55]
    buffer_load_dwordx4 a[76:79], v12, s[12:15], s29 offen offset:1024
    s_add_u32 s29, s29, 2048
    v_mfma_f32_16x16x32_bf16 v[60:63], a[84:87], a[0:3], v[60:63]
    v_mfma_f32_16x16x32_bf16 v[68:71], a[84:87], a[4:7], v[68:71]
    ds_read_b128 a[48:51], v10 offset:38144
    v_mfma_f32_16x16x32_bf16 v[76:79], a[84:87], a[8:11], v[76:79]
    v_mfma_f32_16x16x32_bf16 v[84:87], a[84:87], a[12:15], v[84:87]
    v_mfma_f32_16x16x32_bf16 v[92:95], a[84:87], a[16:19], v[92:95]
    v_mfma_f32_16x16x32_bf16 v[100:103], a[84:87], a[20:23], v[100:103]
    s_waitcnt vmcnt(7)
    v_mfma_f32_16x16x32_bf16 v[40:43], a[88:91], a[64:67], v[40:43]
    v_mfma_f32_16x16x32_bf16 v[48:51], a[88:91], a[0:3], v[48:51]
    buffer_load_dwordx4 a[80:83], v12, s[12:15], s29 offen offset:0
    v_mfma_f32_16x16x32_bf16 v[56:59], a[88:91], a[4:7], v[56:59]
    v_mfma_f32_16x16x32_bf16 v[64:67], a[88:91], a[8:11], v[64:67]
    ds_read_b128 a[52:55], v10 offset:38400
    v_mfma_f32_16x16x32_bf16 v[72:75], a[88:91], a[12:15], v[72:75]
    v_mfma_f32_16x16x32_bf16 v[80:83], a[88:91], a[16:19], v[80:83]
    v_mfma_f32_16x16x32_bf16 v[88:91], a[88:91], a[20:23], v[88:91]
    v_mfma_f32_16x16x32_bf16 v[96:99], a[88:91], a[24:27], v[96:99]
    s_waitcnt vmcnt(7)
    v_mfma_f32_16x16x32_bf16 v[44:47], a[92:95], a[64:67], v[44:47]
    v_mfma_f32_16x16x32_bf16 v[52:55], a[92:95], a[0:3], v[52:55]
    buffer_load_dwordx4 a[84:87], v12, s[12:15], s29 offen offset:1024
    s_add_u32 s29, s29, 2048
    v_mfma_f32_16x16x32_bf16 v[60:63], a[92:95], a[4:7], v[60:63]
    v_mfma_f32_16x16x32_bf16 v[68:71], a[92:95], a[8:11], v[68:71]
    ds_read_b128 a[56:59], v10 offset:38656
    v_mfma_f32_16x16x32_bf16 v[76:79], a[92:95], a[12:15], v[76:79]
    v_mfma_f32_16x16x32_bf16 v[84:87], a[92:95], a[16:19], v[84:87]
    v_mfma_f32_16x16x32_bf16 v[92:95], a[92:95], a[20:23], v[92:95]
    v_mfma_f32_16x16x32_bf16 v[100:103], a[92:95], a[24:27], v[100:103]
    s_waitcnt vmcnt(7)
    s_waitcnt lgkmcnt(7)
    v_mfma_f32_16x16x32_bf16 v[40:43], a[96:99], a[28:31], v[40:43]
    s_waitcnt lgkmcnt(6)
    v_mfma_f32_16x16x32_bf16 v[48:51], a[96:99], a[32:35], v[48:51]
    buffer_load_dwordx4 a[88:91], v12, s[12:15], s29 offen offset:0
    s_waitcnt lgkmcnt(5)
    v_mfma_f32_16x16x32_bf16 v[56:59], a[96:99], a[36:39], v[56:59]
    s_waitcnt lgkmcnt(4)
    v_mfma_f32_16x16x32_bf16 v[64:67], a[96:99], a[40:43], v[64:67]
    ds_read_b128 a[0:3], v11 offset:38912
    s_waitcnt lgkmcnt(4)
    v_mfma_f32_16x16x32_bf16 v[72:75], a[96:99], a[44:47], v[72:75]
    s_waitcnt lgkmcnt(3)
    v_mfma_f32_16x16x32_bf16 v[80:83], a[96:99], a[48:51], v[80:83]
    s_waitcnt lgkmcnt(2)
    v_mfma_f32_16x16x32_bf16 v[88:91], a[96:99], a[52:55], v[88:91]
    s_waitcnt lgkmcnt(1)
    v_mfma_f32_16x16x32_bf16 v[96:99], a[96:99], a[56:59], v[96:99]
    s_waitcnt vmcnt(7)
    v_mfma_f32_16x16x32_bf16 v[44:47], a[100:103], a[28:31], v[44:47]
    v_mfma_f32_16x16x32_bf16 v[52:55], a[100:103], a[32:35], v[52:55]
    buffer_load_dwordx4 a[92:95], v12, s[12:15], s29 offen offset:1024
    s_add_u32 s29, s29, 2048
    v_mfma_f32_16x16x32_bf16 v[60:63], a[100:103], a[36:39], v[60:63]
    v_mfma_f32_16x16x32_bf16 v[68:71], a[100:103], a[40:43], v[68:71]
    ds_read_b128 a[4:7], v11 offset:39168
    v_mfma_f32_16x16x32_bf16 v[76:79], a[100:103], a[44:47], v[76:79]
    v_mfma_f32_16x16x32_bf16 v[84:87], a[100:103], a[48:51], v[84:87]
    v_mfma_f32_16x16x32_bf16 v[92:95], a[100:103], a[52:55], v[92:95]
    v_mfma_f32_16x16x32_bf16 v[100:103], a[100:103], a[56:59], v[100:103]
    s_waitcnt vmcnt(7)
    v_mfma_f32_16x16x32_bf16 v[40:43], a[104:107], a[32:35], v[40:43]
    v_mfma_f32_16x16x32_bf16 v[48:51], a[104:107], a[36:39], v[48:51]
    buffer_load_dwordx4 a[96:99], v12, s[12:15], s29 offen offset:0
    v_mfma_f32_16x16x32_bf16 v[56:59], a[104:107], a[40:43], v[56:59]
    v_mfma_f32_16x16x32_bf16 v[64:67], a[104:107], a[44:47], v[64:67]
    ds_read_b128 a[8:11], v11 offset:39424
    v_mfma_f32_16x16x32_bf16 v[72:75], a[104:107], a[48:51], v[72:75]
    v_mfma_f32_16x16x32_bf16 v[80:83], a[104:107], a[52:55], v[80:83]
    v_mfma_f32_16x16x32_bf16 v[88:91], a[104:107], a[56:59], v[88:91]
    s_waitcnt lgkmcnt(2)
    v_mfma_f32_16x16x32_bf16 v[96:99], a[104:107], a[0:3], v[96:99]
    s_waitcnt vmcnt(7)
    v_mfma_f32_16x16x32_bf16 v[44:47], a[108:111], a[32:35], v[44:47]
    v_mfma_f32_16x16x32_bf16 v[52:55], a[108:111], a[36:39], v[52:55]
    buffer_load_dwordx4 a[100:103], v12, s[12:15], s29 offen offset:1024
    s_add_u32 s29, s29, 2048
    v_mfma_f32_16x16x32_bf16 v[60:63], a[108:111], a[40:43], v[60:63]
    v_mfma_f32_16x16x32_bf16 v[68:71], a[108:111], a[44:47], v[68:71]
    ds_read_b128 a[12:15], v11 offset:39680
    v_mfma_f32_16x16x32_bf16 v[76:79], a[108:111], a[48:51], v[76:79]
    v_mfma_f32_16x16x32_bf16 v[84:87], a[108:111], a[52:55], v[84:87]
    v_mfma_f32_16x16x32_bf16 v[92:95], a[108:111], a[56:59], v[92:95]
    v_mfma_f32_16x16x32_bf16 v[100:103], a[108:111], a[0:3], v[100:103]
    s_waitcnt vmcnt(7)
    v_mfma_f32_16x16x32_bf16 v[40:43], a[72:75], a[36:39], v[40:43]
    v_mfma_f32_16x16x32_bf16 v[48:51], a[72:75], a[40:43], v[48:51]
    buffer_load_dwordx4 a[104:107], v12, s[12:15], s29 offen offset:0
    v_mfma_f32_16x16x32_bf16 v[56:59], a[72:75], a[44:47], v[56:59]
    v_mfma_f32_16x16x32_bf16 v[64:67], a[72:75], a[48:51], v[64:67]
    ds_read_b128 a[16:19], v11 offset:39936
    v_mfma_f32_16x16x32_bf16 v[72:75], a[72:75], a[52:55], v[72:75]
    v_mfma_f32_16x16x32_bf16 v[80:83], a[72:75], a[56:59], v[80:83]
    v_mfma_f32_16x16x32_bf16 v[88:91], a[72:75], a[0:3], v[88:91]
    s_waitcnt lgkmcnt(3)
    v_mfma_f32_16x16x32_bf16 v[96:99], a[72:75], a[4:7], v[96:99]
    s_waitcnt vmcnt(7)
    v_mfma_f32_16x16x32_bf16 v[44:47], a[76:79], a[36:39], v[44:47]
    v_mfma_f32_16x16x32_bf16 v[52:55], a[76:79], a[40:43], v[52:55]
    buffer_load_dwordx4 a[108:111], v12, s[12:15], s29 offen offset:1024
    s_add_u32 s29, s29, 2048
    v_mfma_f32_16x16x32_bf16 v[60:63], a[76:79], a[44:47], v[60:63]
    v_mfma_f32_16x16x32_bf16 v[68:71], a[76:79], a[48:51], v[68:71]
    ds_read_b128 a[20:23], v11 offset:40192
    v_mfma_f32_16x16x32_bf16 v[76:79], a[76:79], a[52:55], v[76:79]
    v_mfma_f32_16x16x32_bf16 v[84:87], a[76:79], a[56:59], v[84:87]
    v_mfma_f32_16x16x32_bf16 v[92:95], a[76:79], a[0:3], v[92:95]
    v_mfma_f32_16x16x32_bf16 v[100:103], a[76:79], a[4:7], v[100:103]
    s_waitcnt lgkmcnt(0)
    s_barrier
    s_waitcnt vmcnt(7)
    v_mfma_f32_16x16x32_bf16 v[40:43], a[80:83], a[40:43], v[40:43]
    v_lshlrev_b32 v20, 4, v2
    v_mfma_f32_16x16x32_bf16 v[48:51], a[80:83], a[44:47], v[48:51]
    v_add_u32 v21, 0x10000, v20
    v_mfma_f32_16x16x32_bf16 v[56:59], a[80:83], a[48:51], v[56:59]
    s_mul_i32 s41, s28, 12288
    v_mfma_f32_16x16x32_bf16 v[64:67], a[80:83], a[52:55], v[64:67]
    v_add_u32 v22, s41, v20
    v_mfma_f32_16x16x32_bf16 v[72:75], a[80:83], a[56:59], v[72:75]
    v_mov_b32 v24, 0xc0135761
    v_mfma_f32_16x16x32_bf16 v[80:83], a[80:83], a[0:3], v[80:83]
    v_mov_b32 v25, 0xc0135761
    v_mfma_f32_16x16x32_bf16 v[88:91], a[80:83], a[4:7], v[88:91]
    v_mov_b32 v26, 0xbdd2d3e8
    v_mfma_f32_16x16x32_bf16 v[96:99], a[80:83], a[8:11], v[96:99]
    v_mov_b32 v27, 0xbdd2d3e8
    s_waitcnt vmcnt(6)
    v_mfma_f32_16x16x32_bf16 v[44:47], a[84:87], a[40:43], v[44:47]
    v_mov_b32 v28, 1.0
    v_mfma_f32_16x16x32_bf16 v[52:55], a[84:87], a[44:47], v[52:55]
    v_mov_b32 v29, 1.0
    v_mfma_f32_16x16x32_bf16 v[60:63], a[84:87], a[48:51], v[60:63]
    v_and_b32 v30, 15, v2
    v_mfma_f32_16x16x32_bf16 v[68:71], a[84:87], a[52:55], v[68:71]
    v_mfma_f32_16x16x32_bf16 v[76:79], a[84:87], a[56:59], v[76:79]
    v_mfma_f32_16x16x32_bf16 v[84:87], a[84:87], a[0:3], v[84:87]
    v_mfma_f32_16x16x32_bf16 v[92:95], a[84:87], a[4:7], v[92:95]
    v_mfma_f32_16x16x32_bf16 v[100:103], a[84:87], a[8:11], v[100:103]
    s_waitcnt vmcnt(5)
    v_mfma_f32_16x16x32_bf16 v[40:43], a[88:91], a[44:47], v[40:43]
    v_lshrrev_b32 v31, 4, v2
    v_mfma_f32_16x16x32_bf16 v[48:51], a[88:91], a[48:51], v[48:51]
    v_and_b32 v32, 3, v30
    v_mfma_f32_16x16x32_bf16 v[56:59], a[88:91], a[52:55], v[56:59]
    v_lshlrev_b32 v32, 1, v32
    v_mfma_f32_16x16x32_bf16 v[64:67], a[88:91], a[56:59], v[64:67]
    v_mul_u32_u24 v33, 64, v30
    v_mfma_f32_16x16x32_bf16 v[72:75], a[88:91], a[0:3], v[72:75]
    v_add_u32 v33, s41, v33
    v_mfma_f32_16x16x32_bf16 v[80:83], a[88:91], a[4:7], v[80:83]
    v_add_u32 v34, 0, v31
    v_mfma_f32_16x16x32_bf16 v[88:91], a[88:91], a[8:11], v[88:91]
    v_xor_b32 v34, v34, v32
    v_mfma_f32_16x16x32_bf16 v[96:99], a[88:91], a[12:15], v[96:99]
    v_lshl_add_u32 v4, v34, 3, v33
    s_waitcnt vmcnt(4)
    v_mfma_f32_16x16x32_bf16 v[44:47], a[92:95], a[44:47], v[44:47]
    v_add_u32 v34, 4, v31
    v_mfma_f32_16x16x32_bf16 v[52:55], a[92:95], a[48:51], v[52:55]
    v_xor_b32 v34, v34, v32
    v_mfma_f32_16x16x32_bf16 v[60:63], a[92:95], a[52:55], v[60:63]
    v_mfma_f32_16x16x32_bf16 v[68:71], a[92:95], a[56:59], v[68:71]
    v_mfma_f32_16x16x32_bf16 v[76:79], a[92:95], a[0:3], v[76:79]
    v_mfma_f32_16x16x32_bf16 v[84:87], a[92:95], a[4:7], v[84:87]
    v_mfma_f32_16x16x32_bf16 v[92:95], a[92:95], a[8:11], v[92:95]
    v_mfma_f32_16x16x32_bf16 v[100:103], a[92:95], a[12:15], v[100:103]
    s_waitcnt vmcnt(3)
    v_mfma_f32_16x16x32_bf16 v[40:43], a[96:99], a[48:51], v[40:43]
    v_lshl_add_u32 v5, v34, 3, v33
    v_mfma_f32_16x16x32_bf16 v[48:51], a[96:99], a[52:55], v[48:51]
    v_lshrrev_b32 v30, 2, v2
    v_mfma_f32_16x16x32_bf16 v[56:59], a[96:99], a[56:59], v[56:59]
    v_xor_b32 v31, v30, v2
    v_mfma_f32_16x16x32_bf16 v[64:67], a[96:99], a[0:3], v[64:67]
    v_and_b32 v31, 3, v31
    v_mfma_f32_16x16x32_bf16 v[72:75], a[96:99], a[4:7], v[72:75]
    v_lshlrev_b32 v31, 4, v31
    v_mfma_f32_16x16x32_bf16 v[80:83], a[96:99], a[8:11], v[80:83]
    v_lshl_add_u32 v8, v30, 13, v31
    v_mfma_f32_16x16x32_bf16 v[88:91], a[96:99], a[12:15], v[88:91]
    s_lshl_b32 s42, s28, 1
    v_mfma_f32_16x16x32_bf16 v[96:99], a[96:99], a[16:19], v[96:99]
    s_add_u32 s42, s42, s38
    s_waitcnt vmcnt(2)
    v_mfma_f32_16x16x32_bf16 v[44:47], a[100:103], a[48:51], v[44:47]
    s_lshl_b32 s42, s42, 10
    v_mfma_f32_16x16x32_bf16 v[52:55], a[100:103], a[52:55], v[52:55]
    s_add_u32 s42, s42, s39
    v_mfma_f32_16x16x32_bf16 v[60:63], a[100:103], a[56:59], v[60:63]
    v_mfma_f32_16x16x32_bf16 v[68:71], a[100:103], a[0:3], v[68:71]
    v_mfma_f32_16x16x32_bf16 v[76:79], a[100:103], a[4:7], v[76:79]
    v_mfma_f32_16x16x32_bf16 v[84:87], a[100:103], a[8:11], v[84:87]
    v_mfma_f32_16x16x32_bf16 v[92:95], a[100:103], a[12:15], v[92:95]
    v_mfma_f32_16x16x32_bf16 v[100:103], a[100:103], a[16:19], v[100:103]
    s_cmp_lg_u32 s28, 0
    s_cbranch_scc1 conv2_kernel_red0
    s_waitcnt vmcnt(1)
    v_mfma_f32_16x16x32_bf16 v[40:43], a[104:107], a[52:55], v[40:43]
    v_mfma_f32_16x16x32_bf16 v[48:51], a[104:107], a[56:59], v[48:51]
    s_waitcnt vmcnt(0)
    v_mfma_f32_16x16x32_bf16 v[44:47], a[108:111], a[52:55], v[44:47]
    v_mfma_f32_16x16x32_bf16 v[52:55], a[108:111], a[56:59], v[52:55]
    v_mfma_f32_16x16x32_bf16 v[56:59], a[104:107], a[0:3], v[56:59]
    v_mfma_f32_16x16x32_bf16 v[64:67], a[104:107], a[4:7], v[64:67]
    v_mfma_f32_16x16x32_bf16 v[60:63], a[108:111], a[0:3], v[60:63]
    v_mfma_f32_16x16x32_bf16 v[68:71], a[108:111], a[4:7], v[68:71]
    v_mfma_f32_16x16x32_bf16 v[72:75], a[104:107], a[8:11], v[72:75]
    v_mfma_f32_16x16x32_bf16 v[80:83], a[104:107], a[12:15], v[80:83]
    v_mfma_f32_16x16x32_bf16 v[76:79], a[108:111], a[8:11], v[76:79]
    v_mfma_f32_16x16x32_bf16 v[84:87], a[108:111], a[12:15], v[84:87]
    v_mfma_f32_16x16x32_bf16 v[88:91], a[104:107], a[16:19], v[88:91]
    ds_write_b128 v20, v[56:59] offset:12288
    v_mfma_f32_16x16x32_bf16 v[96:99], a[104:107], a[20:23], v[96:99]
    ds_write_b128 v20, v[64:67] offset:14336
    v_mfma_f32_16x16x32_bf16 v[92:95], a[108:111], a[16:19], v[92:95]
    ds_write_b128 v20, v[60:63] offset:13312
    v_mfma_f32_16x16x32_bf16 v[100:103], a[108:111], a[20:23], v[100:103]
    ds_write_b128 v20, v[68:71] offset:15360
    s_nop 7
    ds_write_b128 v20, v[72:75] offset:28672
    ds_write_b128 v20, v[80:83] offset:30720
    ds_write_b128 v20, v[76:79] offset:29696
    ds_write_b128 v20, v[84:87] offset:31744
    ds_write_b128 v20, v[88:91] offset:45056
    ds_write_b128 v20, v[96:99] offset:47104
    ds_write_b128 v20, v[92:95] offset:46080
    ds_write_b128 v20, v[100:103] offset:48128
    s_waitcnt lgkmcnt(0)
    s_barrier
    ds_read_b128 v[56:59], v22 offset:0
    ds_read_b128 v[60:63], v22 offset:1024
    ds_read_b128 v[72:75], v22 offset:4096
    ds_read_b128 v[76:79], v22 offset:5120
    ds_read_b128 v[88:91], v22 offset:8192
    ds_read_b128 v[92:95], v22 offset:9216
    ds_read_b128 v[64:67], v22 offset:2048
    ds_read_b128 v[68:71], v22 offset:3072
    ds_read_b128 v[80:83], v22 offset:6144
    ds_read_b128 v[84:87], v22 offset:7168
    ds_read_b128 v[96:99], v22 offset:10240
    ds_read_b128 v[100:103], v22 offset:11264
    s_branch conv2_kernel_redd
conv2_kernel_red0:
    s_cmp_lg_u32 s28, 1
    s_cbranch_scc1 conv2_kernel_red1
    s_waitcnt vmcnt(1)
    v_mfma_f32_16x16x32_bf16 v[40:43], a[104:107], a[52:55], v[40:43]
    v_mfma_f32_16x16x32_bf16 v[48:51], a[104:107], a[56:59], v[48:51]
    s_waitcnt vmcnt(0)
    v_mfma_f32_16x16x32_bf16 v[44:47], a[108:111], a[52:55], v[44:47]
    v_mfma_f32_16x16x32_bf16 v[52:55], a[108:111], a[56:59], v[52:55]
    v_mfma_f32_16x16x32_bf16 v[56:59], a[104:107], a[0:3], v[56:59]
    v_mfma_f32_16x16x32_bf16 v[64:67], a[104:107], a[4:7], v[64:67]
    v_mfma_f32_16x16x32_bf16 v[60:63], a[108:111], a[0:3], v[60:63]
    v_mfma_f32_16x16x32_bf16 v[68:71], a[108:111], a[4:7], v[68:71]
    v_mfma_f32_16x16x32_bf16 v[72:75], a[104:107], a[8:11], v[72:75]
    ds_write_b128 v20, v[40:43] offset:0
    v_mfma_f32_16x16x32_bf16 v[80:83], a[104:107], a[12:15], v[80:83]
    ds_write_b128 v20, v[48:51] offset:2048
    v_mfma_f32_16x16x32_bf16 v[76:79], a[108:111], a[8:11], v[76:79]
    ds_write_b128 v20, v[44:47] offset:1024
    v_mfma_f32_16x16x32_bf16 v[84:87], a[108:111], a[12:15], v[84:87]
    ds_write_b128 v20, v[52:55] offset:3072
    v_mfma_f32_16x16x32_bf16 v[88:91], a[104:107], a[16:19], v[88:91]
    v_mfma_f32_16x16x32_bf16 v[96:99], a[104:107], a[20:23], v[96:99]
    v_mfma_f32_16x16x32_bf16 v[92:95], a[108:111], a[16:19], v[92:95]
    v_mfma_f32_16x16x32_bf16 v[100:103], a[108:111], a[20:23], v[100:103]
    s_nop 7
    ds_write_b128 v20, v[72:75] offset:32768
    ds_write_b128 v20, v[80:83] offset:34816
    ds_write_b128 v20, v[76:79] offset:33792
    ds_write_b128 v20, v[84:87] offset:35840
    ds_write_b128 v20, v[88:91] offset:40960
    ds_write_b128 v20, v[96:99] offset:43008
    ds_write_b128 v20, v[92:95] offset:41984
    ds_write_b128 v20, v[100:103] offset:44032
    s_waitcnt lgkmcnt(0)
    s_barrier
    ds_read_b128 v[40:43], v22 offset:0
    ds_read_b128 v[44:47], v22 offset:1024
    ds_read_b128 v[88:91], v22 offset:4096
    ds_read_b128 v[92:95], v22 offset:5120
    ds_read_b128 v[72:75], v22 offset:8192
    ds_read_b128 v[76:79], v22 offset:9216
    ds_read_b128 v[48:51], v22 offset:2048
    ds_read_b128 v[52:55], v22 offset:3072
    ds_read_b128 v[96:99], v22 offset:6144
    ds_read_b128 v[100:103], v22 offset:7168
    ds_read_b128 v[80:83], v22 offset:10240
    ds_read_b128 v[84:87], v22 offset:11264
    s_branch conv2_kernel_redd
conv2_kernel_red1:
    s_cmp_lg_u32 s28, 2
    s_cbranch_scc1 conv2_kernel_red2
    s_waitcnt vmcnt(1)
    v_mfma_f32_16x16x32_bf16 v[40:43], a[104:107], a[52:55], v[40:43]
    v_mfma_f32_16x16x32_bf16 v[48:51], a[104:107], a[56:59], v[48:51]
    s_waitcnt vmcnt(0)
    v_mfma_f32_16x16x32_bf16 v[44:47], a[108:111], a[52:55], v[44:47]
    v_mfma_f32_16x16x32_bf16 v[52:55], a[108:111], a[56:59], v[52:55]
    v_mfma_f32_16x16x32_bf16 v[56:59], a[104:107], a[0:3], v[56:59]
    v_mfma_f32_16x16x32_bf16 v[64:67], a[104:107], a[4:7], v[64:67]
    v_mfma_f32_16x16x32_bf16 v[60:63], a[108:111], a[0:3], v[60:63]
    v_mfma_f32_16x16x32_bf16 v[68:71], a[108:111], a[4:7], v[68:71]
    v_mfma_f32_16x16x32_bf16 v[72:75], a[104:107], a[8:11], v[72:75]
    ds_write_b128 v20, v[40:43] offset:4096
    v_mfma_f32_16x16x32_bf16 v[80:83], a[104:107], a[12:15], v[80:83]
    ds_write_b128 v20, v[48:51] offset:6144
    v_mfma_f32_16x16x32_bf16 v[76:79], a[108:111], a[8:11], v[76:79]
    ds_write_b128 v20, v[44:47] offset:5120
    v_mfma_f32_16x16x32_bf16 v[84:87], a[108:111], a[12:15], v[84:87]
    ds_write_b128 v20, v[52:55] offset:7168
    v_mfma_f32_16x16x32_bf16 v[88:91], a[104:107], a[16:19], v[88:91]
    ds_write_b128 v20, v[56:59] offset:20480
    v_mfma_f32_16x16x32_bf16 v[96:99], a[104:107], a[20:23], v[96:99]
    ds_write_b128 v20, v[64:67] offset:22528
    v_mfma_f32_16x16x32_bf16 v[92:95], a[108:111], a[16:19], v[92:95]
    ds_write_b128 v20, v[60:63] offset:21504
    v_mfma_f32_16x16x32_bf16 v[100:103], a[108:111], a[20:23], v[100:103]
    ds_write_b128 v20, v[68:71] offset:23552
    s_nop 7
    ds_write_b128 v20, v[88:91] offset:36864
    ds_write_b128 v20, v[96:99] offset:38912
    ds_write_b128 v20, v[92:95] offset:37888
    ds_write_b128 v20, v[100:103] offset:39936
    s_waitcnt lgkmcnt(0)
    s_barrier
    ds_read_b128 v[88:91], v22 offset:0
    ds_read_b128 v[92:95], v22 offset:1024
    ds_read_b128 v[40:43], v22 offset:4096
    ds_read_b128 v[44:47], v22 offset:5120
    ds_read_b128 v[56:59], v22 offset:8192
    ds_read_b128 v[60:63], v22 offset:9216
    ds_read_b128 v[96:99], v22 offset:2048
    ds_read_b128 v[100:103], v22 offset:3072
    ds_read_b128 v[48:51], v22 offset:6144
    ds_read_b128 v[52:55], v22 offset:7168
    ds_read_b128 v[64:67], v22 offset:10240
    ds_read_b128 v[68:71], v22 offset:11264
    s_branch conv2_kernel_redd
conv2_kernel_red2:
    s_cmp_lg_u32 s28, 3
    s_cbranch_scc1 conv2_kernel_red3
    s_waitcnt vmcnt(1)
    v_mfma_f32_16x16x32_bf16 v[40:43], a[104:107], a[52:55], v[40:43]
    v_mfma_f32_16x16x32_bf16 v[48:51], a[104:107], a[56:59], v[48:51]
    s_waitcnt vmcnt(0)
    v_mfma_f32_16x16x32_bf16 v[44:47], a[108:111], a[52:55], v[44:47]
    v_mfma_f32_16x16x32_bf16 v[52:55], a[108:111], a[56:59], v[52:55]
    v_mfma_f32_16x16x32_bf16 v[56:59], a[104:107], a[0:3], v[56:59]
    v_mfma_f32_16x16x32_bf16 v[64:67], a[104:107], a[4:7], v[64:67]
    v_mfma_f32_16x16x32_bf16 v[60:63], a[108:111], a[0:3], v[60:63]
    v_mfma_f32_16x16x32_bf16 v[68:71], a[108:111], a[4:7], v[68:71]
    v_mfma_f32_16x16x32_bf16 v[72:75], a[104:107], a[8:11], v[72:75]
    ds_write_b128 v20, v[40:43] offset:8192
    v_mfma_f32_16x16x32_bf16 v[80:83], a[104:107], a[12:15], v[80:83]
    ds_write_b128 v20, v[48:51] offset:10240
    v_mfma_f32_16x16x32_bf16 v[76:79], a[108:111], a[8:11], v[76:79]
    ds_write_b128 v20, v[44:47] offset:9216
    v_mfma_f32_16x16x32_bf16 v[84:87], a[108:111], a[12:15], v[84:87]
    ds_write_b128 v20, v[52:55] offset:11264
    v_mfma_f32_16x16x32_bf16 v[88:91], a[104:107], a[16:19], v[88:91]
    ds_write_b128 v20, v[56:59] offset:16384
    v_mfma_f32_16x16x32_bf16 v[96:99], a[104:107], a[20:23], v[96:99]
    ds_write_b128 v20, v[64:67] offset:18432
    v_mfma_f32_16x16x32_bf16 v[92:95], a[108:111], a[16:19], v[92:95]
    ds_write_b128 v20, v[60:63] offset:17408
    v_mfma_f32_16x16x32_bf16 v[100:103], a[108:111], a[20:23], v[100:103]
    ds_write_b128 v20, v[68:71] offset:19456
    s_nop 7
    ds_write_b128 v20, v[72:75] offset:24576
    ds_write_b128 v20, v[80:83] offset:26624
    ds_write_b128 v20, v[76:79] offset:25600
    ds_write_b128 v20, v[84:87] offset:27648
    s_waitcnt lgkmcnt(0)
    s_barrier
    ds_read_b128 v[72:75], v22 offset:0
    ds_read_b128 v[76:79], v22 offset:1024
    ds_read_b128 v[56:59], v22 offset:4096
    ds_read_b128 v[60:63], v22 offset:5120
    ds_read_b128 v[40:43], v22 offset:8192
    ds_read_b128 v[44:47], v22 offset:9216
    ds_read_b128 v[80:83], v22 offset:2048
    ds_read_b128 v[84:87], v22 offset:3072
    ds_read_b128 v[64:67], v22 offset:6144
    ds_read_b128 v[68:71], v22 offset:7168
    ds_read_b128 v[48:51], v22 offset:10240
    ds_read_b128 v[52:55], v22 offset:11264
    s_branch conv2_kernel_redd
conv2_kernel_red3:
conv2_kernel_redd:
    s_waitcnt lgkmcnt(6)
    v_pk_add_f32 v[40:41], v[40:41], v[56:57]
    v_pk_add_f32 v[42:43], v[42:43], v[58:59]
    v_pk_add_f32 v[44:45], v[44:45], v[60:61]
    v_pk_add_f32 v[46:47], v[46:47], v[62:63]
    v_pk_add_f32 v[72:73], v[72:73], v[88:89]
    v_pk_add_f32 v[74:75], v[74:75], v[90:91]
    v_pk_add_f32 v[76:77], v[76:77], v[92:93]
    v_pk_add_f32 v[78:79], v[78:79], v[94:95]
    v_pk_add_f32 v[40:41], v[40:41], v[72:73]
    v_pk_add_f32 v[42:43], v[42:43], v[74:75]
    v_pk_add_f32 v[44:45], v[44:45], v[76:77]
    v_pk_add_f32 v[46:47], v[46:47], v[78:79]
    s_waitcnt lgkmcnt(0)
    v_pk_add_f32 v[48:49], v[48:49], v[64:65]
    v_pk_add_f32 v[50:51], v[50:51], v[66:67]
    v_pk_add_f32 v[52:53], v[52:53], v[68:69]
    v_pk_add_f32 v[54:55], v[54:55], v[70:71]
    v_pk_add_f32 v[80:81], v[80:81], v[96:97]
    v_pk_add_f32 v[82:83], v[82:83], v[98:99]
    v_pk_add_f32 v[84:85], v[84:85], v[100:101]
    v_pk_add_f32 v[86:87], v[86:87], v[102:103]
    v_pk_add_f32 v[48:49], v[48:49], v[80:81]
    v_pk_add_f32 v[50:51], v[50:51], v[82:83]
    v_pk_add_f32 v[52:53], v[52:53], v[84:85]
    v_pk_add_f32 v[54:55], v[54:55], v[86:87]
    v_pk_mul_f32 v[56:57], v[40:41], v[40:41]
    v_pk_mul_f32 v[58:59], v[42:43], v[42:43]
    v_pk_mul_f32 v[60:61], v[44:45], v[44:45]
    v_pk_mul_f32 v[62:63], v[46:47], v[46:47]
    v_pk_mul_f32 v[64:65], v[48:49], v[48:49]
    v_pk_mul_f32 v[66:67], v[50:51], v[50:51]
    v_pk_mul_f32 v[68:69], v[52:53], v[52:53]
    v_pk_mul_f32 v[70:71], v[54:55], v[54:55]
    v_pk_fma_f32 v[56:57], v[56:57], v[26:27], v[24:25]
    v_pk_fma_f32 v[58:59], v[58:59], v[26:27], v[24:25]
    v_pk_fma_f32 v[60:61], v[60:61], v[26:27], v[24:25]
    v_pk_fma_f32 v[62:63], v[62:63], v[26:27], v[24:25]
    v_pk_fma_f32 v[64:65], v[64:65], v[26:27], v[24:25]
    v_pk_fma_f32 v[66:67], v[66:67], v[26:27], v[24:25]
    v_pk_fma_f32 v[68:69], v[68:69], v[26:27], v[24:25]
    v_pk_fma_f32 v[70:71], v[70:71], v[26:27], v[24:25]
    v_pk_mul_f32 v[56:57], v[56:57], v[40:41]
    v_pk_mul_f32 v[58:59], v[58:59], v[42:43]
    v_pk_mul_f32 v[60:61], v[60:61], v[44:45]
    v_pk_mul_f32 v[62:63], v[62:63], v[46:47]
    v_pk_mul_f32 v[64:65], v[64:65], v[48:49]
    v_pk_mul_f32 v[66:67], v[66:67], v[50:51]
    v_pk_mul_f32 v[68:69], v[68:69], v[52:53]
    v_pk_mul_f32 v[70:71], v[70:71], v[54:55]
    v_exp_f32 v56, v56
    v_exp_f32 v57, v57
    v_exp_f32 v58, v58
    v_exp_f32 v59, v59
    v_exp_f32 v60, v60
    v_exp_f32 v61, v61
    v_exp_f32 v62, v62
    v_exp_f32 v63, v63
    v_exp_f32 v64, v64
    v_exp_f32 v65, v65
    v_exp_f32 v66, v66
    v_exp_f32 v67, v67
    v_exp_f32 v68, v68
    v_exp_f32 v69, v69
    v_exp_f32 v70, v70
    v_exp_f32 v71, v71
    v_pk_add_f32 v[56:57], v[56:57], v[28:29]
    v_pk_add_f32 v[58:59], v[58:59], v[28:29]
    v_pk_add_f32 v[60:61], v[60:61], v[28:29]
    v_pk_add_f32 v[62:63], v[62:63], v[28:29]
    v_pk_add_f32 v[64:65], v[64:65], v[28:29]
    v_pk_add_f32 v[66:67], v[66:67], v[28:29]
    v_pk_add_f32 v[68:69], v[68:69], v[28:29]
    v_pk_add_f32 v[70:71], v[70:71], v[28:29]
    v_rcp_f32 v56, v56
    v_rcp_f32 v57, v57
    v_rcp_f32 v58, v58
    v_rcp_f32 v59, v59
    v_rcp_f32 v60, v60
    v_rcp_f32 v61, v61
    v_rcp_f32 v62, v62
    v_rcp_f32 v63, v63
    v_rcp_f32 v64, v64
    v_rcp_f32 v65, v65
    v_rcp_f32 v66, v66
    v_rcp_f32 v67, v67
    v_rcp_f32 v68, v68
    v_rcp_f32 v69, v69
    v_rcp_f32 v70, v70
    v_rcp_f32 v71, v71
    v_pk_mul_f32 v[40:41], v[40:41], v[56:57]
    v_pk_mul_f32 v[42:43], v[42:43], v[58:59]
    v_pk_mul_f32 v[44:45], v[44:45], v[60:61]
    v_pk_mul_f32 v[46:47], v[46:47], v[62:63]
    v_pk_mul_f32 v[48:49], v[48:49], v[64:65]
    v_pk_mul_f32 v[50:51], v[50:51], v[66:67]
    v_pk_mul_f32 v[52:53], v[52:53], v[68:69]
    v_pk_mul_f32 v[54:55], v[54:55], v[70:71]
    v_cvt_pk_bf16_f32 v72, v40, v41
    v_cvt_pk_bf16_f32 v73, v42, v43
    v_cvt_pk_bf16_f32 v74, v44, v45
    v_cvt_pk_bf16_f32 v75, v46, v47
    v_cvt_pk_bf16_f32 v76, v48, v49
    v_cvt_pk_bf16_f32 v77, v50, v51
    v_cvt_pk_bf16_f32 v78, v52, v53
    v_cvt_pk_bf16_f32 v79, v54, v55
    ds_write_b64 v4, v[72:73] offset:0
    ds_write_b64 v5, v[74:75] offset:0
    ds_write_b64 v4, v[76:77] offset:1024
    ds_write_b64 v5, v[78:79] offset:1024
    s_waitcnt lgkmcnt(0)
    ds_read_b128 v[56:59], v22 offset:0
    ds_read_b128 v[60:63], v22 offset:1024
    s_add_u32 s36, s42, 0
    s_waitcnt lgkmcnt(1)
    buffer_store_dwordx4 v[56:59], v8, s[16:19], s36 offen
    s_add_u32 s36, s42, 1024
    s_waitcnt lgkmcnt(0)
    buffer_store_dwordx4 v[60:63], v8, s[16:19], s36 offen
    s_waitcnt vmcnt(0)
conv2_kernel_end:
    s_endpgm
conv2_kernel_helper:
    s_cmp_ge_u32 s2, 40
    s_cbranch_scc1 conv2_kernel_end
    s_cmp_ge_u32 s2, 32
    s_cbranch_scc1 conv2_kernel_hsum
    s_load_dwordx2 s[4:5], s[0:1], 24
    s_lshl_b32 s41, s2, 14
    s_add_u32 s41, s41, 13107200
    s_add_u32 s8, s20, s41
    s_addc_u32 s9, s21, 0
    s_mov_b32 s10, 16384
    s_mov_b32 s11, 0x20000
    v_lshlrev_b32 v3, 4, v2
    v_and_b32 v4, 15, v2
    v_lshrrev_b32 v5, 4, v2
    v_lshlrev_b32 v6, 10, v4
    v_lshl_add_u32 v6, v5, 4, v6
    s_barrier
    s_mov_b32 s36, 0
    buffer_load_dwordx4 v[32:35], v3, s[8:11], s36 offen offset:0
    buffer_load_dwordx4 v[36:39], v3, s[8:11], s36 offen offset:1024
    buffer_load_dwordx4 v[40:43], v3, s[8:11], s36 offen offset:2048
    buffer_load_dwordx4 v[44:47], v3, s[8:11], s36 offen offset:3072
    s_mov_b32 s36, 4096
    buffer_load_dwordx4 v[48:51], v3, s[8:11], s36 offen offset:0
    buffer_load_dwordx4 v[52:55], v3, s[8:11], s36 offen offset:1024
    buffer_load_dwordx4 v[56:59], v3, s[8:11], s36 offen offset:2048
    buffer_load_dwordx4 v[60:63], v3, s[8:11], s36 offen offset:3072
    s_mov_b32 s36, 8192
    buffer_load_dwordx4 v[64:67], v3, s[8:11], s36 offen offset:0
    buffer_load_dwordx4 v[68:71], v3, s[8:11], s36 offen offset:1024
    buffer_load_dwordx4 v[72:75], v3, s[8:11], s36 offen offset:2048
    buffer_load_dwordx4 v[76:79], v3, s[8:11], s36 offen offset:3072
    s_mov_b32 s36, 12288
    buffer_load_dwordx4 v[80:83], v3, s[8:11], s36 offen offset:0
    buffer_load_dwordx4 v[84:87], v3, s[8:11], s36 offen offset:1024
    buffer_load_dwordx4 v[88:91], v3, s[8:11], s36 offen offset:2048
    buffer_load_dwordx4 v[92:95], v3, s[8:11], s36 offen offset:3072
    s_waitcnt lgkmcnt(0)
    s_mov_b32 s12, s4
    s_mov_b32 s13, s5
    s_mov_b32 s14, 16384
    s_mov_b32 s15, 0x20000
    buffer_load_dwordx4 a[0:3], v6, s[12:15], 0 offen offset:0
    buffer_load_dwordx4 a[4:7], v6, s[12:15], 0 offen offset:64
    buffer_load_dwordx4 a[8:11], v6, s[12:15], 0 offen offset:128
    buffer_load_dwordx4 a[12:15], v6, s[12:15], 0 offen offset:192
    buffer_load_dwordx4 a[16:19], v6, s[12:15], 0 offen offset:256
    buffer_load_dwordx4 a[20:23], v6, s[12:15], 0 offen offset:320
    buffer_load_dwordx4 a[24:27], v6, s[12:15], 0 offen offset:384
    buffer_load_dwordx4 a[28:31], v6, s[12:15], 0 offen offset:448
    buffer_load_dwordx4 a[32:35], v6, s[12:15], 0 offen offset:512
    buffer_load_dwordx4 a[36:39], v6, s[12:15], 0 offen offset:576
    buffer_load_dwordx4 a[40:43], v6, s[12:15], 0 offen offset:640
    buffer_load_dwordx4 a[44:47], v6, s[12:15], 0 offen offset:704
    buffer_load_dwordx4 a[48:51], v6, s[12:15], 0 offen offset:768
    buffer_load_dwordx4 a[52:55], v6, s[12:15], 0 offen offset:832
    buffer_load_dwordx4 a[56:59], v6, s[12:15], 0 offen offset:896
    buffer_load_dwordx4 a[60:63], v6, s[12:15], 0 offen offset:960
    s_add_u32 s16, s20, 21233664
    s_addc_u32 s17, s21, 0
    s_mov_b32 s18, 4096
    s_mov_b32 s19, 0x20000
    s_lshl_b32 s41, s2, 7
    v_mov_b32 v7, 0
    v_lshlrev_b32 v8, 2, v2
    v_cmp_gt_u32 vcc, 32, v2
    s_and_saveexec_b64 s[42:43], vcc
    buffer_store_dword v7, v8, s[16:19], s41 offen
    s_mov_b64 exec, s[42:43]
    s_barrier
    s_waitcnt vmcnt(1)
    v_mfma_f32_16x16x32_bf16 v[12:15], v[32:35], a[0:3], 0
    v_mfma_f32_16x16x32_bf16 v[12:15], v[36:39], a[4:7], v[12:15]
    v_mfma_f32_16x16x32_bf16 v[12:15], v[40:43], a[8:11], v[12:15]
    v_mfma_f32_16x16x32_bf16 v[12:15], v[44:47], a[12:15], v[12:15]
    v_mfma_f32_16x16x32_bf16 v[12:15], v[48:51], a[16:19], v[12:15]
    v_mfma_f32_16x16x32_bf16 v[12:15], v[52:55], a[20:23], v[12:15]
    v_mfma_f32_16x16x32_bf16 v[12:15], v[56:59], a[24:27], v[12:15]
    v_mfma_f32_16x16x32_bf16 v[12:15], v[60:63], a[28:31], v[12:15]
    v_mfma_f32_16x16x32_bf16 v[12:15], v[64:67], a[32:35], v[12:15]
    v_mfma_f32_16x16x32_bf16 v[12:15], v[68:71], a[36:39], v[12:15]
    v_mfma_f32_16x16x32_bf16 v[12:15], v[72:75], a[40:43], v[12:15]
    v_mfma_f32_16x16x32_bf16 v[12:15], v[76:79], a[44:47], v[12:15]
    v_mfma_f32_16x16x32_bf16 v[12:15], v[80:83], a[48:51], v[12:15]
    v_mfma_f32_16x16x32_bf16 v[12:15], v[84:87], a[52:55], v[12:15]
    v_mfma_f32_16x16x32_bf16 v[12:15], v[88:91], a[56:59], v[12:15]
    v_mfma_f32_16x16x32_bf16 v[12:15], v[92:95], a[60:63], v[12:15]
    v_mov_b32 v9, 0x4038aa3b
    s_nop 7
    v_fma_f32 v12, v9, v12, -1.0
    v_fma_f32 v13, v9, v13, -1.0
    v_fma_f32 v14, v9, v14, -1.0
    v_fma_f32 v15, v9, v15, -1.0
    s_add_u32 s16, s20, 20971520
    s_addc_u32 s17, s21, 0
    s_mov_b32 s18, 32768
    s_lshl_b32 s41, s2, 6
    v_lshlrev_b32 v6, 11, v4
    v_lshl_add_u32 v6, v5, 4, v6
    buffer_store_dwordx4 v[12:15], v6, s[16:19], s41 offen
    v_max3_f32 v10, abs(v12), abs(v13), abs(v14)
    v_max_f32 v10, abs(v15), v10
    v_cmp_lt_f32 vcc, 0x42700000, v10
    s_nop 4
    s_cmp_lg_u64 vcc, 0
    s_cselect_b32 s44, 1, 0
    v_mov_b32 v11, s44
    s_add_u32 s16, s20, 21037056
    s_addc_u32 s17, s21, 0
    s_mov_b32 s18, 8192
    s_lshl_b32 s41, s2, 2
    s_add_u32 s41, s41, 4096
    v_mov_b32 v8, 0
    s_mov_b64 exec, 1
    buffer_store_dword v11, v8, s[16:19], s41 offen
    s_waitcnt vmcnt(0)
    s_endpgm
conv2_kernel_hsum:
    s_add_u32 s8, s20, 21102592
    s_addc_u32 s9, s21, 0
    s_mov_b32 s10, 32768
    s_mov_b32 s11, 0x20000
    s_sub_u32 s41, s2, 32
    s_lshl_b32 s41, s41, 8
    v_lshlrev_b32 v3, 2, v2
    s_barrier
    s_add_u32 s36, s41, 0
    buffer_load_dword v32, v3, s[8:11], s36 offen
    s_add_u32 s36, s41, 2048
    buffer_load_dword v33, v3, s[8:11], s36 offen
    s_add_u32 s36, s41, 4096
    buffer_load_dword v34, v3, s[8:11], s36 offen
    s_add_u32 s36, s41, 6144
    buffer_load_dword v35, v3, s[8:11], s36 offen
    s_add_u32 s36, s41, 8192
    buffer_load_dword v36, v3, s[8:11], s36 offen
    s_add_u32 s36, s41, 10240
    buffer_load_dword v37, v3, s[8:11], s36 offen
    s_add_u32 s36, s41, 12288
    buffer_load_dword v38, v3, s[8:11], s36 offen
    s_add_u32 s36, s41, 14336
    buffer_load_dword v39, v3, s[8:11], s36 offen
    s_add_u32 s36, s41, 16384
    buffer_load_dword v40, v3, s[8:11], s36 offen
    s_add_u32 s36, s41, 18432
    buffer_load_dword v41, v3, s[8:11], s36 offen
    s_add_u32 s36, s41, 20480
    buffer_load_dword v42, v3, s[8:11], s36 offen
    s_add_u32 s36, s41, 22528
    buffer_load_dword v43, v3, s[8:11], s36 offen
    s_add_u32 s36, s41, 24576
    buffer_load_dword v44, v3, s[8:11], s36 offen
    s_add_u32 s36, s41, 26624
    buffer_load_dword v45, v3, s[8:11], s36 offen
    s_add_u32 s36, s41, 28672
    buffer_load_dword v46, v3, s[8:11], s36 offen
    s_add_u32 s36, s41, 30720
    buffer_load_dword v47, v3, s[8:11], s36 offen
    s_barrier
    s_waitcnt vmcnt(0)
    v_add_f32 v32, v32, v40
    v_add_f32 v33, v33, v41
    v_add_f32 v34, v34, v42
    v_add_f32 v35, v35, v43
    v_add_f32 v36, v36, v44
    v_add_f32 v37, v37, v45
    v_add_f32 v38, v38, v46
    v_add_f32 v39, v39, v47
    v_add_f32 v32, v32, v36
    v_add_f32 v33, v33, v37
    v_add_f32 v34, v34, v38
    v_add_f32 v35, v35, v39
    v_add_f32 v32, v32, v34
    v_add_f32 v33, v33, v35
    v_add_f32 v32, v32, v33
    s_add_u32 s8, s20, 21168128
    s_addc_u32 s9, s21, 0
    s_mov_b32 s10, 2048
    buffer_store_dword v32, v3, s[8:11], s41 offen
    s_waitcnt vmcnt(0)
    s_endpgm
.globl joint_kernel
.p2align 8
.type joint_kernel,@function
joint_kernel:
    s_cmp_ge_u32 s2, 256
    s_cbranch_scc1 joint_kernel_end
    s_getpc_b64 s[56:57]
joint_kernel_pc:
    s_mov_b32 s58, joint_kernel_slow-joint_kernel_pc
    s_mov_b32 s59, 0x20000
    v_lshlrev_b32 v5, 7, v0
    buffer_load_dword v249, v5, s[56:59], 0 offen
    s_load_dwordx2 s[20:21], s[0:1], 72
    s_load_dwordx2 s[4:5], s[0:1], 56
    v_lshrrev_b32 v1, 6, v0
    v_and_b32 v2, 63, v0
    s_and_b32 s40, s2, 7
    s_lshr_b32 s41, s2, 3
    s_and_b32 s38, s41, 7
    s_lshr_b32 s41, s41, 3
    s_lshl_b32 s39, s40, 2
    s_add_u32 s39, s39, s41
    s_and_b32 s45, s38, 1
    s_lshr_b32 s46, s39, 4
    s_and_b32 s47, s39, 15
    s_lshl_b32 s47, s47, 6
    v_readfirstlane_b32 s28, v1
    s_lshr_b32 s43, s38, 1
    s_lshl_b32 s43, s43, 4
    s_add_u32 s43, s43, s47
    v_lshlrev_b32 v3, 5, v2
    v_lshlrev_b32 v4, 4, v2
    v_xor_b32 v8, 0, v4
    v_xor_b32 v9, 32, v4
    v_xor_b32 v10, 64, v4
    v_xor_b32 v11, 96, v4
    v_xor_b32 v12, 128, v4
    v_xor_b32 v13, 160, v4
    v_xor_b32 v14, 192, v4
    v_xor_b32 v15, 224, v4
    s_waitcnt lgkmcnt(0)
    s_mul_i32 s49, s46, 1024000
    s_add_u32 s48, s49, 14680064
    s_add_u32 s68, s20, s48
    s_addc_u32 s69, s21, 0
    s_mov_b32 s70, 1024000
    s_mov_b32 s71, 0x20000
    s_lshl_b32 s49, s38, 2
    s_add_u32 s49, s49, s28
    s_lshl_b32 s49, s49, 14
    s_add_u32 s48, s49, 12582912
    s_add_u32 s52, s20, s48
    s_addc_u32 s53, s21, 0
    s_mov_b32 s54, 16384
    s_mov_b32 s55, 0x20000
    s_lshl_b32 s50, s28, 4
    s_add_u32 s50, s50, s47
    s_lshl_b32 s50, s50, 10
    s_lshl_b32 s51, s28, 14
    s_add_u32 m0, s51, 0
    s_add_u32 s36, s50, 0
    buffer_load_dwordx4 v8, s[68:71], s36 offen lds
    s_add_u32 m0, s51, 1024
    s_add_u32 s36, s50, 1024
    buffer_load_dwordx4 v9, s[68:71], s36 offen lds
    s_add_u32 m0, s51, 2048
    s_add_u32 s36, s50, 2048
    buffer_load_dwordx4 v10, s[68:71], s36 offen lds
    s_add_u32 m0, s51, 3072
    s_add_u32 s36, s50, 3072
    buffer_load_dwordx4 v11, s[68:71], s36 offen lds
    s_add_u32 m0, s51, 4096
    s_add_u32 s36, s50, 4096
    buffer_load_dwordx4 v12, s[68:71], s36 offen lds
    s_add_u32 m0, s51, 5120
    s_add_u32 s36, s50, 5120
    buffer_load_dwordx4 v13, s[68:71], s36 offen lds
    s_add_u32 m0, s51, 6144
    s_add_u32 s36, s50, 6144
    buffer_load_dwordx4 v14, s[68:71], s36 offen lds
    s_add_u32 m0, s51, 7168
    s_add_u32 s36, s50, 7168
    buffer_load_dwordx4 v15, s[68:71], s36 offen lds
    s_add_u32 m0, s51, 8192
    s_add_u32 s36, s50, 8192
    buffer_load_dwordx4 v8, s[68:71], s36 offen lds
    s_add_u32 m0, s51, 9216
    s_add_u32 s36, s50, 9216
    buffer_load_dwordx4 v9, s[68:71], s36 offen lds
    s_add_u32 m0, s51, 10240
    s_add_u32 s36, s50, 10240
    buffer_load_dwordx4 v10, s[68:71], s36 offen lds
    s_add_u32 m0, s51, 11264
    s_add_u32 s36, s50, 11264
    buffer_load_dwordx4 v11, s[68:71], s36 offen lds
    s_add_u32 m0, s51, 12288
    s_add_u32 s36, s50, 12288
    buffer_load_dwordx4 v12, s[68:71], s36 offen lds
    s_mov_b32 s37, 0
    buffer_load_dwordx4 v[32:35], v4, s[52:55], s37 offen offset:0
    s_add_u32 m0, s51, 13312
    s_add_u32 s36, s50, 13312
    buffer_load_dwordx4 v13, s[68:71], s36 offen lds
    buffer_load_dwordx4 v[36:39], v4, s[52:55], s37 offen offset:1024
    s_add_u32 m0, s51, 14336
    s_add_u32 s36, s50, 14336
    buffer_load_dwordx4 v14, s[68:71], s36 offen lds
    buffer_load_dwordx4 v[40:43], v4, s[52:55], s37 offen offset:2048
    s_add_u32 m0, s51, 15360
    s_add_u32 s36, s50, 15360
    buffer_load_dwordx4 v15, s[68:71], s36 offen lds
    buffer_load_dwordx4 v[44:47], v4, s[52:55], s37 offen offset:3072
    s_mov_b32 s37, 4096
    buffer_load_dwordx4 v[48:51], v4, s[52:55], s37 offen offset:0
    buffer_load_dwordx4 v[52:55], v4, s[52:55], s37 offen offset:1024
    buffer_load_dwordx4 v[56:59], v4, s[52:55], s37 offen offset:2048
    buffer_load_dwordx4 v[60:63], v4, s[52:55], s37 offen offset:3072
    s_mov_b32 s37, 8192
    buffer_load_dwordx4 v[64:67], v4, s[52:55], s37 offen offset:0
    buffer_load_dwordx4 v[68:71], v4, s[52:55], s37 offen offset:1024
    buffer_load_dwordx4 v[72:75], v4, s[52:55], s37 offen offset:2048
    buffer_load_dwordx4 v[76:79], v4, s[52:55], s37 offen offset:3072
    s_mov_b32 s37, 12288
    buffer_load_dwordx4 v[80:83], v4, s[52:55], s37 offen offset:0
    buffer_load_dwordx4 v[84:87], v4, s[52:55], s37 offen offset:1024
    buffer_load_dwordx4 v[88:91], v4, s[52:55], s37 offen offset:2048
    buffer_load_dwordx4 v[92:95], v4, s[52:55], s37 offen offset:3072
    s_mul_i32 s49, s46, 2048000
    s_add_u32 s48, s49, 16777216
    s_add_u32 s8, s20, s48
    s_addc_u32 s9, s21, 0
    s_mov_b32 s10, 2048000
    s_mov_b32 s11, 0x20000
    s_lshl_b32 s49, s46, 14
    s_add_u32 s48, s49, 20971520
    s_add_u32 s12, s20, s48
    s_addc_u32 s13, s21, 0
    s_mov_b32 s14, 16384
    s_mov_b32 s15, 0x20000
    s_lshl_b32 s49, s45, 2
    s_add_u32 s49, s49, s28
    s_lshl_b32 s49, s49, 16
    s_add_u32 s48, s49, 13631488
    s_add_u32 s16, s20, s48
    s_addc_u32 s17, s21, 0
    s_mov_b32 s18, 65536
    s_mov_b32 s19, 0x20000
    s_mul_i32 s49, s46, 8192000
    s_add_u32 s24, s4, s49
    s_addc_u32 s25, s5, 0
    s_mov_b32 s26, 8192000
    s_mov_b32 s27, 0x20000
    s_lshl_b32 s49, s39, 7
    s_add_u32 s48, s49, 21233664
    s_add_u32 s64, s20, s48
    s_addc_u32 s65, s21, 0
    s_mov_b32 s66, 128
    s_mov_b32 s67, 0x20000
    s_add_u32 s30, s43, s28
    s_lshl_b32 s30, s30, 11
    s_lshl_b32 s31, s43, 13
    s_lshl_b32 s49, s45, 9
    s_add_u32 s31, s31, s49
    s_lshl_b32 s49, s28, 7
    s_add_u32 s31, s31, s49
    s_add_u32 s56, s20, 21037056
    s_addc_u32 s57, s21, 0
    s_mov_b32 s58, 8192
    s_mov_b32 s59, 0x20000
    v_and_b32 v6, 31, v2
    v_lshlrev_b32 v6, 2, v6
    s_mov_b32 s49, 4096
    buffer_load_dword v31, v6, s[56:59], s49 offen
    s_lshl_b32 s49, s28, 12
    s_add_u32 s48, s49, 81920
    s_add_u32 m0, s48, 0
    s_add_u32 s36, s49, 0
    buffer_load_dwordx4 v4, s[12:15], s36 offen lds
    s_add_u32 m0, s48, 1024
    s_add_u32 s36, s49, 1024
    buffer_load_dwordx4 v4, s[12:15], s36 offen lds
    s_add_u32 m0, s48, 2048
    s_add_u32 s36, s49, 2048
    buffer_load_dwordx4 v4, s[12:15], s36 offen lds
    s_add_u32 m0, s48, 3072
    s_add_u32 s36, s49, 3072
    buffer_load_dwordx4 v4, s[12:15], s36 offen lds
    s_add_u32 s60, s20, 21168128
    s_addc_u32 s61, s21, 0
    s_mov_b32 s62, 2048
    s_mov_b32 s63, 0x20000
    s_lshl_b32 s36, s45, 10
    s_mov_b32 m0, 98304
    s_nop 0
    buffer_load_dwordx4 v4, s[60:63], s36 offen lds
    v_and_b32 v16, 15, v2
    v_lshrrev_b32 v17, 4, v2
    v_and_b32 v18, 7, v16
    v_lshlrev_b32 v18, 1, v18
    v_lshlrev_b32 v19, 10, v16
    v_add_u32 v20, 0, v17
    v_xor_b32 v20, v20, v18
    v_lshl_add_u32 v208, v20, 4, v19
    v_add_u32 v20, 4, v17
    v_xor_b32 v20, v20, v18
    v_lshl_add_u32 v209, v20, 4, v19
    v_add_u32 v20, 8, v17
    v_xor_b32 v20, v20, v18
    v_lshl_add_u32 v210, v20, 4, v19
    v_add_u32 v20, 12, v17
    v_xor_b32 v20, v20, v18
    v_lshl_add_u32 v211, v20, 4, v19
    s_lshl_b32 s49, s28, 2
    v_add_u32 v20, s49, v17
    v_xor_b32 v20, v20, v16
    v_lshlrev_b32 v20, 4, v20
    v_lshl_add_u32 v20, v16, 8, v20
    v_add_u32 v212, 0x10000, v20
    s_lshl_b32 s49, s28, 12
    s_add_u32 s49, s49, 0x10000
    v_add_u32 v213, s49, v4
    v_add_u32 v20, 0, v17
    v_xor_b32 v21, v20, v16
    v_lshlrev_b32 v21, 4, v21
    v_lshl_add_u32 v214, v20, 11, v21
    v_add_u32 v20, 4, v17
    v_xor_b32 v21, v20, v16
    v_lshlrev_b32 v21, 4, v21
    v_lshl_add_u32 v215, v20, 11, v21
    v_add_u32 v20, 8, v17
    v_xor_b32 v21, v20, v16
    v_lshlrev_b32 v21, 4, v21
    v_lshl_add_u32 v216, v20, 11, v21
    v_add_u32 v20, 12, v17
    v_xor_b32 v21, v20, v16
    v_lshlrev_b32 v21, 4, v21
    v_lshl_add_u32 v217, v20, 11, v21
    s_lshl_b32 s51, s50, 1
    s_lshl_b32 s49, s38, 8
    s_add_u32 s51, s51, s49
    v_mov_b32 v96, 0
    v_mov_b32 v97, 0
    v_mov_b32 v98, 0
    v_mov_b32 v99, 0
    v_mov_b32 v100, 0
    v_mov_b32 v101, 0
    v_mov_b32 v102, 0
    v_mov_b32 v103, 0
    v_mov_b32 v104, 0
    v_mov_b32 v105, 0
    v_mov_b32 v106, 0
    v_mov_b32 v107, 0
    v_mov_b32 v108, 0
    v_mov_b32 v109, 0
    v_mov_b32 v110, 0
    v_mov_b32 v111, 0
    v_mov_b32 v218, 0x4038aa3b
    s_waitcnt vmcnt(19)
    s_barrier
    ds_read_b128 v[112:115], v208 offset:0
    ds_read_b128 v[116:119], v208 offset:16384
    ds_read_b128 v[120:123], v208 offset:32768
    ds_read_b128 v[124:127], v208 offset:49152
    ds_read_b128 v[128:131], v209 offset:0
    ds_read_b128 v[132:135], v209 offset:16384
    ds_read_b128 v[136:139], v209 offset:32768
    ds_read_b128 v[140:143], v209 offset:49152
    ds_read_b128 v[144:147], v210 offset:0
    ds_read_b128 v[148:151], v210 offset:16384
    ds_read_b128 v[152:155], v210 offset:32768
    ds_read_b128 v[156:159], v210 offset:49152
    s_waitcnt lgkmcnt(11)
    v_mfma_f32_16x16x32_bf16 v[96:99], v[32:35], v[112:115], v[96:99]
    ds_read_b128 v[160:163], v211 offset:0
    s_waitcnt lgkmcnt(11)
    v_mfma_f32_16x16x32_bf16 v[100:103], v[32:35], v[116:119], v[100:103]
    ds_read_b128 v[164:167], v211 offset:16384
    s_waitcnt lgkmcnt(11)
    v_mfma_f32_16x16x32_bf16 v[104:107], v[32:35], v[120:123], v[104:107]
    ds_read_b128 v[168:171], v211 offset:32768
    s_waitcnt lgkmcnt(11)
    v_mfma_f32_16x16x32_bf16 v[108:111], v[32:35], v[124:127], v[108:111]
    ds_read_b128 v[172:175], v211 offset:49152
    s_waitcnt lgkmcnt(11)
    v_mfma_f32_16x16x32_bf16 v[96:99], v[36:39], v[128:131], v[96:99]
    ds_read_b128 v[112:115], v208 offset:256
    s_waitcnt lgkmcnt(11)
    v_mfma_f32_16x16x32_bf16 v[100:103], v[36:39], v[132:135], v[100:103]
    ds_read_b128 v[116:119], v208 offset:16640
    s_waitcnt lgkmcnt(11)
    v_mfma_f32_16x16x32_bf16 v[104:107], v[36:39], v[136:139], v[104:107]
    ds_read_b128 v[120:123], v208 offset:33024
    s_waitcnt lgkmcnt(11)
    v_mfma_f32_16x16x32_bf16 v[108:111], v[36:39], v[140:143], v[108:111]
    ds_read_b128 v[124:127], v208 offset:49408
    s_waitcnt lgkmcnt(11)
    v_mfma_f32_16x16x32_bf16 v[96:99], v[40:43], v[144:147], v[96:99]
    ds_read_b128 v[128:131], v209 offset:256
    s_waitcnt lgkmcnt(11)
    v_mfma_f32_16x16x32_bf16 v[100:103], v[40:43], v[148:151], v[100:103]
    ds_read_b128 v[132:135], v209 offset:16640
    s_waitcnt lgkmcnt(11)
    v_mfma_f32_16x16x32_bf16 v[104:107], v[40:43], v[152:155], v[104:107]
    ds_read_b128 v[136:139], v209 offset:33024
    s_waitcnt lgkmcnt(11)
    v_mfma_f32_16x16x32_bf16 v[108:111], v[40:43], v[156:159], v[108:111]
    ds_read_b128 v[140:143], v209 offset:49408
    s_waitcnt vmcnt(18)
    s_waitcnt lgkmcnt(11)
    v_mfma_f32_16x16x32_bf16 v[96:99], v[44:47], v[160:163], v[96:99]
    ds_read_b128 v[144:147], v210 offset:256
    s_waitcnt lgkmcnt(11)
    v_mfma_f32_16x16x32_bf16 v[100:103], v[44:47], v[164:167], v[100:103]
    ds_read_b128 v[148:151], v210 offset:16640
    s_waitcnt lgkmcnt(11)
    v_mfma_f32_16x16x32_bf16 v[104:107], v[44:47], v[168:171], v[104:107]
    ds_read_b128 v[152:155], v210 offset:33024
    s_waitcnt lgkmcnt(11)
    v_mfma_f32_16x16x32_bf16 v[108:111], v[44:47], v[172:175], v[108:111]
    ds_read_b128 v[156:159], v210 offset:49408
    s_waitcnt vmcnt(17)
    s_waitcnt lgkmcnt(11)
    v_mfma_f32_16x16x32_bf16 v[96:99], v[48:51], v[112:115], v[96:99]
    ds_read_b128 v[160:163], v211 offset:256
    s_waitcnt lgkmcnt(11)
    v_mfma_f32_16x16x32_bf16 v[100:103], v[48:51], v[116:119], v[100:103]
    ds_read_b128 v[164:167], v211 offset:16640
    s_waitcnt lgkmcnt(11)
    v_mfma_f32_16x16x32_bf16 v[104:107], v[48:51], v[120:123], v[104:107]
    ds_read_b128 v[168:171], v211 offset:33024
    s_waitcnt lgkmcnt(11)
    v_mfma_f32_16x16x32_bf16 v[108:111], v[48:51], v[124:127], v[108:111]
    ds_read_b128 v[172:175], v211 offset:49408
    s_waitcnt vmcnt(16)
    s_waitcnt lgkmcnt(11)
    v_mfma_f32_16x16x32_bf16 v[96:99], v[52:55], v[128:131], v[96:99]
    ds_read_b128 v[112:115], v208 offset:512
    s_waitcnt lgkmcnt(11)
    v_mfma_f32_16x16x32_bf16 v[100:103], v[52:55], v[132:135], v[100:103]
    ds_read_b128 v[116:119], v208 offset:16896
    s_waitcnt lgkmcnt(11)
    v_mfma_f32_16x16x32_bf16 v[104:107], v[52:55], v[136:139], v[104:107]
    ds_read_b128 v[120:123], v208 offset:33280
    s_waitcnt lgkmcnt(11)
    v_mfma_f32_16x16x32_bf16 v[108:111], v[52:55], v[140:143], v[108:111]
    ds_read_b128 v[124:127], v208 offset:49664
    s_waitcnt vmcnt(15)
    s_waitcnt lgkmcnt(11)
    v_mfma_f32_16x16x32_bf16 v[96:99], v[56:59], v[144:147], v[96:99]
    ds_read_b128 v[128:131], v209 offset:512
    s_waitcnt lgkmcnt(11)
    v_mfma_f32_16x16x32_bf16 v[100:103], v[56:59], v[148:151], v[100:103]
    ds_read_b128 v[132:135], v209 offset:16896
    s_waitcnt lgkmcnt(11)
    v_mfma_f32_16x16x32_bf16 v[104:107], v[56:59], v[152:155], v[104:107]
    ds_read_b128 v[136:139], v209 offset:33280
    s_waitcnt lgkmcnt(11)
    v_mfma_f32_16x16x32_bf16 v[108:111], v[56:59], v[156:159], v[108:111]
    ds_read_b128 v[140:143], v209 offset:49664
    s_waitcnt vmcnt(14)
    s_waitcnt lgkmcnt(11)
    v_mfma_f32_16x16x32_bf16 v[96:99], v[60:63], v[160:163], v[96:99]
    ds_read_b128 v[144:147], v210 offset:512
    s_waitcnt lgkmcnt(11)
    v_mfma_f32_16x16x32_bf16 v[100:103], v[60:63], v[164:167], v[100:103]
    ds_read_b128 v[148:151], v210 offset:16896
    s_waitcnt lgkmcnt(11)
    v_mfma_f32_16x16x32_bf16 v[104:107], v[60:63], v[168:171], v[104:107]
    ds_read_b128 v[152:155], v210 offset:33280
    s_waitcnt lgkmcnt(11)
    v_mfma_f32_16x16x32_bf16 v[108:111], v[60:63], v[172:175], v[108:111]
    ds_read_b128 v[156:159], v210 offset:49664
    s_waitcnt vmcnt(13)
    s_waitcnt lgkmcnt(11)
    v_mfma_f32_16x16x32_bf16 v[96:99], v[64:67], v[112:115], v[96:99]
    ds_read_b128 v[160:163], v211 offset:512
    s_waitcnt lgkmcnt(11)
    v_mfma_f32_16x16x32_bf16 v[100:103], v[64:67], v[116:119], v[100:103]
    ds_read_b128 v[164:167], v211 offset:16896
    s_waitcnt lgkmcnt(11)
    v_mfma_f32_16x16x32_bf16 v[104:107], v[64:67], v[120:123], v[104:107]
    ds_read_b128 v[168:171], v211 offset:33280
    s_waitcnt lgkmcnt(11)
    v_mfma_f32_16x16x32_bf16 v[108:111], v[64:67], v[124:127], v[108:111]
    ds_read_b128 v[172:175], v211 offset:49664
    s_waitcnt vmcnt(12)
    s_waitcnt lgkmcnt(11)
    v_mfma_f32_16x16x32_bf16 v[96:99], v[68:71], v[128:131], v[96:99]
    ds_read_b128 v[112:115], v208 offset:768
    s_waitcnt lgkmcnt(11)
    v_mfma_f32_16x16x32_bf16 v[100:103], v[68:71], v[132:135], v[100:103]
    ds_read_b128 v[116:119], v208 offset:17152
    s_waitcnt lgkmcnt(11)
    v_mfma_f32_16x16x32_bf16 v[104:107], v[68:71], v[136:139], v[104:107]
    ds_read_b128 v[120:123], v208 offset:33536
    s_waitcnt lgkmcnt(11)
    v_mfma_f32_16x16x32_bf16 v[108:111], v[68:71], v[140:143], v[108:111]
    ds_read_b128 v[124:127], v208 offset:49920
    s_waitcnt vmcnt(11)
    s_waitcnt lgkmcnt(11)
    v_mfma_f32_16x16x32_bf16 v[96:99], v[72:75], v[144:147], v[96:99]
    ds_read_b128 v[128:131], v209 offset:768
    s_waitcnt lgkmcnt(11)
    v_mfma_f32_16x16x32_bf16 v[100:103], v[72:75], v[148:151], v[100:103]
    ds_read_b128 v[132:135], v209 offset:17152
    s_waitcnt lgkmcnt(11)
    v_mfma_f32_16x16x32_bf16 v[104:107], v[72:75], v[152:155], v[104:107]
    ds_read_b128 v[136:139], v209 offset:33536
    s_waitcnt lgkmcnt(11)
    v_mfma_f32_16x16x32_bf16 v[108:111], v[72:75], v[156:159], v[108:111]
    ds_read_b128 v[140:143], v209 offset:49920
    s_waitcnt vmcnt(10)
    s_waitcnt lgkmcnt(11)
    v_mfma_f32_16x16x32_bf16 v[96:99], v[76:79], v[160:163], v[96:99]
    ds_read_b128 v[144:147], v210 offset:768
    s_waitcnt lgkmcnt(11)
    v_mfma_f32_16x16x32_bf16 v[100:103], v[76:79], v[164:167], v[100:103]
    ds_read_b128 v[148:151], v210 offset:17152
    s_waitcnt lgkmcnt(11)
    v_mfma_f32_16x16x32_bf16 v[104:107], v[76:79], v[168:171], v[104:107]
    ds_read_b128 v[152:155], v210 offset:33536
    s_waitcnt lgkmcnt(11)
    v_mfma_f32_16x16x32_bf16 v[108:111], v[76:79], v[172:175], v[108:111]
    ds_read_b128 v[156:159], v210 offset:49920
    s_waitcnt vmcnt(9)
    s_waitcnt lgkmcnt(11)
    v_mfma_f32_16x16x32_bf16 v[96:99], v[80:83], v[112:115], v[96:99]
    ds_read_b128 v[160:163], v211 offset:768
    s_waitcnt lgkmcnt(11)
    v_mfma_f32_16x16x32_bf16 v[100:103], v[80:83], v[116:119], v[100:103]
    ds_read_b128 v[164:167], v211 offset:17152
    s_waitcnt lgkmcnt(11)
    v_mfma_f32_16x16x32_bf16 v[104:107], v[80:83], v[120:123], v[104:107]
    ds_read_b128 v[168:171], v211 offset:33536
    s_waitcnt lgkmcnt(11)
    v_mfma_f32_16x16x32_bf16 v[108:111], v[80:83], v[124:127], v[108:111]
    ds_read_b128 v[172:175], v211 offset:49920
    s_waitcnt vmcnt(8)
    s_waitcnt lgkmcnt(11)
    v_mfma_f32_16x16x32_bf16 v[96:99], v[84:87], v[128:131], v[96:99]
    s_waitcnt lgkmcnt(10)
    v_mfma_f32_16x16x32_bf16 v[100:103], v[84:87], v[132:135], v[100:103]
    s_waitcnt lgkmcnt(9)
    v_mfma_f32_16x16x32_bf16 v[104:107], v[84:87], v[136:139], v[104:107]
    s_waitcnt lgkmcnt(8)
    v_mfma_f32_16x16x32_bf16 v[108:111], v[84:87], v[140:143], v[108:111]
    s_waitcnt vmcnt(7)
    s_waitcnt lgkmcnt(7)
    v_mfma_f32_16x16x32_bf16 v[96:99], v[88:91], v[144:147], v[96:99]
    s_waitcnt lgkmcnt(6)
    v_mfma_f32_16x16x32_bf16 v[100:103], v[88:91], v[148:151], v[100:103]
    s_waitcnt lgkmcnt(5)
    v_mfma_f32_16x16x32_bf16 v[104:107], v[88:91], v[152:155], v[104:107]
    s_waitcnt lgkmcnt(4)
    v_mfma_f32_16x16x32_bf16 v[108:111], v[88:91], v[156:159], v[108:111]
    s_waitcnt vmcnt(6)
    s_waitcnt lgkmcnt(3)
    v_mfma_f32_16x16x32_bf16 v[96:99], v[92:95], v[160:163], v[96:99]
    s_waitcnt lgkmcnt(2)
    v_mfma_f32_16x16x32_bf16 v[100:103], v[92:95], v[164:167], v[100:103]
    s_waitcnt lgkmcnt(1)
    v_mfma_f32_16x16x32_bf16 v[104:107], v[92:95], v[168:171], v[104:107]
    s_waitcnt lgkmcnt(0)
    v_mfma_f32_16x16x32_bf16 v[108:111], v[92:95], v[172:175], v[108:111]
    s_nop 7
    v_mul_f32 v96, v218, v96
    v_mul_f32 v97, v218, v97
    v_mul_f32 v98, v218, v98
    v_mul_f32 v99, v218, v99
    v_mul_f32 v100, v218, v100
    v_mul_f32 v101, v218, v101
    v_mul_f32 v102, v218, v102
    v_mul_f32 v103, v218, v103
    v_mul_f32 v104, v218, v104
    v_mul_f32 v105, v218, v105
    v_mul_f32 v106, v218, v106
    v_mul_f32 v107, v218, v107
    v_mul_f32 v108, v218, v108
    v_mul_f32 v109, v218, v109
    v_mul_f32 v110, v218, v110
    v_mul_f32 v111, v218, v111
    ds_write_b128 v212, v[96:99] offset:0
    ds_write_b128 v212, v[100:103] offset:4096
    ds_write_b128 v212, v[104:107] offset:8192
    ds_write_b128 v212, v[108:111] offset:12288
    v_mov_b32 v5, 0
    v_max3_f32 v5, abs(v96), abs(v97), v5
    v_max3_f32 v5, abs(v98), abs(v99), v5
    v_max3_f32 v5, abs(v100), abs(v101), v5
    v_max3_f32 v5, abs(v102), abs(v103), v5
    v_max3_f32 v5, abs(v104), abs(v105), v5
    v_max3_f32 v5, abs(v106), abs(v107), v5
    v_max3_f32 v5, abs(v108), abs(v109), v5
    v_max3_f32 v5, abs(v110), abs(v111), v5
    v_cmp_lt_f32 vcc, 0x42700000, v5
    s_nop 4
    s_cmp_lg_u64 vcc, 0
    s_cselect_b32 s49, 3, 1
    v_mov_b32 v7, s49
    s_lshl_b32 s49, s38, 2
    s_add_u32 s49, s49, s28
    s_lshl_b32 s34, s49, 2
    s_waitcnt vmcnt(0)
    s_waitcnt lgkmcnt(0)
    s_barrier
    ds_read_b128 v[232:235], v213 offset:0
    ds_read_b128 v[236:239], v213 offset:1024
    ds_read_b128 v[240:243], v213 offset:2048
    ds_read_b128 v[244:247], v213 offset:3072
    s_waitcnt lgkmcnt(3)
    buffer_store_dwordx4 v[232:235], v214, s[8:11], s51 offen sc1
    s_waitcnt lgkmcnt(2)
    buffer_store_dwordx4 v[236:239], v215, s[8:11], s51 offen sc1
    s_waitcnt lgkmcnt(1)
    buffer_store_dwordx4 v[240:243], v216, s[8:11], s51 offen sc1
    s_waitcnt lgkmcnt(0)
    buffer_store_dwordx4 v[244:247], v217, s[8:11], s51 offen sc1
    s_mov_b32 s35, 0
    buffer_load_dwordx4 a[0:3], v4, s[16:19], s35 offen offset:0
    buffer_load_dwordx4 a[4:7], v4, s[16:19], s35 offen offset:1024
    buffer_load_dwordx4 a[8:11], v4, s[16:19], s35 offen offset:2048
    buffer_load_dwordx4 a[12:15], v4, s[16:19], s35 offen offset:3072
    s_and_b32 s47, s28, 1
    s_lshl_b32 s47, s47, 3
    s_lshl_b32 s48, s28, 13
    s_add_u32 s49, s47, 0
    v_xor_b32 v5, s49, v2
    v_lshlrev_b32 v5, 4, v5
    s_add_u32 s49, s48, 0
    v_add_u32 v8, s49, v5
    s_add_u32 s49, s47, 1
    v_xor_b32 v5, s49, v2
    v_lshlrev_b32 v5, 4, v5
    s_add_u32 s49, s48, 1024
    v_add_u32 v9, s49, v5
    s_add_u32 s49, s47, 2
    v_xor_b32 v5, s49, v2
    v_lshlrev_b32 v5, 4, v5
    s_add_u32 s49, s48, 2048
    v_add_u32 v10, s49, v5
    s_add_u32 s49, s47, 3
    v_xor_b32 v5, s49, v2
    v_lshlrev_b32 v5, 4, v5
    s_add_u32 s49, s48, 3072
    v_add_u32 v11, s49, v5
    s_add_u32 s49, s47, 4
    v_xor_b32 v5, s49, v2
    v_lshlrev_b32 v5, 4, v5
    s_add_u32 s49, s48, 4096
    v_add_u32 v12, s49, v5
    s_add_u32 s49, s47, 5
    v_xor_b32 v5, s49, v2
    v_lshlrev_b32 v5, 4, v5
    s_add_u32 s49, s48, 5120
    v_add_u32 v13, s49, v5
    s_add_u32 s49, s47, 6
    v_xor_b32 v5, s49, v2
    v_lshlrev_b32 v5, 4, v5
    s_add_u32 s49, s48, 6144
    v_add_u32 v14, s49, v5
    s_add_u32 s49, s47, 7
    v_xor_b32 v5, s49, v2
    v_lshlrev_b32 v5, 4, v5
    s_add_u32 s49, s48, 7168
    v_add_u32 v15, s49, v5
    v_and_b32 v5, 31, v2
    v_lshrrev_b32 v6, 5, v2
    v_and_b32 v30, 15, v5
    v_lshlrev_b32 v1, 10, v5
    v_add_u32 v0, 0, v6
    v_xor_b32 v0, v0, v30
    v_lshl_add_u32 v16, v0, 4, v1
    v_add_u32 v0, 2, v6
    v_xor_b32 v0, v0, v30
    v_lshl_add_u32 v17, v0, 4, v1
    v_add_u32 v0, 4, v6
    v_xor_b32 v0, v0, v30
    v_lshl_add_u32 v18, v0, 4, v1
    v_add_u32 v0, 6, v6
    v_xor_b32 v0, v0, v30
    v_lshl_add_u32 v19, v0, 4, v1
    v_add_u32 v0, 8, v6
    v_xor_b32 v0, v0, v30
    v_lshl_add_u32 v20, v0, 4, v1
    v_add_u32 v0, 10, v6
    v_xor_b32 v0, v0, v30
    v_lshl_add_u32 v21, v0, 4, v1
    v_add_u32 v0, 12, v6
    v_xor_b32 v0, v0, v30
    v_lshl_add_u32 v22, v0, 4, v1
    v_add_u32 v0, 14, v6
    v_xor_b32 v0, v0, v30
    v_lshl_add_u32 v23, v0, 4, v1
    s_lshl_b32 s49, s28, 12
    s_add_u32 s49, s49, 65536
    v_and_b32 v30, 7, v5
    v_xor_b32 v30, v30, v6
    v_lshlrev_b32 v30, 4, v30
    v_lshl_add_u32 v30, v5, 7, v30
    v_add_u32 v30, s49, v30
    v_xor_b32 v24, 0, v30
    v_xor_b32 v25, 32, v30
    v_xor_b32 v26, 64, v30
    v_xor_b32 v27, 96, v30
    v_add_u32 v28, s49, v4
    v_lshrrev_b32 v5, 3, v2
    v_xor_b32 v6, v5, v2
    v_and_b32 v6, 7, v6
    v_lshlrev_b32 v6, 4, v6
    v_lshl_add_u32 v29, v5, 10, v6
    v_add_u32 v248, 81920, v3
    v_lshrrev_b32 v6, 5, v2
    v_lshlrev_b32 v6, 4, v6
    s_lshl_b32 s49, s28, 8
    s_add_u32 s49, s49, 98304
    v_add_u32 v250, s49, v6
    s_waitcnt vmcnt(4)
    v_mov_b32 v5, s34
    s_mov_b64 s[48:49], exec
    s_mov_b64 exec, 1
    buffer_store_dword v7, v5, s[64:67], 0 offen sc1
    s_mov_b64 exec, s[48:49]
    s_cmp_ge_u32 s43, 1000
    s_cbranch_scc1 joint_kernel_done
    ds_read_b128 v[32:35], v248 offset:0
    ds_read_b128 v[36:39], v248 offset:16
    ds_read_b128 v[40:43], v248 offset:2048
    ds_read_b128 v[44:47], v248 offset:2064
    ds_read_b128 v[48:51], v248 offset:4096
    ds_read_b128 v[52:55], v248 offset:4112
    ds_read_b128 v[56:59], v248 offset:6144
    ds_read_b128 v[60:63], v248 offset:6160
    ds_read_b128 v[64:67], v248 offset:8192
    ds_read_b128 v[68:71], v248 offset:8208
    ds_read_b128 v[72:75], v248 offset:10240
    ds_read_b128 v[76:79], v248 offset:10256
    ds_read_b128 v[80:83], v248 offset:12288
    ds_read_b128 v[84:87], v248 offset:12304
    ds_read_b128 v[88:91], v248 offset:14336
    ds_read_b128 v[92:95], v248 offset:14352
    s_waitcnt lgkmcnt(14)
    v_exp_f32 v32, v32
    v_exp_f32 v33, v33
    v_exp_f32 v34, v34
    v_exp_f32 v35, v35
    v_exp_f32 v36, v36
    v_exp_f32 v37, v37
    v_exp_f32 v38, v38
    v_exp_f32 v39, v39
    s_mov_b32 s35, 4096
    buffer_load_dwordx4 a[16:19], v4, s[16:19], s35 offen offset:0
    buffer_load_dwordx4 a[20:23], v4, s[16:19], s35 offen offset:1024
    s_waitcnt lgkmcnt(12)
    v_exp_f32 v40, v40
    v_exp_f32 v41, v41
    v_exp_f32 v42, v42
    v_exp_f32 v43, v43
    v_exp_f32 v44, v44
    v_exp_f32 v45, v45
    v_exp_f32 v46, v46
    v_exp_f32 v47, v47
    buffer_load_dwordx4 a[24:27], v4, s[16:19], s35 offen offset:2048
    buffer_load_dwordx4 a[28:31], v4, s[16:19], s35 offen offset:3072
    s_waitcnt lgkmcnt(10)
    v_exp_f32 v48, v48
    v_exp_f32 v49, v49
    v_exp_f32 v50, v50
    v_exp_f32 v51, v51
    v_exp_f32 v52, v52
    v_exp_f32 v53, v53
    v_exp_f32 v54, v54
    v_exp_f32 v55, v55
    s_mov_b32 s35, 8192
    buffer_load_dwordx4 a[32:35], v4, s[16:19], s35 offen offset:0
    buffer_load_dwordx4 a[36:39], v4, s[16:19], s35 offen offset:1024
    s_waitcnt lgkmcnt(8)
    v_exp_f32 v56, v56
    v_exp_f32 v57, v57
    v_exp_f32 v58, v58
    v_exp_f32 v59, v59
    v_exp_f32 v60, v60
    v_exp_f32 v61, v61
    v_exp_f32 v62, v62
    v_exp_f32 v63, v63
    buffer_load_dwordx4 a[40:43], v4, s[16:19], s35 offen offset:2048
    buffer_load_dwordx4 a[44:47], v4, s[16:19], s35 offen offset:3072
    s_waitcnt lgkmcnt(6)
    v_exp_f32 v64, v64
    v_exp_f32 v65, v65
    v_exp_f32 v66, v66
    v_exp_f32 v67, v67
    v_exp_f32 v68, v68
    v_exp_f32 v69, v69
    v_exp_f32 v70, v70
    v_exp_f32 v71, v71
    s_mov_b32 s35, 12288
    buffer_load_dwordx4 a[48:51], v4, s[16:19], s35 offen offset:0
    buffer_load_dwordx4 a[52:55], v4, s[16:19], s35 offen offset:1024
    s_waitcnt lgkmcnt(4)
    v_exp_f32 v72, v72
    v_exp_f32 v73, v73
    v_exp_f32 v74, v74
    v_exp_f32 v75, v75
    v_exp_f32 v76, v76
    v_exp_f32 v77, v77
    v_exp_f32 v78, v78
    v_exp_f32 v79, v79
    buffer_load_dwordx4 a[56:59], v4, s[16:19], s35 offen offset:2048
    buffer_load_dwordx4 a[60:63], v4, s[16:19], s35 offen offset:3072
    s_waitcnt lgkmcnt(2)
    v_exp_f32 v80, v80
    v_exp_f32 v81, v81
    v_exp_f32 v82, v82
    v_exp_f32 v83, v83
    v_exp_f32 v84, v84
    v_exp_f32 v85, v85
    v_exp_f32 v86, v86
    v_exp_f32 v87, v87
    s_mov_b32 s35, 16384
    buffer_load_dwordx4 a[64:67], v4, s[16:19], s35 offen offset:0
    buffer_load_dwordx4 a[68:71], v4, s[16:19], s35 offen offset:1024
    s_waitcnt lgkmcnt(0)
    v_exp_f32 v88, v88
    v_exp_f32 v89, v89
    v_exp_f32 v90, v90
    v_exp_f32 v91, v91
    v_exp_f32 v92, v92
    v_exp_f32 v93, v93
    v_exp_f32 v94, v94
    v_exp_f32 v95, v95
    buffer_load_dwordx4 a[72:75], v4, s[16:19], s35 offen offset:2048
    buffer_load_dwordx4 a[76:79], v4, s[16:19], s35 offen offset:3072
    s_mov_b32 s35, 20480
    buffer_load_dwordx4 a[80:83], v4, s[16:19], s35 offen offset:0
    buffer_load_dwordx4 a[84:87], v4, s[16:19], s35 offen offset:1024
    buffer_load_dwordx4 a[88:91], v4, s[16:19], s35 offen offset:2048
    buffer_load_dwordx4 a[92:95], v4, s[16:19], s35 offen offset:3072
    s_mov_b32 s35, 24576
    buffer_load_dwordx4 a[96:99], v4, s[16:19], s35 offen offset:0
    buffer_load_dwordx4 a[100:103], v4, s[16:19], s35 offen offset:1024
    buffer_load_dwordx4 a[104:107], v4, s[16:19], s35 offen offset:2048
    buffer_load_dwordx4 a[108:111], v4, s[16:19], s35 offen offset:3072
    v_and_b32 v5, 31, v2
    v_lshlrev_b32 v5, 2, v5
    s_mov_b32 s33, 0
    s_cmp_lg_u32 s28, 0
    s_cbranch_scc1 joint_kernel_got
joint_kernel_poll:
    buffer_load_dword v6, v5, s[64:67], 0 offen sc1
    s_waitcnt vmcnt(0)
    v_cmp_ne_u32 vcc, 0, v6
    s_add_u32 s33, s33, 1
    s_nop 2
    s_cmp_eq_u64 vcc, -1
    s_cbranch_scc1 joint_kernel_got0
    s_sleep 2
    s_cmp_lt_u32 s33, 100000
    s_cbranch_scc1 joint_kernel_poll
joint_kernel_got0:
    v_add_u32 v0, 99328, v5
    ds_write_b32 v0, v6
    s_waitcnt lgkmcnt(0)
joint_kernel_got:
    s_barrier
    v_add_u32 v0, 99328, v5
    ds_read_b32 v6, v0
    s_waitcnt vmcnt(0) lgkmcnt(0)
    s_add_u32 s36, s30, 0
    buffer_load_dwordx4 v[96:99], v3, s[8:11], s36 offen offset:0 sc1
    buffer_load_dwordx4 v[100:103], v3, s[8:11], s36 offen offset:16 sc1
    s_add_u32 s36, s30, 8192
    buffer_load_dwordx4 v[104:107], v3, s[8:11], s36 offen offset:0 sc1
    buffer_load_dwordx4 v[108:111], v3, s[8:11], s36 offen offset:16 sc1
    v_and_b32 v6, 2, v6
    v_or_b32 v6, v6, v31
    v_cmp_ne_u32 vcc, 0, v6
    s_nop 4
    s_cbranch_vccnz joint_kernel_slow
    s_waitcnt vmcnt(2)
    v_exp_f32 v96, v96
    v_exp_f32 v97, v97
    v_exp_f32 v98, v98
    v_exp_f32 v99, v99
    s_mov_b32 s35, 28672
    buffer_load_dwordx4 a[112:115], v4, s[16:19], s35 offen offset:0
    v_exp_f32 v100, v100
    v_exp_f32 v101, v101
    v_exp_f32 v102, v102
    v_exp_f32 v103, v103
    buffer_load_dwordx4 a[116:119], v4, s[16:19], s35 offen offset:1024
    v_fma_f32 v208, v96, -v32, -0.5
    v_fma_f32 v209, v97, -v33, -0.5
    v_fma_f32 v210, v98, -v34, -0.5
    v_fma_f32 v211, v99, -v35, -0.5
    v_fma_f32 v212, v100, -v36, -0.5
    v_fma_f32 v213, v101, -v37, -0.5
    v_fma_f32 v214, v102, -v38, -0.5
    v_fma_f32 v215, v103, -v39, -0.5
    buffer_load_dwordx4 a[120:123], v4, s[16:19], s35 offen offset:2048
    v_rcp_f32 v208, v208
    v_rcp_f32 v209, v209
    v_rcp_f32 v210, v210
    v_rcp_f32 v211, v211
    buffer_load_dwordx4 a[124:127], v4, s[16:19], s35 offen offset:3072
    v_rcp_f32 v212, v212
    v_rcp_f32 v213, v213
    v_rcp_f32 v214, v214
    v_rcp_f32 v215, v215
    s_mov_b32 s35, 32768
    buffer_load_dwordx4 a[128:131], v4, s[16:19], s35 offen offset:0
    v_cvt_pk_bf16_f32 v224, v208, v209
    v_cvt_pk_bf16_f32 v225, v210, v211
    v_cvt_pk_bf16_f32 v226, v212, v213
    v_cvt_pk_bf16_f32 v227, v214, v215
    ds_write_b128 v8, v[224:227] offset:0
    v_fma_f32 v216, v96, -v40, -0.5
    buffer_load_dwordx4 a[132:135], v4, s[16:19], s35 offen offset:1024
    v_fma_f32 v217, v97, -v41, -0.5
    v_fma_f32 v218, v98, -v42, -0.5
    v_fma_f32 v219, v99, -v43, -0.5
    v_fma_f32 v220, v100, -v44, -0.5
    v_fma_f32 v221, v101, -v45, -0.5
    v_fma_f32 v222, v102, -v46, -0.5
    v_fma_f32 v223, v103, -v47, -0.5
    v_rcp_f32 v216, v216
    buffer_load_dwordx4 a[136:139], v4, s[16:19], s35 offen offset:2048
    v_rcp_f32 v217, v217
    v_rcp_f32 v218, v218
    v_rcp_f32 v219, v219
    v_rcp_f32 v220, v220
    buffer_load_dwordx4 a[140:143], v4, s[16:19], s35 offen offset:3072
    v_rcp_f32 v221, v221
    v_rcp_f32 v222, v222
    v_rcp_f32 v223, v223
    v_cvt_pk_bf16_f32 v228, v216, v217
    v_cvt_pk_bf16_f32 v229, v218, v219
    s_mov_b32 s35, 36864
    buffer_load_dwordx4 a[144:147], v4, s[16:19], s35 offen offset:0
    v_cvt_pk_bf16_f32 v230, v220, v221
    v_cvt_pk_bf16_f32 v231, v222, v223
    ds_write_b128 v9, v[228:231] offset:0
    v_fma_f32 v208, v96, -v48, -0.5
    v_fma_f32 v209, v97, -v49, -0.5
    v_fma_f32 v210, v98, -v50, -0.5
    buffer_load_dwordx4 a[148:151], v4, s[16:19], s35 offen offset:1024
    v_fma_f32 v211, v99, -v51, -0.5
    v_fma_f32 v212, v100, -v52, -0.5
    v_fma_f32 v213, v101, -v53, -0.5
    v_fma_f32 v214, v102, -v54, -0.5
    v_fma_f32 v215, v103, -v55, -0.5
    v_rcp_f32 v208, v208
    v_rcp_f32 v209, v209
    buffer_load_dwordx4 a[152:155], v4, s[16:19], s35 offen offset:2048
    v_rcp_f32 v210, v210
    v_rcp_f32 v211, v211
    v_rcp_f32 v212, v212
    v_rcp_f32 v213, v213
    buffer_load_dwordx4 a[156:159], v4, s[16:19], s35 offen offset:3072
    v_rcp_f32 v214, v214
    v_rcp_f32 v215, v215
    v_cvt_pk_bf16_f32 v224, v208, v209
    v_cvt_pk_bf16_f32 v225, v210, v211
    v_cvt_pk_bf16_f32 v226, v212, v213
    v_cvt_pk_bf16_f32 v227, v214, v215
    s_mov_b32 s35, 40960
    buffer_load_dwordx4 a[160:163], v4, s[16:19], s35 offen offset:0
    ds_write_b128 v10, v[224:227] offset:0
    v_fma_f32 v216, v96, -v56, -0.5
    v_fma_f32 v217, v97, -v57, -0.5
    v_fma_f32 v218, v98, -v58, -0.5
    v_fma_f32 v219, v99, -v59, -0.5
    v_fma_f32 v220, v100, -v60, -0.5
    buffer_load_dwordx4 a[164:167], v4, s[16:19], s35 offen offset:1024
    v_fma_f32 v221, v101, -v61, -0.5
    v_fma_f32 v222, v102, -v62, -0.5
    v_fma_f32 v223, v103, -v63, -0.5
    v_rcp_f32 v216, v216
    v_rcp_f32 v217, v217
    v_rcp_f32 v218, v218
    buffer_load_dwordx4 a[168:171], v4, s[16:19], s35 offen offset:2048
    v_rcp_f32 v219, v219
    v_rcp_f32 v220, v220
    v_rcp_f32 v221, v221
    v_rcp_f32 v222, v222
    buffer_load_dwordx4 a[172:175], v4, s[16:19], s35 offen offset:3072
    v_rcp_f32 v223, v223
    v_cvt_pk_bf16_f32 v228, v216, v217
    v_cvt_pk_bf16_f32 v229, v218, v219
    v_cvt_pk_bf16_f32 v230, v220, v221
    v_cvt_pk_bf16_f32 v231, v222, v223
    ds_write_b128 v11, v[228:231] offset:0
    s_mov_b32 s35, 45056
    buffer_load_dwordx4 a[176:179], v4, s[16:19], s35 offen offset:0
    v_fma_f32 v208, v96, -v64, -0.5
    v_fma_f32 v209, v97, -v65, -0.5
    v_fma_f32 v210, v98, -v66, -0.5
    v_fma_f32 v211, v99, -v67, -0.5
    v_fma_f32 v212, v100, -v68, -0.5
    v_fma_f32 v213, v101, -v69, -0.5
    v_fma_f32 v214, v102, -v70, -0.5
    v_fma_f32 v215, v103, -v71, -0.5
    buffer_load_dwordx4 a[180:183], v4, s[16:19], s35 offen offset:1024
    v_rcp_f32 v208, v208
    v_rcp_f32 v209, v209
    v_rcp_f32 v210, v210
    v_rcp_f32 v211, v211
    buffer_load_dwordx4 a[184:187], v4, s[16:19], s35 offen offset:2048
    v_rcp_f32 v212, v212
    v_rcp_f32 v213, v213
    v_rcp_f32 v214, v214
    v_rcp_f32 v215, v215
    buffer_load_dwordx4 a[188:191], v4, s[16:19], s35 offen offset:3072
    v_cvt_pk_bf16_f32 v224, v208, v209
    v_cvt_pk_bf16_f32 v225, v210, v211
    v_cvt_pk_bf16_f32 v226, v212, v213
    v_cvt_pk_bf16_f32 v227, v214, v215
    ds_write_b128 v12, v[224:227] offset:0
    v_fma_f32 v216, v96, -v72, -0.5
    s_mov_b32 s35, 49152
    buffer_load_dwordx4 a[192:195], v4, s[16:19], s35 offen offset:0
    v_fma_f32 v217, v97, -v73, -0.5
    v_fma_f32 v218, v98, -v74, -0.5
    v_fma_f32 v219, v99, -v75, -0.5
    v_fma_f32 v220, v100, -v76, -0.5
    v_fma_f32 v221, v101, -v77, -0.5
    v_fma_f32 v222, v102, -v78, -0.5
    v_fma_f32 v223, v103, -v79, -0.5
    v_rcp_f32 v216, v216
    buffer_load_dwordx4 a[196:199], v4, s[16:19], s35 offen offset:1024
    v_rcp_f32 v217, v217
    v_rcp_f32 v218, v218
    v_rcp_f32 v219, v219
    v_rcp_f32 v220, v220
    buffer_load_dwordx4 a[200:203], v4, s[16:19], s35 offen offset:2048
    v_rcp_f32 v221, v221
    v_rcp_f32 v222, v222
    v_rcp_f32 v223, v223
    v_cvt_pk_bf16_f32 v228, v216, v217
    v_cvt_pk_bf16_f32 v229, v218, v219
    buffer_load_dwordx4 a[204:207], v4, s[16:19], s35 offen offset:3072
    v_cvt_pk_bf16_f32 v230, v220, v221
    v_cvt_pk_bf16_f32 v231, v222, v223
    ds_write_b128 v13, v[228:231] offset:0
    v_fma_f32 v208, v96, -v80, -0.5
    v_fma_f32 v209, v97, -v81, -0.5
    v_fma_f32 v210, v98, -v82, -0.5
    s_mov_b32 s35, 53248
    buffer_load_dwordx4 a[208:211], v4, s[16:19], s35 offen offset:0
    v_fma_f32 v211, v99, -v83, -0.5
    v_fma_f32 v212, v100, -v84, -0.5
    v_fma_f32 v213, v101, -v85, -0.5
    v_fma_f32 v214, v102, -v86, -0.5
    v_fma_f32 v215, v103, -v87, -0.5
    v_rcp_f32 v208, v208
    v_rcp_f32 v209, v209
    buffer_load_dwordx4 a[212:215], v4, s[16:19], s35 offen offset:1024
    v_rcp_f32 v210, v210
    v_rcp_f32 v211, v211
    v_rcp_f32 v212, v212
    v_rcp_f32 v213, v213
    buffer_load_dwordx4 a[216:219], v4, s[16:19], s35 offen offset:2048
    v_rcp_f32 v214, v214
    v_rcp_f32 v215, v215
    v_cvt_pk_bf16_f32 v224, v208, v209
    v_cvt_pk_bf16_f32 v225, v210, v211
    v_cvt_pk_bf16_f32 v226, v212, v213
    v_cvt_pk_bf16_f32 v227, v214, v215
    buffer_load_dwordx4 a[220:223], v4, s[16:19], s35 offen offset:3072
    ds_write_b128 v14, v[224:227] offset:0
    v_fma_f32 v216, v96, -v88, -0.5
    v_fma_f32 v217, v97, -v89, -0.5
    v_fma_f32 v218, v98, -v90, -0.5
    v_fma_f32 v219, v99, -v91, -0.5
    v_fma_f32 v220, v100, -v92, -0.5
    s_mov_b32 s35, 57344
    buffer_load_dwordx4 a[224:227], v4, s[16:19], s35 offen offset:0
    v_fma_f32 v221, v101, -v93, -0.5
    v_fma_f32 v222, v102, -v94, -0.5
    v_fma_f32 v223, v103, -v95, -0.5
    v_rcp_f32 v216, v216
    v_rcp_f32 v217, v217
    v_rcp_f32 v218, v218
    buffer_load_dwordx4 a[228:231], v4, s[16:19], s35 offen offset:1024
    v_rcp_f32 v219, v219
    v_rcp_f32 v220, v220
    v_rcp_f32 v221, v221
    v_rcp_f32 v222, v222
    buffer_load_dwordx4 a[232:235], v4, s[16:19], s35 offen offset:2048
    v_rcp_f32 v223, v223
    v_cvt_pk_bf16_f32 v228, v216, v217
    v_cvt_pk_bf16_f32 v229, v218, v219
    v_cvt_pk_bf16_f32 v230, v220, v221
    v_cvt_pk_bf16_f32 v231, v222, v223
    ds_write_b128 v15, v[228:231] offset:0
    buffer_load_dwordx4 a[236:239], v4, s[16:19], s35 offen offset:3072
    ds_read_b128 v[112:115], v250 offset:0
    ds_read_b128 v[116:119], v250 offset:32
    ds_read_b128 v[120:123], v250 offset:64
    ds_read_b128 v[124:127], v250 offset:96
    ds_read_b128 v[128:131], v250 offset:128
    ds_read_b128 v[132:135], v250 offset:160
    ds_read_b128 v[136:139], v250 offset:192
    ds_read_b128 v[140:143], v250 offset:224
    ds_read_b128 v[144:147], v250 offset:0
    ds_read_b128 v[148:151], v250 offset:32
    ds_read_b128 v[152:155], v250 offset:64
    ds_read_b128 v[156:159], v250 offset:96
    ds_read_b128 v[160:163], v250 offset:128
    ds_read_b128 v[164:167], v250 offset:160
    ds_read_b128 v[168:171], v250 offset:192
    ds_read_b128 v[172:175], v250 offset:224
    s_waitcnt lgkmcnt(0)
    s_barrier
    ds_read_b128 v[176:179], v16 offset:0
    ds_read_b128 v[180:183], v17 offset:0
    ds_read_b128 v[184:187], v18 offset:0
    ds_read_b128 v[188:191], v19 offset:0
    ds_read_b128 v[192:195], v20 offset:0
    ds_read_b128 v[196:199], v21 offset:0
    s_waitcnt lgkmcnt(4)
    v_mfma_f32_32x32x16_bf16 v[112:127], a[0:3], v[176:179], v[112:127]
    s_mov_b32 s35, 61440
    buffer_load_dwordx4 a[240:243], v4, s[16:19], s35 offen offset:0
    ds_read_b128 v[200:203], v22 offset:0
    s_add_u32 s36, s30, 16384
    buffer_load_dwordx4 v[96:99], v3, s[8:11], s36 offen offset:0 sc1
    buffer_load_dwordx4 v[100:103], v3, s[8:11], s36 offen offset:16 sc1
    s_waitcnt vmcnt(35)
    v_exp_f32 v104, v104
    v_exp_f32 v105, v105
    v_mfma_f32_32x32x16_bf16 v[128:143], a[4:7], v[176:179], v[128:143]
    buffer_load_dwordx4 a[244:247], v4, s[16:19], s35 offen offset:1024
    v_exp_f32 v106, v106
    v_exp_f32 v107, v107
    v_mfma_f32_32x32x16_bf16 v[112:127], a[8:11], v[180:183], v[112:127]
    buffer_load_dwordx4 a[248:251], v4, s[16:19], s35 offen offset:2048
    ds_read_b128 v[204:207], v23 offset:0
    v_exp_f32 v108, v108
    v_exp_f32 v109, v109
    v_mfma_f32_32x32x16_bf16 v[128:143], a[12:15], v[180:183], v[128:143]
    buffer_load_dwordx4 a[252:255], v4, s[16:19], s35 offen offset:3072
    v_exp_f32 v110, v110
    v_exp_f32 v111, v111
    v_fma_f32 v208, v104, -v32, -0.5
    s_waitcnt lgkmcnt(4)
    v_mfma_f32_32x32x16_bf16 v[112:127], a[16:19], v[184:187], v[112:127]
    ds_read_b128 v[176:179], v16 offset:256
    v_fma_f32 v209, v105, -v33, -0.5
    v_fma_f32 v210, v106, -v34, -0.5
    v_fma_f32 v211, v107, -v35, -0.5
    v_fma_f32 v212, v108, -v36, -0.5
    v_fma_f32 v213, v109, -v37, -0.5
    v_mfma_f32_32x32x16_bf16 v[128:143], a[20:23], v[184:187], v[128:143]
    v_fma_f32 v214, v110, -v38, -0.5
    v_fma_f32 v215, v111, -v39, -0.5
    v_rcp_f32 v208, v208
    v_rcp_f32 v209, v209
    v_mfma_f32_32x32x16_bf16 v[112:127], a[24:27], v[188:191], v[112:127]
    ds_read_b128 v[180:183], v17 offset:256
    v_rcp_f32 v210, v210
    v_rcp_f32 v211, v211
    v_rcp_f32 v212, v212
    v_mfma_f32_32x32x16_bf16 v[128:143], a[28:31], v[188:191], v[128:143]
    v_rcp_f32 v213, v213
    v_rcp_f32 v214, v214
    v_rcp_f32 v215, v215
    s_waitcnt lgkmcnt(4)
    v_mfma_f32_32x32x16_bf16 v[112:127], a[32:35], v[192:195], v[112:127]
    ds_read_b128 v[184:187], v18 offset:256
    v_cvt_pk_bf16_f32 v224, v208, v209
    v_cvt_pk_bf16_f32 v225, v210, v211
    v_cvt_pk_bf16_f32 v226, v212, v213
    v_cvt_pk_bf16_f32 v227, v214, v215
    v_mfma_f32_32x32x16_bf16 v[128:143], a[36:39], v[192:195], v[128:143]
    ds_write_b128 v8, v[224:227] offset:32768
    v_fma_f32 v216, v104, -v40, -0.5
    v_fma_f32 v217, v105, -v41, -0.5
    v_fma_f32 v218, v106, -v42, -0.5
    v_mfma_f32_32x32x16_bf16 v[112:127], a[40:43], v[196:199], v[112:127]
    ds_read_b128 v[188:191], v19 offset:256
    v_fma_f32 v219, v107, -v43, -0.5
    v_fma_f32 v220, v108, -v44, -0.5
    v_fma_f32 v221, v109, -v45, -0.5
    v_fma_f32 v222, v110, -v46, -0.5
    v_fma_f32 v223, v111, -v47, -0.5
    v_mfma_f32_32x32x16_bf16 v[128:143], a[44:47], v[196:199], v[128:143]
    v_rcp_f32 v216, v216
    v_rcp_f32 v217, v217
    v_rcp_f32 v218, v218
    s_waitcnt lgkmcnt(5)
    v_mfma_f32_32x32x16_bf16 v[112:127], a[48:51], v[200:203], v[112:127]
    ds_read_b128 v[192:195], v20 offset:256
    v_rcp_f32 v219, v219
    v_rcp_f32 v220, v220
    v_rcp_f32 v221, v221
    v_mfma_f32_32x32x16_bf16 v[128:143], a[52:55], v[200:203], v[128:143]
    v_rcp_f32 v222, v222
    v_rcp_f32 v223, v223
    v_cvt_pk_bf16_f32 v228, v216, v217
    v_mfma_f32_32x32x16_bf16 v[112:127], a[56:59], v[204:207], v[112:127]
    ds_read_b128 v[196:199], v21 offset:256
    v_cvt_pk_bf16_f32 v229, v218, v219
    v_cvt_pk_bf16_f32 v230, v220, v221
    v_cvt_pk_bf16_f32 v231, v222, v223
    ds_write_b128 v9, v[228:231] offset:32768
    v_mfma_f32_32x32x16_bf16 v[128:143], a[60:63], v[204:207], v[128:143]
    v_fma_f32 v208, v104, -v48, -0.5
    v_fma_f32 v209, v105, -v49, -0.5
    v_fma_f32 v210, v106, -v50, -0.5
    v_fma_f32 v211, v107, -v51, -0.5
    v_fma_f32 v212, v108, -v52, -0.5
    s_waitcnt lgkmcnt(6)
    v_mfma_f32_32x32x16_bf16 v[112:127], a[64:67], v[176:179], v[112:127]
    ds_read_b128 v[200:203], v22 offset:256
    v_fma_f32 v213, v109, -v53, -0.5
    v_fma_f32 v214, v110, -v54, -0.5
    v_fma_f32 v215, v111, -v55, -0.5
    v_rcp_f32 v208, v208
    v_mfma_f32_32x32x16_bf16 v[128:143], a[68:71], v[176:179], v[128:143]
    v_rcp_f32 v209, v209
    v_rcp_f32 v210, v210
    v_rcp_f32 v211, v211
    v_mfma_f32_32x32x16_bf16 v[112:127], a[72:75], v[180:183], v[112:127]
    ds_read_b128 v[204:207], v23 offset:256
    v_rcp_f32 v212, v212
    v_rcp_f32 v213, v213
    v_rcp_f32 v214, v214
    v_mfma_f32_32x32x16_bf16 v[128:143], a[76:79], v[180:183], v[128:143]
    v_rcp_f32 v215, v215
    v_cvt_pk_bf16_f32 v224, v208, v209
    v_cvt_pk_bf16_f32 v225, v210, v211
    v_cvt_pk_bf16_f32 v226, v212, v213
    s_waitcnt lgkmcnt(5)
    v_mfma_f32_32x32x16_bf16 v[112:127], a[80:83], v[184:187], v[112:127]
    ds_read_b128 v[176:179], v16 offset:512
    v_cvt_pk_bf16_f32 v227, v214, v215
    ds_write_b128 v10, v[224:227] offset:32768
    v_fma_f32 v216, v104, -v56, -0.5
    v_mfma_f32_32x32x16_bf16 v[128:143], a[84:87], v[184:187], v[128:143]
    v_fma_f32 v217, v105, -v57, -0.5
    v_fma_f32 v218, v106, -v58, -0.5
    v_fma_f32 v219, v107, -v59, -0.5
    v_fma_f32 v220, v108, -v60, -0.5
    v_fma_f32 v221, v109, -v61, -0.5
    v_fma_f32 v222, v110, -v62, -0.5
    v_mfma_f32_32x32x16_bf16 v[112:127], a[88:91], v[188:191], v[112:127]
    ds_read_b128 v[180:183], v17 offset:512
    v_fma_f32 v223, v111, -v63, -0.5
    v_rcp_f32 v216, v216
    v_rcp_f32 v217, v217
    v_mfma_f32_32x32x16_bf16 v[128:143], a[92:95], v[188:191], v[128:143]
    v_rcp_f32 v218, v218
    v_rcp_f32 v219, v219
    v_rcp_f32 v220, v220
    s_waitcnt lgkmcnt(6)
    v_mfma_f32_32x32x16_bf16 v[112:127], a[96:99], v[192:195], v[112:127]
    ds_read_b128 v[184:187], v18 offset:512
    v_rcp_f32 v221, v221
    v_rcp_f32 v222, v222
    v_rcp_f32 v223, v223
    v_mfma_f32_32x32x16_bf16 v[128:143], a[100:103], v[192:195], v[128:143]
    v_cvt_pk_bf16_f32 v228, v216, v217
    v_cvt_pk_bf16_f32 v229, v218, v219
    v_cvt_pk_bf16_f32 v230, v220, v221
    v_cvt_pk_bf16_f32 v231, v222, v223
    ds_write_b128 v11, v[228:231] offset:32768
    v_mfma_f32_32x32x16_bf16 v[112:127], a[104:107], v[196:199], v[112:127]
    ds_read_b128 v[188:191], v19 offset:512
    v_fma_f32 v208, v104, -v64, -0.5
    v_fma_f32 v209, v105, -v65, -0.5
    v_fma_f32 v210, v106, -v66, -0.5
    v_mfma_f32_32x32x16_bf16 v[128:143], a[108:111], v[196:199], v[128:143]
    v_fma_f32 v211, v107, -v67, -0.5
    v_fma_f32 v212, v108, -v68, -0.5
    v_fma_f32 v213, v109, -v69, -0.5
    v_fma_f32 v214, v110, -v70, -0.5
    v_fma_f32 v215, v111, -v71, -0.5
    v_rcp_f32 v208, v208
    s_waitcnt vmcnt(37)
    s_waitcnt lgkmcnt(6)
    v_mfma_f32_32x32x16_bf16 v[112:127], a[112:115], v[200:203], v[112:127]
    ds_read_b128 v[192:195], v20 offset:512
    v_rcp_f32 v209, v209
    v_rcp_f32 v210, v210
    s_waitcnt vmcnt(36)
    v_mfma_f32_32x32x16_bf16 v[128:143], a[116:119], v[200:203], v[128:143]
    v_rcp_f32 v211, v211
    v_rcp_f32 v212, v212
    v_rcp_f32 v213, v213
    s_waitcnt vmcnt(35)
    v_mfma_f32_32x32x16_bf16 v[112:127], a[120:123], v[204:207], v[112:127]
    ds_read_b128 v[196:199], v21 offset:512
    v_rcp_f32 v214, v214
    v_rcp_f32 v215, v215
    v_cvt_pk_bf16_f32 v224, v208, v209
    s_waitcnt vmcnt(34)
    v_mfma_f32_32x32x16_bf16 v[128:143], a[124:127], v[204:207], v[128:143]
    v_cvt_pk_bf16_f32 v225, v210, v211
    v_cvt_pk_bf16_f32 v226, v212, v213
    v_cvt_pk_bf16_f32 v227, v214, v215
    ds_write_b128 v12, v[224:227] offset:32768
    s_waitcnt vmcnt(33)
    s_waitcnt lgkmcnt(6)
    v_mfma_f32_32x32x16_bf16 v[112:127], a[128:131], v[176:179], v[112:127]
    ds_read_b128 v[200:203], v22 offset:512
    v_fma_f32 v216, v104, -v72, -0.5
    v_fma_f32 v217, v105, -v73, -0.5
    v_fma_f32 v218, v106, -v74, -0.5
    v_fma_f32 v219, v107, -v75, -0.5
    v_fma_f32 v220, v108, -v76, -0.5
    s_waitcnt vmcnt(32)
    v_mfma_f32_32x32x16_bf16 v[128:143], a[132:135], v[176:179], v[128:143]
    v_fma_f32 v221, v109, -v77, -0.5
    v_fma_f32 v222, v110, -v78, -0.5
    v_fma_f32 v223, v111, -v79, -0.5
    v_rcp_f32 v216, v216
    v_rcp_f32 v217, v217
    s_waitcnt vmcnt(31)
    v_mfma_f32_32x32x16_bf16 v[112:127], a[136:139], v[180:183], v[112:127]
    ds_read_b128 v[204:207], v23 offset:512
    v_rcp_f32 v218, v218
    v_rcp_f32 v219, v219
    s_waitcnt vmcnt(30)
    v_mfma_f32_32x32x16_bf16 v[128:143], a[140:143], v[180:183], v[128:143]
    v_rcp_f32 v220, v220
    v_rcp_f32 v221, v221
    v_rcp_f32 v222, v222
    s_waitcnt vmcnt(29)
    s_waitcnt lgkmcnt(5)
    v_mfma_f32_32x32x16_bf16 v[112:127], a[144:147], v[184:187], v[112:127]
    ds_read_b128 v[176:179], v16 offset:768
    v_rcp_f32 v223, v223
    v_cvt_pk_bf16_f32 v228, v216, v217
    v_cvt_pk_bf16_f32 v229, v218, v219
    v_cvt_pk_bf16_f32 v230, v220, v221
    s_waitcnt vmcnt(28)
    v_mfma_f32_32x32x16_bf16 v[128:143], a[148:151], v[184:187], v[128:143]
    v_cvt_pk_bf16_f32 v231, v222, v223
    ds_write_b128 v13, v[228:231] offset:32768
    v_fma_f32 v208, v104, -v80, -0.5
    v_fma_f32 v209, v105, -v81, -0.5
    s_waitcnt vmcnt(27)
    v_mfma_f32_32x32x16_bf16 v[112:127], a[152:155], v[188:191], v[112:127]
    ds_read_b128 v[180:183], v17 offset:768
    v_fma_f32 v210, v106, -v82, -0.5
    v_fma_f32 v211, v107, -v83, -0.5
    v_fma_f32 v212, v108, -v84, -0.5
    v_fma_f32 v213, v109, -v85, -0.5
    v_fma_f32 v214, v110, -v86, -0.5
    s_waitcnt vmcnt(26)
    v_mfma_f32_32x32x16_bf16 v[128:143], a[156:159], v[188:191], v[128:143]
    v_fma_f32 v215, v111, -v87, -0.5
    v_rcp_f32 v208, v208
    v_rcp_f32 v209, v209
    v_rcp_f32 v210, v210
    s_waitcnt vmcnt(25)
    s_waitcnt lgkmcnt(6)
    v_mfma_f32_32x32x16_bf16 v[112:127], a[160:163], v[192:195], v[112:127]
    ds_read_b128 v[184:187], v18 offset:768
    v_rcp_f32 v211, v211
    v_rcp_f32 v212, v212
    s_waitcnt vmcnt(24)
    v_mfma_f32_32x32x16_bf16 v[128:143], a[164:167], v[192:195], v[128:143]
    v_rcp_f32 v213, v213
    v_rcp_f32 v214, v214
    v_rcp_f32 v215, v215
    s_waitcnt vmcnt(23)
    v_mfma_f32_32x32x16_bf16 v[112:127], a[168:171], v[196:199], v[112:127]
    ds_read_b128 v[188:191], v19 offset:768
    v_cvt_pk_bf16_f32 v224, v208, v209
    v_cvt_pk_bf16_f32 v225, v210, v211
    v_cvt_pk_bf16_f32 v226, v212, v213
    v_cvt_pk_bf16_f32 v227, v214, v215
    ds_write_b128 v14, v[224:227] offset:32768
    s_waitcnt vmcnt(22)
    v_mfma_f32_32x32x16_bf16 v[128:143], a[172:175], v[196:199], v[128:143]
    v_fma_f32 v216, v104, -v88, -0.5
    v_fma_f32 v217, v105, -v89, -0.5
    v_fma_f32 v218, v106, -v90, -0.5
    v_fma_f32 v219, v107, -v91, -0.5
    s_waitcnt vmcnt(21)
    s_waitcnt lgkmcnt(6)
    v_mfma_f32_32x32x16_bf16 v[112:127], a[176:179], v[200:203], v[112:127]
    ds_read_b128 v[192:195], v20 offset:768
    v_fma_f32 v220, v108, -v92, -0.5
    v_fma_f32 v221, v109, -v93, -0.5
    v_fma_f32 v222, v110, -v94, -0.5
    v_fma_f32 v223, v111, -v95, -0.5
    v_rcp_f32 v216, v216
    s_waitcnt vmcnt(20)
    v_mfma_f32_32x32x16_bf16 v[128:143], a[180:183], v[200:203], v[128:143]
    v_rcp_f32 v217, v217
    v_rcp_f32 v218, v218
    v_rcp_f32 v219, v219
    s_waitcnt vmcnt(19)
    v_mfma_f32_32x32x16_bf16 v[112:127], a[184:187], v[204:207], v[112:127]
    ds_read_b128 v[196:199], v21 offset:768
    v_rcp_f32 v220, v220
    v_rcp_f32 v221, v221
    s_waitcnt vmcnt(18)
    v_mfma_f32_32x32x16_bf16 v[128:143], a[188:191], v[204:207], v[128:143]
    v_rcp_f32 v222, v222
    v_rcp_f32 v223, v223
    v_cvt_pk_bf16_f32 v228, v216, v217
    v_cvt_pk_bf16_f32 v229, v218, v219
    s_waitcnt vmcnt(17)
    s_waitcnt lgkmcnt(5)
    v_mfma_f32_32x32x16_bf16 v[112:127], a[192:195], v[176:179], v[112:127]
    ds_read_b128 v[200:203], v22 offset:768
    v_cvt_pk_bf16_f32 v230, v220, v221
    v_cvt_pk_bf16_f32 v231, v222, v223
    ds_write_b128 v15, v[228:231] offset:32768
    s_waitcnt vmcnt(16)
    v_mfma_f32_32x32x16_bf16 v[128:143], a[196:199], v[176:179], v[128:143]
    s_waitcnt vmcnt(15)
    v_mfma_f32_32x32x16_bf16 v[112:127], a[200:203], v[180:183], v[112:127]
    ds_read_b128 v[204:207], v23 offset:768
    s_waitcnt vmcnt(14)
    v_mfma_f32_32x32x16_bf16 v[128:143], a[204:207], v[180:183], v[128:143]
    s_waitcnt lgkmcnt(0)
    s_barrier
    s_waitcnt vmcnt(13)
    v_mfma_f32_32x32x16_bf16 v[112:127], a[208:211], v[184:187], v[112:127]
    ds_read_b128 v[176:179], v16 offset:32768
    s_add_u32 s36, s30, 24576
    buffer_load_dwordx4 v[104:107], v3, s[8:11], s36 offen offset:0 sc1
    buffer_load_dwordx4 v[108:111], v3, s[8:11], s36 offen offset:16 sc1
    s_waitcnt vmcnt(5)
    v_exp_f32 v96, v96
    v_exp_f32 v97, v97
    v_mfma_f32_32x32x16_bf16 v[128:143], a[212:215], v[184:187], v[128:143]
    v_exp_f32 v98, v98
    v_exp_f32 v99, v99
    v_exp_f32 v100, v100
    v_mfma_f32_32x32x16_bf16 v[112:127], a[216:219], v[188:191], v[112:127]
    ds_read_b128 v[180:183], v17 offset:32768
    v_exp_f32 v101, v101
    v_exp_f32 v102, v102
    v_exp_f32 v103, v103
    v_mfma_f32_32x32x16_bf16 v[128:143], a[220:223], v[188:191], v[128:143]
    v_fma_f32 v208, v96, -v32, -0.5
    v_fma_f32 v209, v97, -v33, -0.5
    v_fma_f32 v210, v98, -v34, -0.5
    v_fma_f32 v211, v99, -v35, -0.5
    v_fma_f32 v212, v100, -v36, -0.5
    v_mfma_f32_32x32x16_bf16 v[112:127], a[224:227], v[192:195], v[112:127]
    ds_read_b128 v[184:187], v18 offset:32768
    v_fma_f32 v213, v101, -v37, -0.5
    v_fma_f32 v214, v102, -v38, -0.5
    v_fma_f32 v215, v103, -v39, -0.5
    v_rcp_f32 v208, v208
    v_mfma_f32_32x32x16_bf16 v[128:143], a[228:231], v[192:195], v[128:143]
    v_rcp_f32 v209, v209
    v_rcp_f32 v210, v210
    v_rcp_f32 v211, v211
    v_mfma_f32_32x32x16_bf16 v[112:127], a[232:235], v[196:199], v[112:127]
    ds_read_b128 v[188:191], v19 offset:32768
    v_rcp_f32 v212, v212
    v_rcp_f32 v213, v213
    v_rcp_f32 v214, v214
    v_mfma_f32_32x32x16_bf16 v[128:143], a[236:239], v[196:199], v[128:143]
    v_rcp_f32 v215, v215
    v_cvt_pk_bf16_f32 v224, v208, v209
    v_cvt_pk_bf16_f32 v225, v210, v211
    v_cvt_pk_bf16_f32 v226, v212, v213
    v_mfma_f32_32x32x16_bf16 v[112:127], a[240:243], v[200:203], v[112:127]
    ds_read_b128 v[192:195], v20 offset:32768
    v_cvt_pk_bf16_f32 v227, v214, v215
    ds_write_b128 v8, v[224:227] offset:0
    v_fma_f32 v216, v96, -v40, -0.5
    s_waitcnt vmcnt(4)
    v_mfma_f32_32x32x16_bf16 v[128:143], a[244:247], v[200:203], v[128:143]
    v_fma_f32 v217, v97, -v41, -0.5
    v_fma_f32 v218, v98, -v42, -0.5
    v_fma_f32 v219, v99, -v43, -0.5
    v_fma_f32 v220, v100, -v44, -0.5
    v_fma_f32 v221, v101, -v45, -0.5
    v_fma_f32 v222, v102, -v46, -0.5
    s_waitcnt vmcnt(3)
    v_mfma_f32_32x32x16_bf16 v[112:127], a[248:251], v[204:207], v[112:127]
    ds_read_b128 v[196:199], v21 offset:32768
    v_fma_f32 v223, v103, -v47, -0.5
    v_rcp_f32 v216, v216
    v_rcp_f32 v217, v217
    s_waitcnt vmcnt(2)
    v_mfma_f32_32x32x16_bf16 v[128:143], a[252:255], v[204:207], v[128:143]
    v_rcp_f32 v218, v218
    v_rcp_f32 v219, v219
    v_rcp_f32 v220, v220
    s_waitcnt lgkmcnt(5)
    v_mfma_f32_32x32x16_bf16 v[144:159], a[0:3], v[176:179], v[144:159]
    ds_read_b128 v[200:203], v22 offset:32768
    v_rcp_f32 v221, v221
    v_rcp_f32 v222, v222
    v_rcp_f32 v223, v223
    v_mfma_f32_32x32x16_bf16 v[160:175], a[4:7], v[176:179], v[160:175]
    v_cvt_pk_bf16_f32 v228, v216, v217
    v_cvt_pk_bf16_f32 v229, v218, v219
    v_cvt_pk_bf16_f32 v230, v220, v221
    v_cvt_pk_bf16_f32 v231, v222, v223
    ds_write_b128 v9, v[228:231] offset:0
    v_mfma_f32_32x32x16_bf16 v[144:159], a[8:11], v[180:183], v[144:159]
    ds_read_b128 v[204:207], v23 offset:32768
    v_fma_f32 v208, v96, -v48, -0.5
    v_fma_f32 v209, v97, -v49, -0.5
    v_fma_f32 v210, v98, -v50, -0.5
    v_mfma_f32_32x32x16_bf16 v[160:175], a[12:15], v[180:183], v[160:175]
    v_fma_f32 v211, v99, -v51, -0.5
    v_fma_f32 v212, v100, -v52, -0.5
    v_fma_f32 v213, v101, -v53, -0.5
    v_fma_f32 v214, v102, -v54, -0.5
    v_fma_f32 v215, v103, -v55, -0.5
    v_rcp_f32 v208, v208
    s_waitcnt lgkmcnt(6)
    v_mfma_f32_32x32x16_bf16 v[144:159], a[16:19], v[184:187], v[144:159]
    ds_read_b128 v[176:179], v16 offset:33024
    v_rcp_f32 v209, v209
    v_rcp_f32 v210, v210
    v_mfma_f32_32x32x16_bf16 v[160:175], a[20:23], v[184:187], v[160:175]
    v_rcp_f32 v211, v211
    v_rcp_f32 v212, v212
    v_rcp_f32 v213, v213
    v_mfma_f32_32x32x16_bf16 v[144:159], a[24:27], v[188:191], v[144:159]
    ds_read_b128 v[180:183], v17 offset:33024
    v_rcp_f32 v214, v214
    v_rcp_f32 v215, v215
    v_cvt_pk_bf16_f32 v224, v208, v209
    v_mfma_f32_32x32x16_bf16 v[160:175], a[28:31], v[188:191], v[160:175]
    v_cvt_pk_bf16_f32 v225, v210, v211
    v_cvt_pk_bf16_f32 v226, v212, v213
    v_cvt_pk_bf16_f32 v227, v214, v215
    ds_write_b128 v10, v[224:227] offset:0
    s_waitcnt lgkmcnt(6)
    v_mfma_f32_32x32x16_bf16 v[144:159], a[32:35], v[192:195], v[144:159]
    ds_read_b128 v[184:187], v18 offset:33024
    v_cvt_pk_bf16_f32 v232, v112, v113
    v_cvt_pk_bf16_f32 v233, v114, v115
    v_cvt_pk_bf16_f32 v234, v116, v117
    v_cvt_pk_bf16_f32 v235, v118, v119
    v_cvt_pk_bf16_f32 v236, v120, v121
    v_mfma_f32_32x32x16_bf16 v[160:175], a[36:39], v[192:195], v[160:175]
    v_cvt_pk_bf16_f32 v237, v122, v123
    v_cvt_pk_bf16_f32 v238, v124, v125
    v_cvt_pk_bf16_f32 v239, v126, v127
    v_cvt_pk_bf16_f32 v240, v128, v129
    v_cvt_pk_bf16_f32 v241, v130, v131
    v_cvt_pk_bf16_f32 v242, v132, v133
    v_mfma_f32_32x32x16_bf16 v[144:159], a[40:43], v[196:199], v[144:159]
    ds_read_b128 v[188:191], v19 offset:33024
    v_cvt_pk_bf16_f32 v243, v134, v135
    v_cvt_pk_bf16_f32 v244, v136, v137
    v_cvt_pk_bf16_f32 v245, v138, v139
    v_cvt_pk_bf16_f32 v246, v140, v141
    v_cvt_pk_bf16_f32 v247, v142, v143
    v_mfma_f32_32x32x16_bf16 v[160:175], a[44:47], v[196:199], v[160:175]
    s_nop 1
    ds_read_b128 v[112:115], v250 offset:0
    ds_read_b128 v[116:119], v250 offset:32
    ds_read_b128 v[120:123], v250 offset:64
    ds_read_b128 v[124:127], v250 offset:96
    ds_read_b128 v[128:131], v250 offset:128
    s_waitcnt lgkmcnt(10)
    v_mfma_f32_32x32x16_bf16 v[144:159], a[48:51], v[200:203], v[144:159]
    ds_read_b128 v[192:195], v20 offset:33024
    ds_read_b128 v[132:135], v250 offset:160
    ds_read_b128 v[136:139], v250 offset:192
    ds_read_b128 v[140:143], v250 offset:224
    v_permlane32_swap_b32 v232, v234
    v_permlane32_swap_b32 v233, v235
    v_mfma_f32_32x32x16_bf16 v[160:175], a[52:55], v[200:203], v[160:175]
    v_permlane32_swap_b32 v236, v238
    v_permlane32_swap_b32 v237, v239
    v_permlane32_swap_b32 v240, v242
    v_permlane32_swap_b32 v241, v243
    v_permlane32_swap_b32 v244, v246
    v_permlane32_swap_b32 v245, v247
    v_mfma_f32_32x32x16_bf16 v[144:159], a[56:59], v[204:207], v[144:159]
    ds_read_b128 v[196:199], v21 offset:33024
    v_fma_f32 v216, v96, -v56, -0.5
    v_fma_f32 v217, v97, -v57, -0.5
    v_fma_f32 v218, v98, -v58, -0.5
    v_fma_f32 v219, v99, -v59, -0.5
    v_fma_f32 v220, v100, -v60, -0.5
    v_mfma_f32_32x32x16_bf16 v[160:175], a[60:63], v[204:207], v[160:175]
    v_fma_f32 v221, v101, -v61, -0.5
    v_fma_f32 v222, v102, -v62, -0.5
    v_fma_f32 v223, v103, -v63, -0.5
    v_rcp_f32 v216, v216
    v_rcp_f32 v217, v217
    s_waitcnt lgkmcnt(13)
    v_mfma_f32_32x32x16_bf16 v[144:159], a[64:67], v[176:179], v[144:159]
    ds_read_b128 v[200:203], v22 offset:33024
    ds_write_b128 v24, v[232:235]
    v_rcp_f32 v218, v218
    v_mfma_f32_32x32x16_bf16 v[160:175], a[68:71], v[176:179], v[160:175]
    v_rcp_f32 v219, v219
    v_rcp_f32 v220, v220
    v_rcp_f32 v221, v221
    v_mfma_f32_32x32x16_bf16 v[144:159], a[72:75], v[180:183], v[144:159]
    ds_read_b128 v[204:207], v23 offset:33024
    ds_write_b128 v25, v[236:239]
    v_rcp_f32 v222, v222
    v_mfma_f32_32x32x16_bf16 v[160:175], a[76:79], v[180:183], v[160:175]
    v_rcp_f32 v223, v223
    v_cvt_pk_bf16_f32 v228, v216, v217
    v_cvt_pk_bf16_f32 v229, v218, v219
    v_cvt_pk_bf16_f32 v230, v220, v221
    s_waitcnt lgkmcnt(14)
    v_mfma_f32_32x32x16_bf16 v[144:159], a[80:83], v[184:187], v[144:159]
    ds_read_b128 v[176:179], v16 offset:33280
    ds_write_b128 v26, v[240:243]
    v_cvt_pk_bf16_f32 v231, v222, v223
    ds_write_b128 v11, v[228:231] offset:0
    v_mfma_f32_32x32x16_bf16 v[160:175], a[84:87], v[184:187], v[160:175]
    v_fma_f32 v208, v96, -v64, -0.5
    v_fma_f32 v209, v97, -v65, -0.5
    v_fma_f32 v210, v98, -v66, -0.5
    v_fma_f32 v211, v99, -v67, -0.5
    v_mfma_f32_32x32x16_bf16 v[144:159], a[88:91], v[188:191], v[144:159]
    ds_read_b128 v[180:183], v17 offset:33280
    ds_write_b128 v27, v[244:247]
    v_fma_f32 v212, v100, -v68, -0.5
    v_fma_f32 v213, v101, -v69, -0.5
    v_mfma_f32_32x32x16_bf16 v[160:175], a[92:95], v[188:191], v[160:175]
    v_fma_f32 v214, v102, -v70, -0.5
    v_fma_f32 v215, v103, -v71, -0.5
    v_rcp_f32 v208, v208
    v_rcp_f32 v209, v209
    s_waitcnt lgkmcnt(9)
    v_mfma_f32_32x32x16_bf16 v[144:159], a[96:99], v[192:195], v[144:159]
    ds_read_b128 v[184:187], v18 offset:33280
    v_rcp_f32 v210, v210
    v_rcp_f32 v211, v211
    v_rcp_f32 v212, v212
    v_mfma_f32_32x32x16_bf16 v[160:175], a[100:103], v[192:195], v[160:175]
    v_rcp_f32 v213, v213
    v_rcp_f32 v214, v214
    v_rcp_f32 v215, v215
    v_mfma_f32_32x32x16_bf16 v[144:159], a[104:107], v[196:199], v[144:159]
    ds_read_b128 v[188:191], v19 offset:33280
    v_cvt_pk_bf16_f32 v224, v208, v209
    v_cvt_pk_bf16_f32 v225, v210, v211
    v_cvt_pk_bf16_f32 v226, v212, v213
    v_cvt_pk_bf16_f32 v227, v214, v215
    v_mfma_f32_32x32x16_bf16 v[160:175], a[108:111], v[196:199], v[160:175]
    ds_write_b128 v12, v[224:227] offset:0
    v_fma_f32 v216, v96, -v72, -0.5
    v_fma_f32 v217, v97, -v73, -0.5
    v_fma_f32 v218, v98, -v74, -0.5
    s_waitcnt lgkmcnt(9)
    v_mfma_f32_32x32x16_bf16 v[144:159], a[112:115], v[200:203], v[144:159]
    ds_read_b128 v[192:195], v20 offset:33280
    v_fma_f32 v219, v99, -v75, -0.5
    v_fma_f32 v220, v100, -v76, -0.5
    v_fma_f32 v221, v101, -v77, -0.5
    v_fma_f32 v222, v102, -v78, -0.5
    v_fma_f32 v223, v103, -v79, -0.5
    v_mfma_f32_32x32x16_bf16 v[160:175], a[116:119], v[200:203], v[160:175]
    v_rcp_f32 v216, v216
    v_rcp_f32 v217, v217
    v_rcp_f32 v218, v218
    v_mfma_f32_32x32x16_bf16 v[144:159], a[120:123], v[204:207], v[144:159]
    ds_read_b128 v[196:199], v21 offset:33280
    s_waitcnt lgkmcnt(5)
    ds_read_b128 v[232:235], v28 offset:0
    ds_read_b128 v[236:239], v28 offset:1024
    ds_read_b128 v[240:243], v28 offset:2048
    ds_read_b128 v[244:247], v28 offset:3072
    v_rcp_f32 v219, v219
    v_mfma_f32_32x32x16_bf16 v[160:175], a[124:127], v[204:207], v[160:175]
    v_rcp_f32 v220, v220
    v_rcp_f32 v221, v221
    v_rcp_f32 v222, v222
    v_mfma_f32_32x32x16_bf16 v[144:159], a[128:131], v[176:179], v[144:159]
    ds_read_b128 v[200:203], v22 offset:33280
    v_rcp_f32 v223, v223
    v_cvt_pk_bf16_f32 v228, v216, v217
    v_cvt_pk_bf16_f32 v229, v218, v219
    v_mfma_f32_32x32x16_bf16 v[160:175], a[132:135], v[176:179], v[160:175]
    v_cvt_pk_bf16_f32 v230, v220, v221
    v_cvt_pk_bf16_f32 v231, v222, v223
    ds_write_b128 v13, v[228:231] offset:0
    v_fma_f32 v208, v96, -v80, -0.5
    v_mfma_f32_32x32x16_bf16 v[144:159], a[136:139], v[180:183], v[144:159]
    ds_read_b128 v[204:207], v23 offset:33280
    v_fma_f32 v209, v97, -v81, -0.5
    v_fma_f32 v210, v98, -v82, -0.5
    v_fma_f32 v211, v99, -v83, -0.5
    v_fma_f32 v212, v100, -v84, -0.5
    v_fma_f32 v213, v101, -v85, -0.5
    v_mfma_f32_32x32x16_bf16 v[160:175], a[140:143], v[180:183], v[160:175]
    v_fma_f32 v214, v102, -v86, -0.5
    v_fma_f32 v215, v103, -v87, -0.5
    v_rcp_f32 v208, v208
    v_rcp_f32 v209, v209
    s_waitcnt lgkmcnt(10)
    v_mfma_f32_32x32x16_bf16 v[144:159], a[144:147], v[184:187], v[144:159]
    ds_read_b128 v[176:179], v16 offset:33536
    v_rcp_f32 v210, v210
    v_rcp_f32 v211, v211
    v_rcp_f32 v212, v212
    v_mfma_f32_32x32x16_bf16 v[160:175], a[148:151], v[184:187], v[160:175]
    v_rcp_f32 v213, v213
    v_rcp_f32 v214, v214
    v_rcp_f32 v215, v215
    v_mfma_f32_32x32x16_bf16 v[144:159], a[152:155], v[188:191], v[144:159]
    ds_read_b128 v[180:183], v17 offset:33536
    s_waitcnt lgkmcnt(8)
    s_add_u32 s36, s31, 0
    buffer_store_dwordx4 v[232:235], v29, s[24:27], s36 offen sc1
    v_cvt_pk_bf16_f32 v224, v208, v209
    v_cvt_pk_bf16_f32 v225, v210, v211
    v_mfma_f32_32x32x16_bf16 v[160:175], a[156:159], v[188:191], v[160:175]
    v_cvt_pk_bf16_f32 v226, v212, v213
    v_cvt_pk_bf16_f32 v227, v214, v215
    ds_write_b128 v14, v[224:227] offset:0
    v_fma_f32 v216, v96, -v88, -0.5
    v_mfma_f32_32x32x16_bf16 v[144:159], a[160:163], v[192:195], v[144:159]
    ds_read_b128 v[184:187], v18 offset:33536
    s_waitcnt lgkmcnt(9)
    s_add_u32 s36, s31, 8192
    buffer_store_dwordx4 v[236:239], v29, s[24:27], s36 offen sc1
    v_fma_f32 v217, v97, -v89, -0.5
    v_fma_f32 v218, v98, -v90, -0.5
    v_fma_f32 v219, v99, -v91, -0.5
    v_mfma_f32_32x32x16_bf16 v[160:175], a[164:167], v[192:195], v[160:175]
    v_fma_f32 v220, v100, -v92, -0.5
    v_fma_f32 v221, v101, -v93, -0.5
    v_fma_f32 v222, v102, -v94, -0.5
    v_fma_f32 v223, v103, -v95, -0.5
    v_rcp_f32 v216, v216
    v_mfma_f32_32x32x16_bf16 v[144:159], a[168:171], v[196:199], v[144:159]
    ds_read_b128 v[188:191], v19 offset:33536
    s_waitcnt lgkmcnt(9)
    s_add_u32 s36, s31, 16384
    buffer_store_dwordx4 v[240:243], v29, s[24:27], s36 offen sc1
    v_rcp_f32 v217, v217
    v_rcp_f32 v218, v218
    v_mfma_f32_32x32x16_bf16 v[160:175], a[172:175], v[196:199], v[160:175]
    v_rcp_f32 v219, v219
    v_rcp_f32 v220, v220
    v_rcp_f32 v221, v221
    s_waitcnt lgkmcnt(5)
    v_mfma_f32_32x32x16_bf16 v[144:159], a[176:179], v[200:203], v[144:159]
    ds_read_b128 v[192:195], v20 offset:33536
    s_add_u32 s36, s31, 24576
    buffer_store_dwordx4 v[244:247], v29, s[24:27], s36 offen sc1
    v_rcp_f32 v222, v222
    v_mfma_f32_32x32x16_bf16 v[160:175], a[180:183], v[200:203], v[160:175]
    v_rcp_f32 v223, v223
    v_cvt_pk_bf16_f32 v228, v216, v217
    v_cvt_pk_bf16_f32 v229, v218, v219
    v_cvt_pk_bf16_f32 v230, v220, v221
    v_cvt_pk_bf16_f32 v231, v222, v223
    v_mfma_f32_32x32x16_bf16 v[144:159], a[184:187], v[204:207], v[144:159]
    ds_read_b128 v[196:199], v21 offset:33536
    ds_write_b128 v15, v[228:231] offset:0
    v_mfma_f32_32x32x16_bf16 v[160:175], a[188:191], v[204:207], v[160:175]
    s_waitcnt lgkmcnt(6)
    v_mfma_f32_32x32x16_bf16 v[144:159], a[192:195], v[176:179], v[144:159]
    ds_read_b128 v[200:203], v22 offset:33536
    v_mfma_f32_32x32x16_bf16 v[160:175], a[196:199], v[176:179], v[160:175]
    v_mfma_f32_32x32x16_bf16 v[144:159], a[200:203], v[180:183], v[144:159]
    ds_read_b128 v[204:207], v23 offset:33536
    v_mfma_f32_32x32x16_bf16 v[160:175], a[204:207], v[180:183], v[160:175]
    s_waitcnt lgkmcnt(0)
    s_barrier
    v_mfma_f32_32x32x16_bf16 v[144:159], a[208:211], v[184:187], v[144:159]
    ds_read_b128 v[176:179], v16 offset:0
    s_waitcnt vmcnt(4)
    v_exp_f32 v104, v104
    v_exp_f32 v105, v105
    v_exp_f32 v106, v106
    v_mfma_f32_32x32x16_bf16 v[160:175], a[212:215], v[184:187], v[160:175]
    v_exp_f32 v107, v107
    v_exp_f32 v108, v108
    v_exp_f32 v109, v109
    v_mfma_f32_32x32x16_bf16 v[144:159], a[216:219], v[188:191], v[144:159]
    ds_read_b128 v[180:183], v17 offset:0
    v_exp_f32 v110, v110
    v_exp_f32 v111, v111
    v_mfma_f32_32x32x16_bf16 v[160:175], a[220:223], v[188:191], v[160:175]
    v_fma_f32 v208, v104, -v32, -0.5
    v_fma_f32 v209, v105, -v33, -0.5
    v_fma_f32 v210, v106, -v34, -0.5
    v_fma_f32 v211, v107, -v35, -0.5
    v_fma_f32 v212, v108, -v36, -0.5
    v_fma_f32 v213, v109, -v37, -0.5
    v_mfma_f32_32x32x16_bf16 v[144:159], a[224:227], v[192:195], v[144:159]
    ds_read_b128 v[184:187], v18 offset:0
    v_fma_f32 v214, v110, -v38, -0.5
    v_fma_f32 v215, v111, -v39, -0.5
    v_rcp_f32 v208, v208
    v_rcp_f32 v209, v209
    v_mfma_f32_32x32x16_bf16 v[160:175], a[228:231], v[192:195], v[160:175]
    v_rcp_f32 v210, v210
    v_rcp_f32 v211, v211
    v_rcp_f32 v212, v212
    v_mfma_f32_32x32x16_bf16 v[144:159], a[232:235], v[196:199], v[144:159]
    ds_read_b128 v[188:191], v19 offset:0
    v_rcp_f32 v213, v213
    v_rcp_f32 v214, v214
    v_mfma_f32_32x32x16_bf16 v[160:175], a[236:239], v[196:199], v[160:175]
    v_rcp_f32 v215, v215
    v_cvt_pk_bf16_f32 v224, v208, v209
    v_cvt_pk_bf16_f32 v225, v210, v211
    v_cvt_pk_bf16_f32 v226, v212, v213
    v_cvt_pk_bf16_f32 v227, v214, v215
    v_mfma_f32_32x32x16_bf16 v[144:159], a[240:243], v[200:203], v[144:159]
    ds_read_b128 v[192:195], v20 offset:0
    ds_write_b128 v8, v[224:227] offset:32768
    v_fma_f32 v216, v104, -v40, -0.5
    v_fma_f32 v217, v105, -v41, -0.5
    v_mfma_f32_32x32x16_bf16 v[160:175], a[244:247], v[200:203], v[160:175]
    v_fma_f32 v218, v106, -v42, -0.5
    v_fma_f32 v219, v107, -v43, -0.5
    v_fma_f32 v220, v108, -v44, -0.5
    v_fma_f32 v221, v109, -v45, -0.5
    v_fma_f32 v222, v110, -v46, -0.5
    v_fma_f32 v223, v111, -v47, -0.5
    v_mfma_f32_32x32x16_bf16 v[144:159], a[248:251], v[204:207], v[144:159]
    ds_read_b128 v[196:199], v21 offset:0
    v_rcp_f32 v216, v216
    v_rcp_f32 v217, v217
    v_rcp_f32 v218, v218
    v_mfma_f32_32x32x16_bf16 v[160:175], a[252:255], v[204:207], v[160:175]
    v_rcp_f32 v219, v219
    v_rcp_f32 v220, v220
    v_rcp_f32 v221, v221
    s_waitcnt lgkmcnt(5)
    v_mfma_f32_32x32x16_bf16 v[112:127], a[0:3], v[176:179], v[112:127]
    ds_read_b128 v[200:203], v22 offset:0
    v_rcp_f32 v222, v222
    v_rcp_f32 v223, v223
    v_mfma_f32_32x32x16_bf16 v[128:143], a[4:7], v[176:179], v[128:143]
    v_cvt_pk_bf16_f32 v228, v216, v217
    v_cvt_pk_bf16_f32 v229, v218, v219
    v_cvt_pk_bf16_f32 v230, v220, v221
    v_cvt_pk_bf16_f32 v231, v222, v223
    ds_write_b128 v9, v[228:231] offset:32768
    v_mfma_f32_32x32x16_bf16 v[112:127], a[8:11], v[180:183], v[112:127]
    ds_read_b128 v[204:207], v23 offset:0
    v_fma_f32 v208, v104, -v48, -0.5
    v_fma_f32 v209, v105, -v49, -0.5
    v_fma_f32 v210, v106, -v50, -0.5
    v_fma_f32 v211, v107, -v51, -0.5
    v_mfma_f32_32x32x16_bf16 v[128:143], a[12:15], v[180:183], v[128:143]
    v_fma_f32 v212, v108, -v52, -0.5
    v_fma_f32 v213, v109, -v53, -0.5
    v_fma_f32 v214, v110, -v54, -0.5
    v_fma_f32 v215, v111, -v55, -0.5
    v_rcp_f32 v208, v208
    s_waitcnt lgkmcnt(6)
    v_mfma_f32_32x32x16_bf16 v[112:127], a[16:19], v[184:187], v[112:127]
    ds_read_b128 v[176:179], v16 offset:256
    v_rcp_f32 v209, v209
    v_rcp_f32 v210, v210
    v_rcp_f32 v211, v211
    v_mfma_f32_32x32x16_bf16 v[128:143], a[20:23], v[184:187], v[128:143]
    v_rcp_f32 v212, v212
    v_rcp_f32 v213, v213
    v_rcp_f32 v214, v214
    v_mfma_f32_32x32x16_bf16 v[112:127], a[24:27], v[188:191], v[112:127]
    ds_read_b128 v[180:183], v17 offset:256
    v_rcp_f32 v215, v215
    v_cvt_pk_bf16_f32 v224, v208, v209
    v_cvt_pk_bf16_f32 v225, v210, v211
    v_mfma_f32_32x32x16_bf16 v[128:143], a[28:31], v[188:191], v[128:143]
    v_cvt_pk_bf16_f32 v226, v212, v213
    v_cvt_pk_bf16_f32 v227, v214, v215
    ds_write_b128 v10, v[224:227] offset:32768
    v_fma_f32 v216, v104, -v56, -0.5
    s_waitcnt lgkmcnt(6)
    v_mfma_f32_32x32x16_bf16 v[112:127], a[32:35], v[192:195], v[112:127]
    ds_read_b128 v[184:187], v18 offset:256
    v_cvt_pk_bf16_f32 v232, v144, v145
    v_cvt_pk_bf16_f32 v233, v146, v147
    v_cvt_pk_bf16_f32 v234, v148, v149
    v_cvt_pk_bf16_f32 v235, v150, v151
    v_cvt_pk_bf16_f32 v236, v152, v153
    v_mfma_f32_32x32x16_bf16 v[128:143], a[36:39], v[192:195], v[128:143]
    v_cvt_pk_bf16_f32 v237, v154, v155
    v_cvt_pk_bf16_f32 v238, v156, v157
    v_cvt_pk_bf16_f32 v239, v158, v159
    v_cvt_pk_bf16_f32 v240, v160, v161
    v_cvt_pk_bf16_f32 v241, v162, v163
    v_cvt_pk_bf16_f32 v242, v164, v165
    v_mfma_f32_32x32x16_bf16 v[112:127], a[40:43], v[196:199], v[112:127]
    ds_read_b128 v[188:191], v19 offset:256
    v_cvt_pk_bf16_f32 v243, v166, v167
    v_cvt_pk_bf16_f32 v244, v168, v169
    v_cvt_pk_bf16_f32 v245, v170, v171
    v_cvt_pk_bf16_f32 v246, v172, v173
    v_cvt_pk_bf16_f32 v247, v174, v175
    v_mfma_f32_32x32x16_bf16 v[128:143], a[44:47], v[196:199], v[128:143]
    s_nop 1
    ds_read_b128 v[144:147], v250 offset:0
    ds_read_b128 v[148:151], v250 offset:32
    ds_read_b128 v[152:155], v250 offset:64
    ds_read_b128 v[156:159], v250 offset:96
    ds_read_b128 v[160:163], v250 offset:128
    s_waitcnt lgkmcnt(10)
    v_mfma_f32_32x32x16_bf16 v[112:127], a[48:51], v[200:203], v[112:127]
    ds_read_b128 v[192:195], v20 offset:256
    ds_read_b128 v[164:167], v250 offset:160
    ds_read_b128 v[168:171], v250 offset:192
    ds_read_b128 v[172:175], v250 offset:224
    v_permlane32_swap_b32 v232, v234
    v_permlane32_swap_b32 v233, v235
    v_mfma_f32_32x32x16_bf16 v[128:143], a[52:55], v[200:203], v[128:143]
    v_permlane32_swap_b32 v236, v238
    v_permlane32_swap_b32 v237, v239
    v_permlane32_swap_b32 v240, v242
    v_permlane32_swap_b32 v241, v243
    v_permlane32_swap_b32 v244, v246
    v_permlane32_swap_b32 v245, v247
    v_mfma_f32_32x32x16_bf16 v[112:127], a[56:59], v[204:207], v[112:127]
    ds_read_b128 v[196:199], v21 offset:256
    v_fma_f32 v217, v105, -v57, -0.5
    v_fma_f32 v218, v106, -v58, -0.5
    v_fma_f32 v219, v107, -v59, -0.5
    v_fma_f32 v220, v108, -v60, -0.5
    v_fma_f32 v221, v109, -v61, -0.5
    v_mfma_f32_32x32x16_bf16 v[128:143], a[60:63], v[204:207], v[128:143]
    v_fma_f32 v222, v110, -v62, -0.5
    v_fma_f32 v223, v111, -v63, -0.5
    v_rcp_f32 v216, v216
    v_rcp_f32 v217, v217
    s_waitcnt lgkmcnt(13)
    v_mfma_f32_32x32x16_bf16 v[112:127], a[64:67], v[176:179], v[112:127]
    ds_read_b128 v[200:203], v22 offset:256
    ds_write_b128 v24, v[232:235]
    v_rcp_f32 v218, v218
    v_mfma_f32_32x32x16_bf16 v[128:143], a[68:71], v[176:179], v[128:143]
    v_rcp_f32 v219, v219
    v_rcp_f32 v220, v220
    v_rcp_f32 v221, v221
    v_mfma_f32_32x32x16_bf16 v[112:127], a[72:75], v[180:183], v[112:127]
    ds_read_b128 v[204:207], v23 offset:256
    ds_write_b128 v25, v[236:239]
    v_rcp_f32 v222, v222
    v_mfma_f32_32x32x16_bf16 v[128:143], a[76:79], v[180:183], v[128:143]
    v_rcp_f32 v223, v223
    v_cvt_pk_bf16_f32 v228, v216, v217
    v_cvt_pk_bf16_f32 v229, v218, v219
    v_cvt_pk_bf16_f32 v230, v220, v221
    v_cvt_pk_bf16_f32 v231, v222, v223
    s_waitcnt lgkmcnt(14)
    v_mfma_f32_32x32x16_bf16 v[112:127], a[80:83], v[184:187], v[112:127]
    ds_read_b128 v[176:179], v16 offset:512
    ds_write_b128 v26, v[240:243]
    ds_write_b128 v11, v[228:231] offset:32768
    v_mfma_f32_32x32x16_bf16 v[128:143], a[84:87], v[184:187], v[128:143]
    v_fma_f32 v208, v104, -v64, -0.5
    v_fma_f32 v209, v105, -v65, -0.5
    v_fma_f32 v210, v106, -v66, -0.5
    v_fma_f32 v211, v107, -v67, -0.5
    v_fma_f32 v212, v108, -v68, -0.5
    v_mfma_f32_32x32x16_bf16 v[112:127], a[88:91], v[188:191], v[112:127]
    ds_read_b128 v[180:183], v17 offset:512
    ds_write_b128 v27, v[244:247]
    v_fma_f32 v213, v109, -v69, -0.5
    v_fma_f32 v214, v110, -v70, -0.5
    v_mfma_f32_32x32x16_bf16 v[128:143], a[92:95], v[188:191], v[128:143]
    v_fma_f32 v215, v111, -v71, -0.5
    v_rcp_f32 v208, v208
    v_rcp_f32 v209, v209
    v_rcp_f32 v210, v210
    s_waitcnt lgkmcnt(9)
    v_mfma_f32_32x32x16_bf16 v[112:127], a[96:99], v[192:195], v[112:127]
    ds_read_b128 v[184:187], v18 offset:512
    v_rcp_f32 v211, v211
    v_rcp_f32 v212, v212
    v_mfma_f32_32x32x16_bf16 v[128:143], a[100:103], v[192:195], v[128:143]
    v_rcp_f32 v213, v213
    v_rcp_f32 v214, v214
    v_rcp_f32 v215, v215
    v_mfma_f32_32x32x16_bf16 v[112:127], a[104:107], v[196:199], v[112:127]
    ds_read_b128 v[188:191], v19 offset:512
    v_cvt_pk_bf16_f32 v224, v208, v209
    v_cvt_pk_bf16_f32 v225, v210, v211
    v_cvt_pk_bf16_f32 v226, v212, v213
    v_cvt_pk_bf16_f32 v227, v214, v215
    ds_write_b128 v12, v[224:227] offset:32768
    v_mfma_f32_32x32x16_bf16 v[128:143], a[108:111], v[196:199], v[128:143]
    v_fma_f32 v216, v104, -v72, -0.5
    v_fma_f32 v217, v105, -v73, -0.5
    v_fma_f32 v218, v106, -v74, -0.5
    v_fma_f32 v219, v107, -v75, -0.5
    s_waitcnt lgkmcnt(9)
    v_mfma_f32_32x32x16_bf16 v[112:127], a[112:115], v[200:203], v[112:127]
    ds_read_b128 v[192:195], v20 offset:512
    v_fma_f32 v220, v108, -v76, -0.5
    v_fma_f32 v221, v109, -v77, -0.5
    v_fma_f32 v222, v110, -v78, -0.5
    v_fma_f32 v223, v111, -v79, -0.5
    v_rcp_f32 v216, v216
    v_mfma_f32_32x32x16_bf16 v[128:143], a[116:119], v[200:203], v[128:143]
    v_rcp_f32 v217, v217
    v_rcp_f32 v218, v218
    v_rcp_f32 v219, v219
    v_mfma_f32_32x32x16_bf16 v[112:127], a[120:123], v[204:207], v[112:127]
    ds_read_b128 v[196:199], v21 offset:512
    s_waitcnt lgkmcnt(5)
    ds_read_b128 v[232:235], v28 offset:0
    ds_read_b128 v[236:239], v28 offset:1024
    ds_read_b128 v[240:243], v28 offset:2048
    ds_read_b128 v[244:247], v28 offset:3072
    v_mfma_f32_32x32x16_bf16 v[128:143], a[124:127], v[204:207], v[128:143]
    v_rcp_f32 v220, v220
    v_rcp_f32 v221, v221
    v_rcp_f32 v222, v222
    v_mfma_f32_32x32x16_bf16 v[112:127], a[128:131], v[176:179], v[112:127]
    ds_read_b128 v[200:203], v22 offset:512
    v_rcp_f32 v223, v223
    v_cvt_pk_bf16_f32 v228, v216, v217
    v_cvt_pk_bf16_f32 v229, v218, v219
    v_cvt_pk_bf16_f32 v230, v220, v221
    v_mfma_f32_32x32x16_bf16 v[128:143], a[132:135], v[176:179], v[128:143]
    v_cvt_pk_bf16_f32 v231, v222, v223
    ds_write_b128 v13, v[228:231] offset:32768
    v_fma_f32 v208, v104, -v80, -0.5
    v_fma_f32 v209, v105, -v81, -0.5
    v_mfma_f32_32x32x16_bf16 v[112:127], a[136:139], v[180:183], v[112:127]
    ds_read_b128 v[204:207], v23 offset:512
    v_fma_f32 v210, v106, -v82, -0.5
    v_fma_f32 v211, v107, -v83, -0.5
    v_fma_f32 v212, v108, -v84, -0.5
    v_fma_f32 v213, v109, -v85, -0.5
    v_fma_f32 v214, v110, -v86, -0.5
    v_mfma_f32_32x32x16_bf16 v[128:143], a[140:143], v[180:183], v[128:143]
    v_fma_f32 v215, v111, -v87, -0.5
    v_rcp_f32 v208, v208
    v_rcp_f32 v209, v209
    v_rcp_f32 v210, v210
    s_waitcnt lgkmcnt(10)
    v_mfma_f32_32x32x16_bf16 v[112:127], a[144:147], v[184:187], v[112:127]
    ds_read_b128 v[176:179], v16 offset:768
    v_rcp_f32 v211, v211
    v_rcp_f32 v212, v212
    v_mfma_f32_32x32x16_bf16 v[128:143], a[148:151], v[184:187], v[128:143]
    v_rcp_f32 v213, v213
    v_rcp_f32 v214, v214
    v_rcp_f32 v215, v215
    v_mfma_f32_32x32x16_bf16 v[112:127], a[152:155], v[188:191], v[112:127]
    ds_read_b128 v[180:183], v17 offset:768
    s_waitcnt lgkmcnt(8)
    s_add_u32 s36, s31, 32768
    buffer_store_dwordx4 v[232:235], v29, s[24:27], s36 offen sc1
    v_cvt_pk_bf16_f32 v224, v208, v209
    v_cvt_pk_bf16_f32 v225, v210, v211
    v_cvt_pk_bf16_f32 v226, v212, v213
    v_mfma_f32_32x32x16_bf16 v[128:143], a[156:159], v[188:191], v[128:143]
    v_cvt_pk_bf16_f32 v227, v214, v215
    ds_write_b128 v14, v[224:227] offset:32768
    v_fma_f32 v216, v104, -v88, -0.5
    v_fma_f32 v217, v105, -v89, -0.5
    v_mfma_f32_32x32x16_bf16 v[112:127], a[160:163], v[192:195], v[112:127]
    ds_read_b128 v[184:187], v18 offset:768
    s_waitcnt lgkmcnt(9)
    s_add_u32 s36, s31, 40960
    buffer_store_dwordx4 v[236:239], v29, s[24:27], s36 offen sc1
    v_fma_f32 v218, v106, -v90, -0.5
    v_fma_f32 v219, v107, -v91, -0.5
    v_fma_f32 v220, v108, -v92, -0.5
    v_mfma_f32_32x32x16_bf16 v[128:143], a[164:167], v[192:195], v[128:143]
    v_fma_f32 v221, v109, -v93, -0.5
    v_fma_f32 v222, v110, -v94, -0.5
    v_fma_f32 v223, v111, -v95, -0.5
    v_rcp_f32 v216, v216
    v_rcp_f32 v217, v217
    v_mfma_f32_32x32x16_bf16 v[112:127], a[168:171], v[196:199], v[112:127]
    ds_read_b128 v[188:191], v19 offset:768
    s_waitcnt lgkmcnt(9)
    s_add_u32 s36, s31, 49152
    buffer_store_dwordx4 v[240:243], v29, s[24:27], s36 offen sc1
    v_rcp_f32 v218, v218
    v_mfma_f32_32x32x16_bf16 v[128:143], a[172:175], v[196:199], v[128:143]
    v_rcp_f32 v219, v219
    v_rcp_f32 v220, v220
    v_rcp_f32 v221, v221
    s_waitcnt lgkmcnt(5)
    v_mfma_f32_32x32x16_bf16 v[112:127], a[176:179], v[200:203], v[112:127]
    ds_read_b128 v[192:195], v20 offset:768
    s_add_u32 s36, s31, 57344
    buffer_store_dwordx4 v[244:247], v29, s[24:27], s36 offen sc1
    v_rcp_f32 v222, v222
    v_rcp_f32 v223, v223
    v_mfma_f32_32x32x16_bf16 v[128:143], a[180:183], v[200:203], v[128:143]
    v_cvt_pk_bf16_f32 v228, v216, v217
    v_cvt_pk_bf16_f32 v229, v218, v219
    v_cvt_pk_bf16_f32 v230, v220, v221
    v_cvt_pk_bf16_f32 v231, v222, v223
    ds_write_b128 v15, v[228:231] offset:32768
    v_mfma_f32_32x32x16_bf16 v[112:127], a[184:187], v[204:207], v[112:127]
    ds_read_b128 v[196:199], v21 offset:768
    v_mfma_f32_32x32x16_bf16 v[128:143], a[188:191], v[204:207], v[128:143]
    s_waitcnt lgkmcnt(6)
    v_mfma_f32_32x32x16_bf16 v[112:127], a[192:195], v[176:179], v[112:127]
    ds_read_b128 v[200:203], v22 offset:768
    v_mfma_f32_32x32x16_bf16 v[128:143], a[196:199], v[176:179], v[128:143]
    v_mfma_f32_32x32x16_bf16 v[112:127], a[200:203], v[180:183], v[112:127]
    ds_read_b128 v[204:207], v23 offset:768
    v_mfma_f32_32x32x16_bf16 v[128:143], a[204:207], v[180:183], v[128:143]
    s_waitcnt lgkmcnt(0)
    s_barrier
    v_mfma_f32_32x32x16_bf16 v[112:127], a[208:211], v[184:187], v[112:127]
    ds_read_b128 v[176:179], v16 offset:32768
    v_mfma_f32_32x32x16_bf16 v[128:143], a[212:215], v[184:187], v[128:143]
    v_mfma_f32_32x32x16_bf16 v[112:127], a[216:219], v[188:191], v[112:127]
    ds_read_b128 v[180:183], v17 offset:32768
    v_mfma_f32_32x32x16_bf16 v[128:143], a[220:223], v[188:191], v[128:143]
    v_mfma_f32_32x32x16_bf16 v[112:127], a[224:227], v[192:195], v[112:127]
    ds_read_b128 v[184:187], v18 offset:32768
    v_mfma_f32_32x32x16_bf16 v[128:143], a[228:231], v[192:195], v[128:143]
    v_mfma_f32_32x32x16_bf16 v[112:127], a[232:235], v[196:199], v[112:127]
    ds_read_b128 v[188:191], v19 offset:32768
    v_mfma_f32_32x32x16_bf16 v[128:143], a[236:239], v[196:199], v[128:143]
    v_mfma_f32_32x32x16_bf16 v[112:127], a[240:243], v[200:203], v[112:127]
    ds_read_b128 v[192:195], v20 offset:32768
    v_mfma_f32_32x32x16_bf16 v[128:143], a[244:247], v[200:203], v[128:143]
    v_mfma_f32_32x32x16_bf16 v[112:127], a[248:251], v[204:207], v[112:127]
    ds_read_b128 v[196:199], v21 offset:32768
    v_mfma_f32_32x32x16_bf16 v[128:143], a[252:255], v[204:207], v[128:143]
    s_waitcnt lgkmcnt(4)
    v_mfma_f32_32x32x16_bf16 v[144:159], a[0:3], v[176:179], v[144:159]
    ds_read_b128 v[200:203], v22 offset:32768
    v_mfma_f32_32x32x16_bf16 v[160:175], a[4:7], v[176:179], v[160:175]
    v_mfma_f32_32x32x16_bf16 v[144:159], a[8:11], v[180:183], v[144:159]
    ds_read_b128 v[204:207], v23 offset:32768
    v_mfma_f32_32x32x16_bf16 v[160:175], a[12:15], v[180:183], v[160:175]
    s_waitcnt lgkmcnt(4)
    v_mfma_f32_32x32x16_bf16 v[144:159], a[16:19], v[184:187], v[144:159]
    ds_read_b128 v[176:179], v16 offset:33024
    v_mfma_f32_32x32x16_bf16 v[160:175], a[20:23], v[184:187], v[160:175]
    v_mfma_f32_32x32x16_bf16 v[144:159], a[24:27], v[188:191], v[144:159]
    ds_read_b128 v[180:183], v17 offset:33024
    v_mfma_f32_32x32x16_bf16 v[160:175], a[28:31], v[188:191], v[160:175]
    s_waitcnt lgkmcnt(4)
    v_mfma_f32_32x32x16_bf16 v[144:159], a[32:35], v[192:195], v[144:159]
    ds_read_b128 v[184:187], v18 offset:33024
    v_cvt_pk_bf16_f32 v232, v112, v113
    v_cvt_pk_bf16_f32 v233, v114, v115
    v_cvt_pk_bf16_f32 v234, v116, v117
    v_cvt_pk_bf16_f32 v235, v118, v119
    v_cvt_pk_bf16_f32 v236, v120, v121
    v_cvt_pk_bf16_f32 v237, v122, v123
    v_cvt_pk_bf16_f32 v238, v124, v125
    v_cvt_pk_bf16_f32 v239, v126, v127
    v_cvt_pk_bf16_f32 v240, v128, v129
    v_cvt_pk_bf16_f32 v241, v130, v131
    v_cvt_pk_bf16_f32 v242, v132, v133
    v_mfma_f32_32x32x16_bf16 v[160:175], a[36:39], v[192:195], v[160:175]
    v_cvt_pk_bf16_f32 v243, v134, v135
    v_cvt_pk_bf16_f32 v244, v136, v137
    v_cvt_pk_bf16_f32 v245, v138, v139
    v_cvt_pk_bf16_f32 v246, v140, v141
    v_cvt_pk_bf16_f32 v247, v142, v143
    s_nop 1
    v_mfma_f32_32x32x16_bf16 v[144:159], a[40:43], v[196:199], v[144:159]
    ds_read_b128 v[188:191], v19 offset:33024
    v_permlane32_swap_b32 v232, v234
    v_permlane32_swap_b32 v233, v235
    v_permlane32_swap_b32 v236, v238
    v_permlane32_swap_b32 v237, v239
    v_permlane32_swap_b32 v240, v242
    v_mfma_f32_32x32x16_bf16 v[160:175], a[44:47], v[196:199], v[160:175]
    v_permlane32_swap_b32 v241, v243
    v_permlane32_swap_b32 v244, v246
    v_permlane32_swap_b32 v245, v247
    s_waitcnt lgkmcnt(4)
    v_mfma_f32_32x32x16_bf16 v[144:159], a[48:51], v[200:203], v[144:159]
    ds_read_b128 v[192:195], v20 offset:33024
    v_mfma_f32_32x32x16_bf16 v[160:175], a[52:55], v[200:203], v[160:175]
    v_mfma_f32_32x32x16_bf16 v[144:159], a[56:59], v[204:207], v[144:159]
    ds_read_b128 v[196:199], v21 offset:33024
    v_mfma_f32_32x32x16_bf16 v[160:175], a[60:63], v[204:207], v[160:175]
    s_waitcnt lgkmcnt(4)
    v_mfma_f32_32x32x16_bf16 v[144:159], a[64:67], v[176:179], v[144:159]
    ds_read_b128 v[200:203], v22 offset:33024
    ds_write_b128 v24, v[232:235]
    v_mfma_f32_32x32x16_bf16 v[160:175], a[68:71], v[176:179], v[160:175]
    v_mfma_f32_32x32x16_bf16 v[144:159], a[72:75], v[180:183], v[144:159]
    ds_read_b128 v[204:207], v23 offset:33024
    ds_write_b128 v25, v[236:239]
    v_mfma_f32_32x32x16_bf16 v[160:175], a[76:79], v[180:183], v[160:175]
    s_waitcnt lgkmcnt(6)
    v_mfma_f32_32x32x16_bf16 v[144:159], a[80:83], v[184:187], v[144:159]
    ds_read_b128 v[176:179], v16 offset:33280
    ds_write_b128 v26, v[240:243]
    v_mfma_f32_32x32x16_bf16 v[160:175], a[84:87], v[184:187], v[160:175]
    v_mfma_f32_32x32x16_bf16 v[144:159], a[88:91], v[188:191], v[144:159]
    ds_read_b128 v[180:183], v17 offset:33280
    ds_write_b128 v27, v[244:247]
    v_mfma_f32_32x32x16_bf16 v[160:175], a[92:95], v[188:191], v[160:175]
    s_waitcnt lgkmcnt(8)
    v_mfma_f32_32x32x16_bf16 v[144:159], a[96:99], v[192:195], v[144:159]
    ds_read_b128 v[184:187], v18 offset:33280
    v_mfma_f32_32x32x16_bf16 v[160:175], a[100:103], v[192:195], v[160:175]
    v_mfma_f32_32x32x16_bf16 v[144:159], a[104:107], v[196:199], v[144:159]
    ds_read_b128 v[188:191], v19 offset:33280
    v_mfma_f32_32x32x16_bf16 v[160:175], a[108:111], v[196:199], v[160:175]
    s_waitcnt lgkmcnt(7)
    v_mfma_f32_32x32x16_bf16 v[144:159], a[112:115], v[200:203], v[144:159]
    ds_read_b128 v[192:195], v20 offset:33280
    v_mfma_f32_32x32x16_bf16 v[160:175], a[116:119], v[200:203], v[160:175]
    v_mfma_f32_32x32x16_bf16 v[144:159], a[120:123], v[204:207], v[144:159]
    ds_read_b128 v[196:199], v21 offset:33280
    s_waitcnt lgkmcnt(4)
    ds_read_b128 v[232:235], v28 offset:0
    ds_read_b128 v[236:239], v28 offset:1024
    ds_read_b128 v[240:243], v28 offset:2048
    ds_read_b128 v[244:247], v28 offset:3072
    v_mfma_f32_32x32x16_bf16 v[160:175], a[124:127], v[204:207], v[160:175]
    v_mfma_f32_32x32x16_bf16 v[144:159], a[128:131], v[176:179], v[144:159]
    ds_read_b128 v[200:203], v22 offset:33280
    v_mfma_f32_32x32x16_bf16 v[160:175], a[132:135], v[176:179], v[160:175]
    v_mfma_f32_32x32x16_bf16 v[144:159], a[136:139], v[180:183], v[144:159]
    ds_read_b128 v[204:207], v23 offset:33280
    v_mfma_f32_32x32x16_bf16 v[160:175], a[140:143], v[180:183], v[160:175]
    s_waitcnt lgkmcnt(8)
    v_mfma_f32_32x32x16_bf16 v[144:159], a[144:147], v[184:187], v[144:159]
    ds_read_b128 v[176:179], v16 offset:33536
    v_mfma_f32_32x32x16_bf16 v[160:175], a[148:151], v[184:187], v[160:175]
    v_mfma_f32_32x32x16_bf16 v[144:159], a[152:155], v[188:191], v[144:159]
    ds_read_b128 v[180:183], v17 offset:33536
    s_waitcnt lgkmcnt(7)
    s_add_u32 s36, s31, 65536
    buffer_store_dwordx4 v[232:235], v29, s[24:27], s36 offen sc1
    v_mfma_f32_32x32x16_bf16 v[160:175], a[156:159], v[188:191], v[160:175]
    v_mfma_f32_32x32x16_bf16 v[144:159], a[160:163], v[192:195], v[144:159]
    ds_read_b128 v[184:187], v18 offset:33536
    s_waitcnt lgkmcnt(7)
    s_add_u32 s36, s31, 73728
    buffer_store_dwordx4 v[236:239], v29, s[24:27], s36 offen sc1
    v_mfma_f32_32x32x16_bf16 v[160:175], a[164:167], v[192:195], v[160:175]
    v_mfma_f32_32x32x16_bf16 v[144:159], a[168:171], v[196:199], v[144:159]
    ds_read_b128 v[188:191], v19 offset:33536
    s_waitcnt lgkmcnt(7)
    s_add_u32 s36, s31, 81920
    buffer_store_dwordx4 v[240:243], v29, s[24:27], s36 offen sc1
    v_mfma_f32_32x32x16_bf16 v[160:175], a[172:175], v[196:199], v[160:175]
    s_waitcnt lgkmcnt(4)
    v_mfma_f32_32x32x16_bf16 v[144:159], a[176:179], v[200:203], v[144:159]
    ds_read_b128 v[192:195], v20 offset:33536
    s_add_u32 s36, s31, 90112
    buffer_store_dwordx4 v[244:247], v29, s[24:27], s36 offen sc1
    v_mfma_f32_32x32x16_bf16 v[160:175], a[180:183], v[200:203], v[160:175]
    v_mfma_f32_32x32x16_bf16 v[144:159], a[184:187], v[204:207], v[144:159]
    ds_read_b128 v[196:199], v21 offset:33536
    v_mfma_f32_32x32x16_bf16 v[160:175], a[188:191], v[204:207], v[160:175]
    s_waitcnt lgkmcnt(4)
    v_mfma_f32_32x32x16_bf16 v[144:159], a[192:195], v[176:179], v[144:159]
    ds_read_b128 v[200:203], v22 offset:33536
    v_mfma_f32_32x32x16_bf16 v[160:175], a[196:199], v[176:179], v[160:175]
    v_mfma_f32_32x32x16_bf16 v[144:159], a[200:203], v[180:183], v[144:159]
    ds_read_b128 v[204:207], v23 offset:33536
    v_mfma_f32_32x32x16_bf16 v[160:175], a[204:207], v[180:183], v[160:175]
    s_waitcnt lgkmcnt(4)
    v_mfma_f32_32x32x16_bf16 v[144:159], a[208:211], v[184:187], v[144:159]
    v_mfma_f32_32x32x16_bf16 v[160:175], a[212:215], v[184:187], v[160:175]
    v_mfma_f32_32x32x16_bf16 v[144:159], a[216:219], v[188:191], v[144:159]
    v_mfma_f32_32x32x16_bf16 v[160:175], a[220:223], v[188:191], v[160:175]
    s_waitcnt lgkmcnt(2)
    v_mfma_f32_32x32x16_bf16 v[144:159], a[224:227], v[192:195], v[144:159]
    v_mfma_f32_32x32x16_bf16 v[160:175], a[228:231], v[192:195], v[160:175]
    v_mfma_f32_32x32x16_bf16 v[144:159], a[232:235], v[196:199], v[144:159]
    v_mfma_f32_32x32x16_bf16 v[160:175], a[236:239], v[196:199], v[160:175]
    s_waitcnt lgkmcnt(0)
    v_mfma_f32_32x32x16_bf16 v[144:159], a[240:243], v[200:203], v[144:159]
    v_mfma_f32_32x32x16_bf16 v[160:175], a[244:247], v[200:203], v[160:175]
    v_mfma_f32_32x32x16_bf16 v[144:159], a[248:251], v[204:207], v[144:159]
    v_mfma_f32_32x32x16_bf16 v[160:175], a[252:255], v[204:207], v[160:175]
    s_nop 7
    s_nop 7
    v_cvt_pk_bf16_f32 v232, v144, v145
    v_cvt_pk_bf16_f32 v233, v146, v147
    v_cvt_pk_bf16_f32 v234, v148, v149
    v_cvt_pk_bf16_f32 v235, v150, v151
    v_cvt_pk_bf16_f32 v236, v152, v153
    v_cvt_pk_bf16_f32 v237, v154, v155
    v_cvt_pk_bf16_f32 v238, v156, v157
    v_cvt_pk_bf16_f32 v239, v158, v159
    v_cvt_pk_bf16_f32 v240, v160, v161
    v_cvt_pk_bf16_f32 v241, v162, v163
    v_cvt_pk_bf16_f32 v242, v164, v165
    v_cvt_pk_bf16_f32 v243, v166, v167
    v_cvt_pk_bf16_f32 v244, v168, v169
    v_cvt_pk_bf16_f32 v245, v170, v171
    v_cvt_pk_bf16_f32 v246, v172, v173
    v_cvt_pk_bf16_f32 v247, v174, v175
    s_nop 1
    v_permlane32_swap_b32 v232, v234
    v_permlane32_swap_b32 v233, v235
    v_permlane32_swap_b32 v236, v238
    v_permlane32_swap_b32 v237, v239
    v_permlane32_swap_b32 v240, v242
    v_permlane32_swap_b32 v241, v243
    v_permlane32_swap_b32 v244, v246
    v_permlane32_swap_b32 v245, v247
    ds_write_b128 v24, v[232:235]
    ds_write_b128 v25, v[236:239]
    ds_write_b128 v26, v[240:243]
    ds_write_b128 v27, v[244:247]
    s_waitcnt lgkmcnt(0)
    ds_read_b128 v[232:235], v28 offset:0
    ds_read_b128 v[236:239], v28 offset:1024
    ds_read_b128 v[240:243], v28 offset:2048
    ds_read_b128 v[244:247], v28 offset:3072
    s_waitcnt lgkmcnt(3)
    s_add_u32 s36, s31, 98304
    buffer_store_dwordx4 v[232:235], v29, s[24:27], s36 offen sc1
    s_waitcnt lgkmcnt(2)
    s_add_u32 s36, s31, 106496
    buffer_store_dwordx4 v[236:239], v29, s[24:27], s36 offen sc1
    s_waitcnt lgkmcnt(1)
    s_add_u32 s36, s31, 114688
    buffer_store_dwordx4 v[240:243], v29, s[24:27], s36 offen sc1
    s_waitcnt lgkmcnt(0)
    s_add_u32 s36, s31, 122880
    buffer_store_dwordx4 v[244:247], v29, s[24:27], s36 offen sc1
    s_waitcnt vmcnt(0)
    s_endpgm
joint_kernel_slow:
    ds_read_b128 v[32:35], v248 offset:0
    ds_read_b128 v[36:39], v248 offset:16
    ds_read_b128 v[40:43], v248 offset:2048
    ds_read_b128 v[44:47], v248 offset:2064
    ds_read_b128 v[48:51], v248 offset:4096
    ds_read_b128 v[52:55], v248 offset:4112
    ds_read_b128 v[56:59], v248 offset:6144
    ds_read_b128 v[60:63], v248 offset:6160
    ds_read_b128 v[64:67], v248 offset:8192
    ds_read_b128 v[68:71], v248 offset:8208
    ds_read_b128 v[72:75], v248 offset:10240
    ds_read_b128 v[76:79], v248 offset:10256
    ds_read_b128 v[80:83], v248 offset:12288
    ds_read_b128 v[84:87], v248 offset:12304
    ds_read_b128 v[88:91], v248 offset:14336
    ds_read_b128 v[92:95], v248 offset:14352
    s_waitcnt lgkmcnt(0)
    s_waitcnt vmcnt(2)
    v_add_f32 v208, v96, v32
    v_add_f32 v209, v97, v33
    v_add_f32 v210, v98, v34
    v_add_f32 v211, v99, v35
    v_add_f32 v212, v100, v36
    v_add_f32 v213, v101, v37
    v_add_f32 v214, v102, v38
    v_add_f32 v215, v103, v39
    s_mov_b32 s35, 28672
    buffer_load_dwordx4 a[112:115], v4, s[16:19], s35 offen offset:0
    v_exp_f32 v208, v208
    v_exp_f32 v209, v209
    v_exp_f32 v210, v210
    v_exp_f32 v211, v211
    buffer_load_dwordx4 a[116:119], v4, s[16:19], s35 offen offset:1024
    v_exp_f32 v212, v212
    v_exp_f32 v213, v213
    v_exp_f32 v214, v214
    v_exp_f32 v215, v215
    buffer_load_dwordx4 a[120:123], v4, s[16:19], s35 offen offset:2048
    v_sub_f32 v208, -0.5, v208
    v_sub_f32 v209, -0.5, v209
    v_sub_f32 v210, -0.5, v210
    v_sub_f32 v211, -0.5, v211
    v_sub_f32 v212, -0.5, v212
    v_sub_f32 v213, -0.5, v213
    v_sub_f32 v214, -0.5, v214
    v_sub_f32 v215, -0.5, v215
    buffer_load_dwordx4 a[124:127], v4, s[16:19], s35 offen offset:3072
    v_rcp_f32 v208, v208
    v_rcp_f32 v209, v209
    v_rcp_f32 v210, v210
    v_rcp_f32 v211, v211
    s_mov_b32 s35, 32768
    buffer_load_dwordx4 a[128:131], v4, s[16:19], s35 offen offset:0
    v_rcp_f32 v212, v212
    v_rcp_f32 v213, v213
    v_rcp_f32 v214, v214
    v_rcp_f32 v215, v215
    buffer_load_dwordx4 a[132:135], v4, s[16:19], s35 offen offset:1024
    v_cvt_pk_bf16_f32 v224, v208, v209
    v_cvt_pk_bf16_f32 v225, v210, v211
    v_cvt_pk_bf16_f32 v226, v212, v213
    v_cvt_pk_bf16_f32 v227, v214, v215
    ds_write_b128 v8, v[224:227] offset:0
    v_add_f32 v216, v96, v40
    buffer_load_dwordx4 a[136:139], v4, s[16:19], s35 offen offset:2048
    v_add_f32 v217, v97, v41
    v_add_f32 v218, v98, v42
    v_add_f32 v219, v99, v43
    v_add_f32 v220, v100, v44
    v_add_f32 v221, v101, v45
    v_add_f32 v222, v102, v46
    v_add_f32 v223, v103, v47
    v_exp_f32 v216, v216
    buffer_load_dwordx4 a[140:143], v4, s[16:19], s35 offen offset:3072
    v_exp_f32 v217, v217
    v_exp_f32 v218, v218
    v_exp_f32 v219, v219
    v_exp_f32 v220, v220
    s_mov_b32 s35, 36864
    buffer_load_dwordx4 a[144:147], v4, s[16:19], s35 offen offset:0
    v_exp_f32 v221, v221
    v_exp_f32 v222, v222
    v_exp_f32 v223, v223
    v_sub_f32 v216, -0.5, v216
    v_sub_f32 v217, -0.5, v217
    buffer_load_dwordx4 a[148:151], v4, s[16:19], s35 offen offset:1024
    v_sub_f32 v218, -0.5, v218
    v_sub_f32 v219, -0.5, v219
    v_sub_f32 v220, -0.5, v220
    v_sub_f32 v221, -0.5, v221
    v_sub_f32 v222, -0.5, v222
    v_sub_f32 v223, -0.5, v223
    v_rcp_f32 v216, v216
    buffer_load_dwordx4 a[152:155], v4, s[16:19], s35 offen offset:2048
    v_rcp_f32 v217, v217
    v_rcp_f32 v218, v218
    v_rcp_f32 v219, v219
    v_rcp_f32 v220, v220
    buffer_load_dwordx4 a[156:159], v4, s[16:19], s35 offen offset:3072
    v_rcp_f32 v221, v221
    v_rcp_f32 v222, v222
    v_rcp_f32 v223, v223
    v_cvt_pk_bf16_f32 v228, v216, v217
    v_cvt_pk_bf16_f32 v229, v218, v219
    s_mov_b32 s35, 40960
    buffer_load_dwordx4 a[160:163], v4, s[16:19], s35 offen offset:0
    v_cvt_pk_bf16_f32 v230, v220, v221
    v_cvt_pk_bf16_f32 v231, v222, v223
    ds_write_b128 v9, v[228:231] offset:0
    v_add_f32 v208, v96, v48
    v_add_f32 v209, v97, v49
    v_add_f32 v210, v98, v50
    buffer_load_dwordx4 a[164:167], v4, s[16:19], s35 offen offset:1024
    v_add_f32 v211, v99, v51
    v_add_f32 v212, v100, v52
    v_add_f32 v213, v101, v53
    v_add_f32 v214, v102, v54
    v_add_f32 v215, v103, v55
    v_exp_f32 v208, v208
    v_exp_f32 v209, v209
    buffer_load_dwordx4 a[168:171], v4, s[16:19], s35 offen offset:2048
    v_exp_f32 v210, v210
    v_exp_f32 v211, v211
    v_exp_f32 v212, v212
    v_exp_f32 v213, v213
    buffer_load_dwordx4 a[172:175], v4, s[16:19], s35 offen offset:3072
    v_exp_f32 v214, v214
    v_exp_f32 v215, v215
    v_sub_f32 v208, -0.5, v208
    v_sub_f32 v209, -0.5, v209
    v_sub_f32 v210, -0.5, v210
    v_sub_f32 v211, -0.5, v211
    s_mov_b32 s35, 45056
    buffer_load_dwordx4 a[176:179], v4, s[16:19], s35 offen offset:0
    v_sub_f32 v212, -0.5, v212
    v_sub_f32 v213, -0.5, v213
    v_sub_f32 v214, -0.5, v214
    v_sub_f32 v215, -0.5, v215
    v_rcp_f32 v208, v208
    v_rcp_f32 v209, v209
    buffer_load_dwordx4 a[180:183], v4, s[16:19], s35 offen offset:1024
    v_rcp_f32 v210, v210
    v_rcp_f32 v211, v211
    v_rcp_f32 v212, v212
    v_rcp_f32 v213, v213
    buffer_load_dwordx4 a[184:187], v4, s[16:19], s35 offen offset:2048
    v_rcp_f32 v214, v214
    v_rcp_f32 v215, v215
    v_cvt_pk_bf16_f32 v224, v208, v209
    v_cvt_pk_bf16_f32 v225, v210, v211
    v_cvt_pk_bf16_f32 v226, v212, v213
    v_cvt_pk_bf16_f32 v227, v214, v215
    buffer_load_dwordx4 a[188:191], v4, s[16:19], s35 offen offset:3072
    ds_write_b128 v10, v[224:227] offset:0
    v_add_f32 v216, v96, v56
    v_add_f32 v217, v97, v57
    v_add_f32 v218, v98, v58
    v_add_f32 v219, v99, v59
    v_add_f32 v220, v100, v60
    s_mov_b32 s35, 49152
    buffer_load_dwordx4 a[192:195], v4, s[16:19], s35 offen offset:0
    v_add_f32 v221, v101, v61
    v_add_f32 v222, v102, v62
    v_add_f32 v223, v103, v63
    v_exp_f32 v216, v216
    v_exp_f32 v217, v217
    v_exp_f32 v218, v218
    buffer_load_dwordx4 a[196:199], v4, s[16:19], s35 offen offset:1024
    v_exp_f32 v219, v219
    v_exp_f32 v220, v220
    v_exp_f32 v221, v221
    v_exp_f32 v222, v222
    buffer_load_dwordx4 a[200:203], v4, s[16:19], s35 offen offset:2048
    v_exp_f32 v223, v223
    v_sub_f32 v216, -0.5, v216
    v_sub_f32 v217, -0.5, v217
    v_sub_f32 v218, -0.5, v218
    v_sub_f32 v219, -0.5, v219
    v_sub_f32 v220, -0.5, v220
    v_sub_f32 v221, -0.5, v221
    buffer_load_dwordx4 a[204:207], v4, s[16:19], s35 offen offset:3072
    v_sub_f32 v222, -0.5, v222
    v_sub_f32 v223, -0.5, v223
    v_rcp_f32 v216, v216
    v_rcp_f32 v217, v217
    v_rcp_f32 v218, v218
    s_mov_b32 s35, 53248
    buffer_load_dwordx4 a[208:211], v4, s[16:19], s35 offen offset:0
    v_rcp_f32 v219, v219
    v_rcp_f32 v220, v220
    v_rcp_f32 v221, v221
    v_rcp_f32 v222, v222
    buffer_load_dwordx4 a[212:215], v4, s[16:19], s35 offen offset:1024
    v_rcp_f32 v223, v223
    v_cvt_pk_bf16_f32 v228, v216, v217
    v_cvt_pk_bf16_f32 v229, v218, v219
    v_cvt_pk_bf16_f32 v230, v220, v221
    v_cvt_pk_bf16_f32 v231, v222, v223
    ds_write_b128 v11, v[228:231] offset:0
    buffer_load_dwordx4 a[216:219], v4, s[16:19], s35 offen offset:2048
    v_add_f32 v208, v96, v64
    v_add_f32 v209, v97, v65
    v_add_f32 v210, v98, v66
    v_add_f32 v211, v99, v67
    v_add_f32 v212, v100, v68
    v_add_f32 v213, v101, v69
    v_add_f32 v214, v102, v70
    v_add_f32 v215, v103, v71
    buffer_load_dwordx4 a[220:223], v4, s[16:19], s35 offen offset:3072
    v_exp_f32 v208, v208
    v_exp_f32 v209, v209
    v_exp_f32 v210, v210
    v_exp_f32 v211, v211
    s_mov_b32 s35, 57344
    buffer_load_dwordx4 a[224:227], v4, s[16:19], s35 offen offset:0
    v_exp_f32 v212, v212
    v_exp_f32 v213, v213
    v_exp_f32 v214, v214
    v_exp_f32 v215, v215
    buffer_load_dwordx4 a[228:231], v4, s[16:19], s35 offen offset:1024
    v_sub_f32 v208, -0.5, v208
    v_sub_f32 v209, -0.5, v209
    v_sub_f32 v210, -0.5, v210
    v_sub_f32 v211, -0.5, v211
    v_sub_f32 v212, -0.5, v212
    v_sub_f32 v213, -0.5, v213
    v_sub_f32 v214, -0.5, v214
    v_sub_f32 v215, -0.5, v215
    buffer_load_dwordx4 a[232:235], v4, s[16:19], s35 offen offset:2048
    v_rcp_f32 v208, v208
    v_rcp_f32 v209, v209
    v_rcp_f32 v210, v210
    v_rcp_f32 v211, v211
    buffer_load_dwordx4 a[236:239], v4, s[16:19], s35 offen offset:3072
    v_rcp_f32 v212, v212
    v_rcp_f32 v213, v213
    v_rcp_f32 v214, v214
    v_rcp_f32 v215, v215
    s_mov_b32 s35, 61440
    buffer_load_dwordx4 a[240:243], v4, s[16:19], s35 offen offset:0
    v_cvt_pk_bf16_f32 v224, v208, v209
    v_cvt_pk_bf16_f32 v225, v210, v211
    v_cvt_pk_bf16_f32 v226, v212, v213
    v_cvt_pk_bf16_f32 v227, v214, v215
    ds_write_b128 v12, v[224:227] offset:0
    v_add_f32 v216, v96, v72
    buffer_load_dwordx4 a[244:247], v4, s[16:19], s35 offen offset:1024
    v_add_f32 v217, v97, v73
    v_add_f32 v218, v98, v74
    v_add_f32 v219, v99, v75
    v_add_f32 v220, v100, v76
    v_add_f32 v221, v101, v77
    v_add_f32 v222, v102, v78
    v_add_f32 v223, v103, v79
    v_exp_f32 v216, v216
    buffer_load_dwordx4 a[248:251], v4, s[16:19], s35 offen offset:2048
    v_exp_f32 v217, v217
    v_exp_f32 v218, v218
    v_exp_f32 v219, v219
    v_exp_f32 v220, v220
    buffer_load_dwordx4 a[252:255], v4, s[16:19], s35 offen offset:3072
    v_exp_f32 v221, v221
    v_exp_f32 v222, v222
    v_exp_f32 v223, v223
    v_sub_f32 v216, -0.5, v216
    v_sub_f32 v217, -0.5, v217
    v_sub_f32 v218, -0.5, v218
    v_sub_f32 v219, -0.5, v219
    v_sub_f32 v220, -0.5, v220
    v_sub_f32 v221, -0.5, v221
    v_sub_f32 v222, -0.5, v222
    v_sub_f32 v223, -0.5, v223
    v_rcp_f32 v216, v216
    v_rcp_f32 v217, v217
    v_rcp_f32 v218, v218
    v_rcp_f32 v219, v219
    v_rcp_f32 v220, v220
    v_rcp_f32 v221, v221
    v_rcp_f32 v222, v222
    v_rcp_f32 v223, v223
    v_cvt_pk_bf16_f32 v228, v216, v217
    v_cvt_pk_bf16_f32 v229, v218, v219
    v_cvt_pk_bf16_f32 v230, v220, v221
    v_cvt_pk_bf16_f32 v231, v222, v223
    ds_write_b128 v13, v[228:231] offset:0
    v_add_f32 v208, v96, v80
    v_add_f32 v209, v97, v81
    v_add_f32 v210, v98, v82
    v_add_f32 v211, v99, v83
    v_add_f32 v212, v100, v84
    v_add_f32 v213, v101, v85
    v_add_f32 v214, v102, v86
    v_add_f32 v215, v103, v87
    v_exp_f32 v208, v208
    v_exp_f32 v209, v209
    v_exp_f32 v210, v210
    v_exp_f32 v211, v211
    v_exp_f32 v212, v212
    v_exp_f32 v213, v213
    v_exp_f32 v214, v214
    v_exp_f32 v215, v215
    v_sub_f32 v208, -0.5, v208
    v_sub_f32 v209, -0.5, v209
    v_sub_f32 v210, -0.5, v210
    v_sub_f32 v211, -0.5, v211
    v_sub_f32 v212, -0.5, v212
    v_sub_f32 v213, -0.5, v213
    v_sub_f32 v214, -0.5, v214
    v_sub_f32 v215, -0.5, v215
    v_rcp_f32 v208, v208
    v_rcp_f32 v209, v209
    v_rcp_f32 v210, v210
    v_rcp_f32 v211, v211
    v_rcp_f32 v212, v212
    v_rcp_f32 v213, v213
    v_rcp_f32 v214, v214
    v_rcp_f32 v215, v215
    v_cvt_pk_bf16_f32 v224, v208, v209
    v_cvt_pk_bf16_f32 v225, v210, v211
    v_cvt_pk_bf16_f32 v226, v212, v213
    v_cvt_pk_bf16_f32 v227, v214, v215
    ds_write_b128 v14, v[224:227] offset:0
    v_add_f32 v216, v96, v88
    v_add_f32 v217, v97, v89
    v_add_f32 v218, v98, v90
    v_add_f32 v219, v99, v91
    v_add_f32 v220, v100, v92
    v_add_f32 v221, v101, v93
    v_add_f32 v222, v102, v94
    v_add_f32 v223, v103, v95
    v_exp_f32 v216, v216
    v_exp_f32 v217, v217
    v_exp_f32 v218, v218
    v_exp_f32 v219, v219
    v_exp_f32 v220, v220
    v_exp_f32 v221, v221
    v_exp_f32 v222, v222
    v_exp_f32 v223, v223
    v_sub_f32 v216, -0.5, v216
    v_sub_f32 v217, -0.5, v217
    v_sub_f32 v218, -0.5, v218
    v_sub_f32 v219, -0.5, v219
    v_sub_f32 v220, -0.5, v220
    v_sub_f32 v221, -0.5, v221
    v_sub_f32 v222, -0.5, v222
    v_sub_f32 v223, -0.5, v223
    v_rcp_f32 v216, v216
    v_rcp_f32 v217, v217
    v_rcp_f32 v218, v218
    v_rcp_f32 v219, v219
    v_rcp_f32 v220, v220
    v_rcp_f32 v221, v221
    v_rcp_f32 v222, v222
    v_rcp_f32 v223, v223
    v_cvt_pk_bf16_f32 v228, v216, v217
    v_cvt_pk_bf16_f32 v229, v218, v219
    v_cvt_pk_bf16_f32 v230, v220, v221
    v_cvt_pk_bf16_f32 v231, v222, v223
    ds_write_b128 v15, v[228:231] offset:0
    ds_read_b128 v[112:115], v250 offset:0
    ds_read_b128 v[116:119], v250 offset:32
    ds_read_b128 v[120:123], v250 offset:64
    ds_read_b128 v[124:127], v250 offset:96
    ds_read_b128 v[128:131], v250 offset:128
    ds_read_b128 v[132:135], v250 offset:160
    ds_read_b128 v[136:139], v250 offset:192
    ds_read_b128 v[140:143], v250 offset:224
    ds_read_b128 v[144:147], v250 offset:0
    ds_read_b128 v[148:151], v250 offset:32
    ds_read_b128 v[152:155], v250 offset:64
    ds_read_b128 v[156:159], v250 offset:96
    ds_read_b128 v[160:163], v250 offset:128
    ds_read_b128 v[164:167], v250 offset:160
    ds_read_b128 v[168:171], v250 offset:192
    ds_read_b128 v[172:175], v250 offset:224
    s_waitcnt lgkmcnt(0)
    s_barrier
    ds_read_b128 v[176:179], v16 offset:0
    ds_read_b128 v[180:183], v17 offset:0
    ds_read_b128 v[184:187], v18 offset:0
    ds_read_b128 v[188:191], v19 offset:0
    ds_read_b128 v[192:195], v20 offset:0
    ds_read_b128 v[196:199], v21 offset:0
    s_waitcnt lgkmcnt(4)
    v_mfma_f32_32x32x16_bf16 v[112:127], a[0:3], v[176:179], v[112:127]
    ds_read_b128 v[200:203], v22 offset:0
    s_add_u32 s36, s30, 16384
    buffer_load_dwordx4 v[96:99], v3, s[8:11], s36 offen offset:0 sc1
    buffer_load_dwordx4 v[100:103], v3, s[8:11], s36 offen offset:16 sc1
    s_waitcnt vmcnt(38)
    v_add_f32 v208, v104, v32
    v_add_f32 v209, v105, v33
    v_add_f32 v210, v106, v34
    v_add_f32 v211, v107, v35
    v_mfma_f32_32x32x16_bf16 v[128:143], a[4:7], v[176:179], v[128:143]
    v_add_f32 v212, v108, v36
    v_add_f32 v213, v109, v37
    v_add_f32 v214, v110, v38
    v_add_f32 v215, v111, v39
    v_exp_f32 v208, v208
    v_mfma_f32_32x32x16_bf16 v[112:127], a[8:11], v[180:183], v[112:127]
    ds_read_b128 v[204:207], v23 offset:0
    v_exp_f32 v209, v209
    v_exp_f32 v210, v210
    v_exp_f32 v211, v211
    v_mfma_f32_32x32x16_bf16 v[128:143], a[12:15], v[180:183], v[128:143]
    v_exp_f32 v212, v212
    v_exp_f32 v213, v213
    v_exp_f32 v214, v214
    s_waitcnt lgkmcnt(4)
    v_mfma_f32_32x32x16_bf16 v[112:127], a[16:19], v[184:187], v[112:127]
    ds_read_b128 v[176:179], v16 offset:256
    v_exp_f32 v215, v215
    v_sub_f32 v208, -0.5, v208
    v_sub_f32 v209, -0.5, v209
    v_mfma_f32_32x32x16_bf16 v[128:143], a[20:23], v[184:187], v[128:143]
    v_sub_f32 v210, -0.5, v210
    v_sub_f32 v211, -0.5, v211
    v_sub_f32 v212, -0.5, v212
    v_sub_f32 v213, -0.5, v213
    v_sub_f32 v214, -0.5, v214
    v_sub_f32 v215, -0.5, v215
    v_mfma_f32_32x32x16_bf16 v[112:127], a[24:27], v[188:191], v[112:127]
    ds_read_b128 v[180:183], v17 offset:256
    v_rcp_f32 v208, v208
    v_rcp_f32 v209, v209
    v_rcp_f32 v210, v210
    v_mfma_f32_32x32x16_bf16 v[128:143], a[28:31], v[188:191], v[128:143]
    v_rcp_f32 v211, v211
    v_rcp_f32 v212, v212
    v_rcp_f32 v213, v213
    s_waitcnt lgkmcnt(4)
    v_mfma_f32_32x32x16_bf16 v[112:127], a[32:35], v[192:195], v[112:127]
    ds_read_b128 v[184:187], v18 offset:256
    v_rcp_f32 v214, v214
    v_rcp_f32 v215, v215
    v_mfma_f32_32x32x16_bf16 v[128:143], a[36:39], v[192:195], v[128:143]
    v_cvt_pk_bf16_f32 v224, v208, v209
    v_cvt_pk_bf16_f32 v225, v210, v211
    v_cvt_pk_bf16_f32 v226, v212, v213
    v_cvt_pk_bf16_f32 v227, v214, v215
    ds_write_b128 v8, v[224:227] offset:32768
    v_mfma_f32_32x32x16_bf16 v[112:127], a[40:43], v[196:199], v[112:127]
    ds_read_b128 v[188:191], v19 offset:256
    v_add_f32 v216, v104, v40
    v_add_f32 v217, v105, v41
    v_add_f32 v218, v106, v42
    v_add_f32 v219, v107, v43
    v_mfma_f32_32x32x16_bf16 v[128:143], a[44:47], v[196:199], v[128:143]
    v_add_f32 v220, v108, v44
    v_add_f32 v221, v109, v45
    v_add_f32 v222, v110, v46
    v_add_f32 v223, v111, v47
    v_exp_f32 v216, v216
    s_waitcnt lgkmcnt(5)
    v_mfma_f32_32x32x16_bf16 v[112:127], a[48:51], v[200:203], v[112:127]
    ds_read_b128 v[192:195], v20 offset:256
    v_exp_f32 v217, v217
    v_exp_f32 v218, v218
    v_exp_f32 v219, v219
    v_mfma_f32_32x32x16_bf16 v[128:143], a[52:55], v[200:203], v[128:143]
    v_exp_f32 v220, v220
    v_exp_f32 v221, v221
    v_exp_f32 v222, v222
    v_mfma_f32_32x32x16_bf16 v[112:127], a[56:59], v[204:207], v[112:127]
    ds_read_b128 v[196:199], v21 offset:256
    v_exp_f32 v223, v223
    v_sub_f32 v216, -0.5, v216
    v_sub_f32 v217, -0.5, v217
    v_mfma_f32_32x32x16_bf16 v[128:143], a[60:63], v[204:207], v[128:143]
    v_sub_f32 v218, -0.5, v218
    v_sub_f32 v219, -0.5, v219
    v_sub_f32 v220, -0.5, v220
    v_sub_f32 v221, -0.5, v221
    v_sub_f32 v222, -0.5, v222
    v_sub_f32 v223, -0.5, v223
    s_waitcnt lgkmcnt(5)
    v_mfma_f32_32x32x16_bf16 v[112:127], a[64:67], v[176:179], v[112:127]
    ds_read_b128 v[200:203], v22 offset:256
    v_rcp_f32 v216, v216
    v_rcp_f32 v217, v217
    v_rcp_f32 v218, v218
    v_mfma_f32_32x32x16_bf16 v[128:143], a[68:71], v[176:179], v[128:143]
    v_rcp_f32 v219, v219
    v_rcp_f32 v220, v220
    v_rcp_f32 v221, v221
    v_mfma_f32_32x32x16_bf16 v[112:127], a[72:75], v[180:183], v[112:127]
    ds_read_b128 v[204:207], v23 offset:256
    v_rcp_f32 v222, v222
    v_rcp_f32 v223, v223
    v_mfma_f32_32x32x16_bf16 v[128:143], a[76:79], v[180:183], v[128:143]
    v_cvt_pk_bf16_f32 v228, v216, v217
    v_cvt_pk_bf16_f32 v229, v218, v219
    v_cvt_pk_bf16_f32 v230, v220, v221
    v_cvt_pk_bf16_f32 v231, v222, v223
    ds_write_b128 v9, v[228:231] offset:32768
    s_waitcnt lgkmcnt(5)
    v_mfma_f32_32x32x16_bf16 v[112:127], a[80:83], v[184:187], v[112:127]
    ds_read_b128 v[176:179], v16 offset:512
    v_add_f32 v208, v104, v48
    v_add_f32 v209, v105, v49
    v_add_f32 v210, v106, v50
    v_add_f32 v211, v107, v51
    v_mfma_f32_32x32x16_bf16 v[128:143], a[84:87], v[184:187], v[128:143]
    v_add_f32 v212, v108, v52
    v_add_f32 v213, v109, v53
    v_add_f32 v214, v110, v54
    v_add_f32 v215, v111, v55
    v_exp_f32 v208, v208
    v_mfma_f32_32x32x16_bf16 v[112:127], a[88:91], v[188:191], v[112:127]
    ds_read_b128 v[180:183], v17 offset:512
    v_exp_f32 v209, v209
    v_exp_f32 v210, v210
    v_exp_f32 v211, v211
    v_mfma_f32_32x32x16_bf16 v[128:143], a[92:95], v[188:191], v[128:143]
    v_exp_f32 v212, v212
    v_exp_f32 v213, v213
    v_exp_f32 v214, v214
    s_waitcnt lgkmcnt(5)
    v_mfma_f32_32x32x16_bf16 v[112:127], a[96:99], v[192:195], v[112:127]
    ds_read_b128 v[184:187], v18 offset:512
    v_exp_f32 v215, v215
    v_sub_f32 v208, -0.5, v208
    v_sub_f32 v209, -0.5, v209
    v_mfma_f32_32x32x16_bf16 v[128:143], a[100:103], v[192:195], v[128:143]
    v_sub_f32 v210, -0.5, v210
    v_sub_f32 v211, -0.5, v211
    v_sub_f32 v212, -0.5, v212
    v_sub_f32 v213, -0.5, v213
    v_sub_f32 v214, -0.5, v214
    v_sub_f32 v215, -0.5, v215
    v_mfma_f32_32x32x16_bf16 v[112:127], a[104:107], v[196:199], v[112:127]
    ds_read_b128 v[188:191], v19 offset:512
    v_rcp_f32 v208, v208
    v_rcp_f32 v209, v209
    v_rcp_f32 v210, v210
    v_mfma_f32_32x32x16_bf16 v[128:143], a[108:111], v[196:199], v[128:143]
    v_rcp_f32 v211, v211
    v_rcp_f32 v212, v212
    v_rcp_f32 v213, v213
    s_waitcnt vmcnt(37)
    s_waitcnt lgkmcnt(5)
    v_mfma_f32_32x32x16_bf16 v[112:127], a[112:115], v[200:203], v[112:127]
    ds_read_b128 v[192:195], v20 offset:512
    v_rcp_f32 v214, v214
    v_rcp_f32 v215, v215
    s_waitcnt vmcnt(36)
    v_mfma_f32_32x32x16_bf16 v[128:143], a[116:119], v[200:203], v[128:143]
    v_cvt_pk_bf16_f32 v224, v208, v209
    v_cvt_pk_bf16_f32 v225, v210, v211
    v_cvt_pk_bf16_f32 v226, v212, v213
    v_cvt_pk_bf16_f32 v227, v214, v215
    ds_write_b128 v10, v[224:227] offset:32768
    s_waitcnt vmcnt(35)
    v_mfma_f32_32x32x16_bf16 v[112:127], a[120:123], v[204:207], v[112:127]
    ds_read_b128 v[196:199], v21 offset:512
    v_add_f32 v216, v104, v56
    v_add_f32 v217, v105, v57
    v_add_f32 v218, v106, v58
    v_add_f32 v219, v107, v59
    s_waitcnt vmcnt(34)
    v_mfma_f32_32x32x16_bf16 v[128:143], a[124:127], v[204:207], v[128:143]
    v_add_f32 v220, v108, v60
    v_add_f32 v221, v109, v61
    v_add_f32 v222, v110, v62
    v_add_f32 v223, v111, v63
    v_exp_f32 v216, v216
    s_waitcnt vmcnt(33)
    s_waitcnt lgkmcnt(5)
    v_mfma_f32_32x32x16_bf16 v[112:127], a[128:131], v[176:179], v[112:127]
    ds_read_b128 v[200:203], v22 offset:512
    v_exp_f32 v217, v217
    v_exp_f32 v218, v218
    v_exp_f32 v219, v219
    s_waitcnt vmcnt(32)
    v_mfma_f32_32x32x16_bf16 v[128:143], a[132:135], v[176:179], v[128:143]
    v_exp_f32 v220, v220
    v_exp_f32 v221, v221
    v_exp_f32 v222, v222
    s_waitcnt vmcnt(31)
    v_mfma_f32_32x32x16_bf16 v[112:127], a[136:139], v[180:183], v[112:127]
    ds_read_b128 v[204:207], v23 offset:512
    v_exp_f32 v223, v223
    v_sub_f32 v216, -0.5, v216
    v_sub_f32 v217, -0.5, v217
    s_waitcnt vmcnt(30)
    v_mfma_f32_32x32x16_bf16 v[128:143], a[140:143], v[180:183], v[128:143]
    v_sub_f32 v218, -0.5, v218
    v_sub_f32 v219, -0.5, v219
    v_sub_f32 v220, -0.5, v220
    v_sub_f32 v221, -0.5, v221
    v_sub_f32 v222, -0.5, v222
    v_sub_f32 v223, -0.5, v223
    s_waitcnt vmcnt(29)
    s_waitcnt lgkmcnt(5)
    v_mfma_f32_32x32x16_bf16 v[112:127], a[144:147], v[184:187], v[112:127]
    ds_read_b128 v[176:179], v16 offset:768
    v_rcp_f32 v216, v216
    v_rcp_f32 v217, v217
    v_rcp_f32 v218, v218
    s_waitcnt vmcnt(28)
    v_mfma_f32_32x32x16_bf16 v[128:143], a[148:151], v[184:187], v[128:143]
    v_rcp_f32 v219, v219
    v_rcp_f32 v220, v220
    v_rcp_f32 v221, v221
    s_waitcnt vmcnt(27)
    v_mfma_f32_32x32x16_bf16 v[112:127], a[152:155], v[188:191], v[112:127]
    ds_read_b128 v[180:183], v17 offset:768
    v_rcp_f32 v222, v222
    v_rcp_f32 v223, v223
    s_waitcnt vmcnt(26)
    v_mfma_f32_32x32x16_bf16 v[128:143], a[156:159], v[188:191], v[128:143]
    v_cvt_pk_bf16_f32 v228, v216, v217
    v_cvt_pk_bf16_f32 v229, v218, v219
    v_cvt_pk_bf16_f32 v230, v220, v221
    v_cvt_pk_bf16_f32 v231, v222, v223
    ds_write_b128 v11, v[228:231] offset:32768
    s_waitcnt vmcnt(25)
    s_waitcnt lgkmcnt(5)
    v_mfma_f32_32x32x16_bf16 v[112:127], a[160:163], v[192:195], v[112:127]
    ds_read_b128 v[184:187], v18 offset:768
    v_add_f32 v208, v104, v64
    v_add_f32 v209, v105, v65
    v_add_f32 v210, v106, v66
    v_add_f32 v211, v107, v67
    s_waitcnt vmcnt(24)
    v_mfma_f32_32x32x16_bf16 v[128:143], a[164:167], v[192:195], v[128:143]
    v_add_f32 v212, v108, v68
    v_add_f32 v213, v109, v69
    v_add_f32 v214, v110, v70
    v_add_f32 v215, v111, v71
    v_exp_f32 v208, v208
    s_waitcnt vmcnt(23)
    v_mfma_f32_32x32x16_bf16 v[112:127], a[168:171], v[196:199], v[112:127]
    ds_read_b128 v[188:191], v19 offset:768
    v_exp_f32 v209, v209
    v_exp_f32 v210, v210
    v_exp_f32 v211, v211
    s_waitcnt vmcnt(22)
    v_mfma_f32_32x32x16_bf16 v[128:143], a[172:175], v[196:199], v[128:143]
    v_exp_f32 v212, v212
    v_exp_f32 v213, v213
    v_exp_f32 v214, v214
    s_waitcnt vmcnt(21)
    s_waitcnt lgkmcnt(5)
    v_mfma_f32_32x32x16_bf16 v[112:127], a[176:179], v[200:203], v[112:127]
    ds_read_b128 v[192:195], v20 offset:768
    v_exp_f32 v215, v215
    v_sub_f32 v208, -0.5, v208
    v_sub_f32 v209, -0.5, v209
    s_waitcnt vmcnt(20)
    v_mfma_f32_32x32x16_bf16 v[128:143], a[180:183], v[200:203], v[128:143]
    v_sub_f32 v210, -0.5, v210
    v_sub_f32 v211, -0.5, v211
    v_sub_f32 v212, -0.5, v212
    v_sub_f32 v213, -0.5, v213
    v_sub_f32 v214, -0.5, v214
    v_sub_f32 v215, -0.5, v215
    s_waitcnt vmcnt(19)
    v_mfma_f32_32x32x16_bf16 v[112:127], a[184:187], v[204:207], v[112:127]
    ds_read_b128 v[196:199], v21 offset:768
    v_rcp_f32 v208, v208
    v_rcp_f32 v209, v209
    v_rcp_f32 v210, v210
    s_waitcnt vmcnt(18)
    v_mfma_f32_32x32x16_bf16 v[128:143], a[188:191], v[204:207], v[128:143]
    v_rcp_f32 v211, v211
    v_rcp_f32 v212, v212
    v_rcp_f32 v213, v213
    s_waitcnt vmcnt(17)
    s_waitcnt lgkmcnt(5)
    v_mfma_f32_32x32x16_bf16 v[112:127], a[192:195], v[176:179], v[112:127]
    ds_read_b128 v[200:203], v22 offset:768
    v_rcp_f32 v214, v214
    v_rcp_f32 v215, v215
    s_waitcnt vmcnt(16)
    v_mfma_f32_32x32x16_bf16 v[128:143], a[196:199], v[176:179], v[128:143]
    v_cvt_pk_bf16_f32 v224, v208, v209
    v_cvt_pk_bf16_f32 v225, v210, v211
    v_cvt_pk_bf16_f32 v226, v212, v213
    v_cvt_pk_bf16_f32 v227, v214, v215
    ds_write_b128 v12, v[224:227] offset:32768
    s_waitcnt vmcnt(15)
    v_mfma_f32_32x32x16_bf16 v[112:127], a[200:203], v[180:183], v[112:127]
    ds_read_b128 v[204:207], v23 offset:768
    v_add_f32 v216, v104, v72
    v_add_f32 v217, v105, v73
    v_add_f32 v218, v106, v74
    v_add_f32 v219, v107, v75
    s_waitcnt vmcnt(14)
    v_mfma_f32_32x32x16_bf16 v[128:143], a[204:207], v[180:183], v[128:143]
    v_add_f32 v220, v108, v76
    v_add_f32 v221, v109, v77
    v_add_f32 v222, v110, v78
    v_add_f32 v223, v111, v79
    v_exp_f32 v216, v216
    v_exp_f32 v217, v217
    v_exp_f32 v218, v218
    v_exp_f32 v219, v219
    v_exp_f32 v220, v220
    v_exp_f32 v221, v221
    v_exp_f32 v222, v222
    v_exp_f32 v223, v223
    v_sub_f32 v216, -0.5, v216
    v_sub_f32 v217, -0.5, v217
    v_sub_f32 v218, -0.5, v218
    v_sub_f32 v219, -0.5, v219
    v_sub_f32 v220, -0.5, v220
    v_sub_f32 v221, -0.5, v221
    v_sub_f32 v222, -0.5, v222
    v_sub_f32 v223, -0.5, v223
    v_rcp_f32 v216, v216
    v_rcp_f32 v217, v217
    v_rcp_f32 v218, v218
    v_rcp_f32 v219, v219
    v_rcp_f32 v220, v220
    v_rcp_f32 v221, v221
    v_rcp_f32 v222, v222
    v_rcp_f32 v223, v223
    v_cvt_pk_bf16_f32 v228, v216, v217
    v_cvt_pk_bf16_f32 v229, v218, v219
    v_cvt_pk_bf16_f32 v230, v220, v221
    v_cvt_pk_bf16_f32 v231, v222, v223
    ds_write_b128 v13, v[228:231] offset:32768
    v_add_f32 v208, v104, v80
    v_add_f32 v209, v105, v81
    v_add_f32 v210, v106, v82
    v_add_f32 v211, v107, v83
    v_add_f32 v212, v108, v84
    v_add_f32 v213, v109, v85
    v_add_f32 v214, v110, v86
    v_add_f32 v215, v111, v87
    v_exp_f32 v208, v208
    v_exp_f32 v209, v209
    v_exp_f32 v210, v210
    v_exp_f32 v211, v211
    v_exp_f32 v212, v212
    v_exp_f32 v213, v213
    v_exp_f32 v214, v214
    v_exp_f32 v215, v215
    v_sub_f32 v208, -0.5, v208
    v_sub_f32 v209, -0.5, v209
    v_sub_f32 v210, -0.5, v210
    v_sub_f32 v211, -0.5, v211
    v_sub_f32 v212, -0.5, v212
    v_sub_f32 v213, -0.5, v213
    v_sub_f32 v214, -0.5, v214
    v_sub_f32 v215, -0.5, v215
    v_rcp_f32 v208, v208
    v_rcp_f32 v209, v209
    v_rcp_f32 v210, v210
    v_rcp_f32 v211, v211
    v_rcp_f32 v212, v212
    v_rcp_f32 v213, v213
    v_rcp_f32 v214, v214
    v_rcp_f32 v215, v215
    v_cvt_pk_bf16_f32 v224, v208, v209
    v_cvt_pk_bf16_f32 v225, v210, v211
    v_cvt_pk_bf16_f32 v226, v212, v213
    v_cvt_pk_bf16_f32 v227, v214, v215
    ds_write_b128 v14, v[224:227] offset:32768
    v_add_f32 v216, v104, v88
    v_add_f32 v217, v105, v89
    v_add_f32 v218, v106, v90
    v_add_f32 v219, v107, v91
    v_add_f32 v220, v108, v92
    v_add_f32 v221, v109, v93
    v_add_f32 v222, v110, v94
    v_add_f32 v223, v111, v95
    v_exp_f32 v216, v216
    v_exp_f32 v217, v217
    v_exp_f32 v218, v218
    v_exp_f32 v219, v219
    v_exp_f32 v220, v220
    v_exp_f32 v221, v221
    v_exp_f32 v222, v222
    v_exp_f32 v223, v223
    v_sub_f32 v216, -0.5, v216
    v_sub_f32 v217, -0.5, v217
    v_sub_f32 v218, -0.5, v218
    v_sub_f32 v219, -0.5, v219
    v_sub_f32 v220, -0.5, v220
    v_sub_f32 v221, -0.5, v221
    v_sub_f32 v222, -0.5, v222
    v_sub_f32 v223, -0.5, v223
    v_rcp_f32 v216, v216
    v_rcp_f32 v217, v217
    v_rcp_f32 v218, v218
    v_rcp_f32 v219, v219
    v_rcp_f32 v220, v220
    v_rcp_f32 v221, v221
    v_rcp_f32 v222, v222
    v_rcp_f32 v223, v223
    v_cvt_pk_bf16_f32 v228, v216, v217
    v_cvt_pk_bf16_f32 v229, v218, v219
    v_cvt_pk_bf16_f32 v230, v220, v221
    v_cvt_pk_bf16_f32 v231, v222, v223
    ds_write_b128 v15, v[228:231] offset:32768
    s_waitcnt lgkmcnt(0)
    s_barrier
    s_waitcnt vmcnt(13)
    v_mfma_f32_32x32x16_bf16 v[112:127], a[208:211], v[184:187], v[112:127]
    ds_read_b128 v[176:179], v16 offset:32768
    s_add_u32 s36, s30, 24576
    buffer_load_dwordx4 v[104:107], v3, s[8:11], s36 offen offset:0 sc1
    buffer_load_dwordx4 v[108:111], v3, s[8:11], s36 offen offset:16 sc1
    s_waitcnt vmcnt(2)
    v_add_f32 v208, v96, v32
    v_add_f32 v209, v97, v33
    v_add_f32 v210, v98, v34
    v_add_f32 v211, v99, v35
    v_mfma_f32_32x32x16_bf16 v[128:143], a[212:215], v[184:187], v[128:143]
    v_add_f32 v212, v100, v36
    v_add_f32 v213, v101, v37
    v_add_f32 v214, v102, v38
    v_add_f32 v215, v103, v39
    v_exp_f32 v208, v208
    v_mfma_f32_32x32x16_bf16 v[112:127], a[216:219], v[188:191], v[112:127]
    ds_read_b128 v[180:183], v17 offset:32768
    v_exp_f32 v209, v209
    v_exp_f32 v210, v210
    v_exp_f32 v211, v211
    v_mfma_f32_32x32x16_bf16 v[128:143], a[220:223], v[188:191], v[128:143]
    v_exp_f32 v212, v212
    v_exp_f32 v213, v213
    v_exp_f32 v214, v214
    v_mfma_f32_32x32x16_bf16 v[112:127], a[224:227], v[192:195], v[112:127]
    ds_read_b128 v[184:187], v18 offset:32768
    v_exp_f32 v215, v215
    v_sub_f32 v208, -0.5, v208
    v_sub_f32 v209, -0.5, v209
    v_mfma_f32_32x32x16_bf16 v[128:143], a[228:231], v[192:195], v[128:143]
    v_sub_f32 v210, -0.5, v210
    v_sub_f32 v211, -0.5, v211
    v_sub_f32 v212, -0.5, v212
    v_sub_f32 v213, -0.5, v213
    v_sub_f32 v214, -0.5, v214
    v_sub_f32 v215, -0.5, v215
    v_mfma_f32_32x32x16_bf16 v[112:127], a[232:235], v[196:199], v[112:127]
    ds_read_b128 v[188:191], v19 offset:32768
    v_rcp_f32 v208, v208
    v_rcp_f32 v209, v209
    v_rcp_f32 v210, v210
    v_mfma_f32_32x32x16_bf16 v[128:143], a[236:239], v[196:199], v[128:143]
    v_rcp_f32 v211, v211
    v_rcp_f32 v212, v212
    v_rcp_f32 v213, v213
    v_mfma_f32_32x32x16_bf16 v[112:127], a[240:243], v[200:203], v[112:127]
    ds_read_b128 v[192:195], v20 offset:32768
    v_rcp_f32 v214, v214
    v_rcp_f32 v215, v215
    v_mfma_f32_32x32x16_bf16 v[128:143], a[244:247], v[200:203], v[128:143]
    v_cvt_pk_bf16_f32 v224, v208, v209
    v_cvt_pk_bf16_f32 v225, v210, v211
    v_cvt_pk_bf16_f32 v226, v212, v213
    v_cvt_pk_bf16_f32 v227, v214, v215
    ds_write_b128 v8, v[224:227] offset:0
    v_mfma_f32_32x32x16_bf16 v[112:127], a[248:251], v[204:207], v[112:127]
    ds_read_b128 v[196:199], v21 offset:32768
    v_add_f32 v216, v96, v40
    v_add_f32 v217, v97, v41
    v_add_f32 v218, v98, v42
    v_add_f32 v219, v99, v43
    v_mfma_f32_32x32x16_bf16 v[128:143], a[252:255], v[204:207], v[128:143]
    v_add_f32 v220, v100, v44
    v_add_f32 v221, v101, v45
    v_add_f32 v222, v102, v46
    v_add_f32 v223, v103, v47
    v_exp_f32 v216, v216
    s_waitcnt lgkmcnt(5)
    v_mfma_f32_32x32x16_bf16 v[144:159], a[0:3], v[176:179], v[144:159]
    ds_read_b128 v[200:203], v22 offset:32768
    v_exp_f32 v217, v217
    v_exp_f32 v218, v218
    v_exp_f32 v219, v219
    v_mfma_f32_32x32x16_bf16 v[160:175], a[4:7], v[176:179], v[160:175]
    v_exp_f32 v220, v220
    v_exp_f32 v221, v221
    v_exp_f32 v222, v222
    v_mfma_f32_32x32x16_bf16 v[144:159], a[8:11], v[180:183], v[144:159]
    ds_read_b128 v[204:207], v23 offset:32768
    v_exp_f32 v223, v223
    v_sub_f32 v216, -0.5, v216
    v_sub_f32 v217, -0.5, v217
    v_mfma_f32_32x32x16_bf16 v[160:175], a[12:15], v[180:183], v[160:175]
    v_sub_f32 v218, -0.5, v218
    v_sub_f32 v219, -0.5, v219
    v_sub_f32 v220, -0.5, v220
    v_sub_f32 v221, -0.5, v221
    v_sub_f32 v222, -0.5, v222
    v_sub_f32 v223, -0.5, v223
    s_waitcnt lgkmcnt(5)
    v_mfma_f32_32x32x16_bf16 v[144:159], a[16:19], v[184:187], v[144:159]
    ds_read_b128 v[176:179], v16 offset:33024
    v_rcp_f32 v216, v216
    v_rcp_f32 v217, v217
    v_rcp_f32 v218, v218
    v_mfma_f32_32x32x16_bf16 v[160:175], a[20:23], v[184:187], v[160:175]
    v_rcp_f32 v219, v219
    v_rcp_f32 v220, v220
    v_rcp_f32 v221, v221
    v_mfma_f32_32x32x16_bf16 v[144:159], a[24:27], v[188:191], v[144:159]
    ds_read_b128 v[180:183], v17 offset:33024
    v_rcp_f32 v222, v222
    v_rcp_f32 v223, v223
    v_mfma_f32_32x32x16_bf16 v[160:175], a[28:31], v[188:191], v[160:175]
    v_cvt_pk_bf16_f32 v228, v216, v217
    v_cvt_pk_bf16_f32 v229, v218, v219
    v_cvt_pk_bf16_f32 v230, v220, v221
    v_cvt_pk_bf16_f32 v231, v222, v223
    ds_write_b128 v9, v[228:231] offset:0
    s_waitcnt lgkmcnt(5)
    v_mfma_f32_32x32x16_bf16 v[144:159], a[32:35], v[192:195], v[144:159]
    ds_read_b128 v[184:187], v18 offset:33024
    v_cvt_pk_bf16_f32 v232, v112, v113
    v_cvt_pk_bf16_f32 v233, v114, v115
    v_cvt_pk_bf16_f32 v234, v116, v117
    v_cvt_pk_bf16_f32 v235, v118, v119
    v_mfma_f32_32x32x16_bf16 v[160:175], a[36:39], v[192:195], v[160:175]
    v_cvt_pk_bf16_f32 v236, v120, v121
    v_cvt_pk_bf16_f32 v237, v122, v123
    v_cvt_pk_bf16_f32 v238, v124, v125
    v_cvt_pk_bf16_f32 v239, v126, v127
    v_cvt_pk_bf16_f32 v240, v128, v129
    v_cvt_pk_bf16_f32 v241, v130, v131
    v_mfma_f32_32x32x16_bf16 v[144:159], a[40:43], v[196:199], v[144:159]
    ds_read_b128 v[188:191], v19 offset:33024
    v_cvt_pk_bf16_f32 v242, v132, v133
    v_cvt_pk_bf16_f32 v243, v134, v135
    v_cvt_pk_bf16_f32 v244, v136, v137
    v_cvt_pk_bf16_f32 v245, v138, v139
    v_cvt_pk_bf16_f32 v246, v140, v141
    v_mfma_f32_32x32x16_bf16 v[160:175], a[44:47], v[196:199], v[160:175]
    v_cvt_pk_bf16_f32 v247, v142, v143
    s_nop 1
    ds_read_b128 v[112:115], v250 offset:0
    ds_read_b128 v[116:119], v250 offset:32
    ds_read_b128 v[120:123], v250 offset:64
    ds_read_b128 v[124:127], v250 offset:96
    s_waitcnt lgkmcnt(9)
    v_mfma_f32_32x32x16_bf16 v[144:159], a[48:51], v[200:203], v[144:159]
    ds_read_b128 v[192:195], v20 offset:33024
    ds_read_b128 v[128:131], v250 offset:128
    ds_read_b128 v[132:135], v250 offset:160
    ds_read_b128 v[136:139], v250 offset:192
    ds_read_b128 v[140:143], v250 offset:224
    v_permlane32_swap_b32 v232, v234
    v_mfma_f32_32x32x16_bf16 v[160:175], a[52:55], v[200:203], v[160:175]
    v_permlane32_swap_b32 v233, v235
    v_permlane32_swap_b32 v236, v238
    v_permlane32_swap_b32 v237, v239
    v_permlane32_swap_b32 v240, v242
    v_permlane32_swap_b32 v241, v243
    v_permlane32_swap_b32 v244, v246
    v_mfma_f32_32x32x16_bf16 v[144:159], a[56:59], v[204:207], v[144:159]
    ds_read_b128 v[196:199], v21 offset:33024
    v_permlane32_swap_b32 v245, v247
    v_add_f32 v208, v96, v48
    v_add_f32 v209, v97, v49
    v_add_f32 v210, v98, v50
    v_add_f32 v211, v99, v51
    v_mfma_f32_32x32x16_bf16 v[160:175], a[60:63], v[204:207], v[160:175]
    v_add_f32 v212, v100, v52
    v_add_f32 v213, v101, v53
    v_add_f32 v214, v102, v54
    v_add_f32 v215, v103, v55
    v_exp_f32 v208, v208
    s_waitcnt lgkmcnt(13)
    v_mfma_f32_32x32x16_bf16 v[144:159], a[64:67], v[176:179], v[144:159]
    ds_read_b128 v[200:203], v22 offset:33024
    ds_write_b128 v24, v[232:235]
    v_exp_f32 v209, v209
    v_mfma_f32_32x32x16_bf16 v[160:175], a[68:71], v[176:179], v[160:175]
    v_exp_f32 v210, v210
    v_exp_f32 v211, v211
    v_exp_f32 v212, v212
    v_mfma_f32_32x32x16_bf16 v[144:159], a[72:75], v[180:183], v[144:159]
    ds_read_b128 v[204:207], v23 offset:33024
    ds_write_b128 v25, v[236:239]
    v_exp_f32 v213, v213
    v_mfma_f32_32x32x16_bf16 v[160:175], a[76:79], v[180:183], v[160:175]
    v_exp_f32 v214, v214
    v_exp_f32 v215, v215
    v_sub_f32 v208, -0.5, v208
    v_sub_f32 v209, -0.5, v209
    s_waitcnt lgkmcnt(14)
    v_mfma_f32_32x32x16_bf16 v[144:159], a[80:83], v[184:187], v[144:159]
    ds_read_b128 v[176:179], v16 offset:33280
    ds_write_b128 v26, v[240:243]
    v_sub_f32 v210, -0.5, v210
    v_sub_f32 v211, -0.5, v211
    v_mfma_f32_32x32x16_bf16 v[160:175], a[84:87], v[184:187], v[160:175]
    v_sub_f32 v212, -0.5, v212
    v_sub_f32 v213, -0.5, v213
    v_sub_f32 v214, -0.5, v214
    v_sub_f32 v215, -0.5, v215
    v_rcp_f32 v208, v208
    v_mfma_f32_32x32x16_bf16 v[144:159], a[88:91], v[188:191], v[144:159]
    ds_read_b128 v[180:183], v17 offset:33280
    ds_write_b128 v27, v[244:247]
    v_rcp_f32 v209, v209
    v_mfma_f32_32x32x16_bf16 v[160:175], a[92:95], v[188:191], v[160:175]
    v_rcp_f32 v210, v210
    v_rcp_f32 v211, v211
    v_rcp_f32 v212, v212
    s_waitcnt lgkmcnt(8)
    v_mfma_f32_32x32x16_bf16 v[144:159], a[96:99], v[192:195], v[144:159]
    ds_read_b128 v[184:187], v18 offset:33280
    v_rcp_f32 v213, v213
    v_rcp_f32 v214, v214
    v_rcp_f32 v215, v215
    v_mfma_f32_32x32x16_bf16 v[160:175], a[100:103], v[192:195], v[160:175]
    v_cvt_pk_bf16_f32 v224, v208, v209
    v_cvt_pk_bf16_f32 v225, v210, v211
    v_cvt_pk_bf16_f32 v226, v212, v213
    v_cvt_pk_bf16_f32 v227, v214, v215
    ds_write_b128 v10, v[224:227] offset:0
    v_mfma_f32_32x32x16_bf16 v[144:159], a[104:107], v[196:199], v[144:159]
    ds_read_b128 v[188:191], v19 offset:33280
    v_add_f32 v216, v96, v56
    v_add_f32 v217, v97, v57
    v_add_f32 v218, v98, v58
    v_mfma_f32_32x32x16_bf16 v[160:175], a[108:111], v[196:199], v[160:175]
    v_add_f32 v219, v99, v59
    v_add_f32 v220, v100, v60
    v_add_f32 v221, v101, v61
    v_add_f32 v222, v102, v62
    v_add_f32 v223, v103, v63
    v_exp_f32 v216, v216
    s_waitcnt lgkmcnt(8)
    v_mfma_f32_32x32x16_bf16 v[144:159], a[112:115], v[200:203], v[144:159]
    ds_read_b128 v[192:195], v20 offset:33280
    v_exp_f32 v217, v217
    v_exp_f32 v218, v218
    v_mfma_f32_32x32x16_bf16 v[160:175], a[116:119], v[200:203], v[160:175]
    v_exp_f32 v219, v219
    v_exp_f32 v220, v220
    v_exp_f32 v221, v221
    v_mfma_f32_32x32x16_bf16 v[144:159], a[120:123], v[204:207], v[144:159]
    ds_read_b128 v[196:199], v21 offset:33280
    s_waitcnt lgkmcnt(5)
    ds_read_b128 v[232:235], v28 offset:0
    ds_read_b128 v[236:239], v28 offset:1024
    ds_read_b128 v[240:243], v28 offset:2048
    ds_read_b128 v[244:247], v28 offset:3072
    v_exp_f32 v222, v222
    v_mfma_f32_32x32x16_bf16 v[160:175], a[124:127], v[204:207], v[160:175]
    v_exp_f32 v223, v223
    v_sub_f32 v216, -0.5, v216
    v_sub_f32 v217, -0.5, v217
    v_sub_f32 v218, -0.5, v218
    v_mfma_f32_32x32x16_bf16 v[144:159], a[128:131], v[176:179], v[144:159]
    ds_read_b128 v[200:203], v22 offset:33280
    v_sub_f32 v219, -0.5, v219
    v_sub_f32 v220, -0.5, v220
    v_sub_f32 v221, -0.5, v221
    v_sub_f32 v222, -0.5, v222
    v_sub_f32 v223, -0.5, v223
    v_mfma_f32_32x32x16_bf16 v[160:175], a[132:135], v[176:179], v[160:175]
    v_rcp_f32 v216, v216
    v_rcp_f32 v217, v217
    v_rcp_f32 v218, v218
    v_mfma_f32_32x32x16_bf16 v[144:159], a[136:139], v[180:183], v[144:159]
    ds_read_b128 v[204:207], v23 offset:33280
    v_rcp_f32 v219, v219
    v_rcp_f32 v220, v220
    v_rcp_f32 v221, v221
    v_mfma_f32_32x32x16_bf16 v[160:175], a[140:143], v[180:183], v[160:175]
    v_rcp_f32 v222, v222
    v_rcp_f32 v223, v223
    v_cvt_pk_bf16_f32 v228, v216, v217
    s_waitcnt lgkmcnt(8)
    v_mfma_f32_32x32x16_bf16 v[144:159], a[144:147], v[184:187], v[144:159]
    ds_read_b128 v[176:179], v16 offset:33536
    v_cvt_pk_bf16_f32 v229, v218, v219
    v_cvt_pk_bf16_f32 v230, v220, v221
    v_cvt_pk_bf16_f32 v231, v222, v223
    ds_write_b128 v11, v[228:231] offset:0
    v_mfma_f32_32x32x16_bf16 v[160:175], a[148:151], v[184:187], v[160:175]
    v_add_f32 v208, v96, v64
    v_add_f32 v209, v97, v65
    v_add_f32 v210, v98, v66
    v_add_f32 v211, v99, v67
    v_add_f32 v212, v100, v68
    v_mfma_f32_32x32x16_bf16 v[144:159], a[152:155], v[188:191], v[144:159]
    ds_read_b128 v[180:183], v17 offset:33536
    s_waitcnt lgkmcnt(8)
    s_add_u32 s36, s31, 0
    buffer_store_dwordx4 v[232:235], v29, s[24:27], s36 offen sc1
    v_add_f32 v213, v101, v69
    v_add_f32 v214, v102, v70
    v_add_f32 v215, v103, v71
    v_mfma_f32_32x32x16_bf16 v[160:175], a[156:159], v[188:191], v[160:175]
    v_exp_f32 v208, v208
    v_exp_f32 v209, v209
    v_exp_f32 v210, v210
    v_mfma_f32_32x32x16_bf16 v[144:159], a[160:163], v[192:195], v[144:159]
    ds_read_b128 v[184:187], v18 offset:33536
    s_waitcnt lgkmcnt(8)
    s_add_u32 s36, s31, 8192
    buffer_store_dwordx4 v[236:239], v29, s[24:27], s36 offen sc1
    v_exp_f32 v211, v211
    v_exp_f32 v212, v212
    v_mfma_f32_32x32x16_bf16 v[160:175], a[164:167], v[192:195], v[160:175]
    v_exp_f32 v213, v213
    v_exp_f32 v214, v214
    v_exp_f32 v215, v215
    v_mfma_f32_32x32x16_bf16 v[144:159], a[168:171], v[196:199], v[144:159]
    ds_read_b128 v[188:191], v19 offset:33536
    s_waitcnt lgkmcnt(8)
    s_add_u32 s36, s31, 16384
    buffer_store_dwordx4 v[240:243], v29, s[24:27], s36 offen sc1
    v_sub_f32 v208, -0.5, v208
    v_sub_f32 v209, -0.5, v209
    v_mfma_f32_32x32x16_bf16 v[160:175], a[172:175], v[196:199], v[160:175]
    v_sub_f32 v210, -0.5, v210
    v_sub_f32 v211, -0.5, v211
    v_sub_f32 v212, -0.5, v212
    v_sub_f32 v213, -0.5, v213
    v_sub_f32 v214, -0.5, v214
    v_sub_f32 v215, -0.5, v215
    s_waitcnt lgkmcnt(5)
    v_mfma_f32_32x32x16_bf16 v[144:159], a[176:179], v[200:203], v[144:159]
    ds_read_b128 v[192:195], v20 offset:33536
    s_add_u32 s36, s31, 24576
    buffer_store_dwordx4 v[244:247], v29, s[24:27], s36 offen sc1
    v_rcp_f32 v208, v208
    v_rcp_f32 v209, v209
    v_mfma_f32_32x32x16_bf16 v[160:175], a[180:183], v[200:203], v[160:175]
    v_rcp_f32 v210, v210
    v_rcp_f32 v211, v211
    v_rcp_f32 v212, v212
    v_mfma_f32_32x32x16_bf16 v[144:159], a[184:187], v[204:207], v[144:159]
    ds_read_b128 v[196:199], v21 offset:33536
    v_rcp_f32 v213, v213
    v_rcp_f32 v214, v214
    v_mfma_f32_32x32x16_bf16 v[160:175], a[188:191], v[204:207], v[160:175]
    v_rcp_f32 v215, v215
    v_cvt_pk_bf16_f32 v224, v208, v209
    v_cvt_pk_bf16_f32 v225, v210, v211
    v_cvt_pk_bf16_f32 v226, v212, v213
    v_cvt_pk_bf16_f32 v227, v214, v215
    s_waitcnt lgkmcnt(4)
    v_mfma_f32_32x32x16_bf16 v[144:159], a[192:195], v[176:179], v[144:159]
    ds_read_b128 v[200:203], v22 offset:33536
    ds_write_b128 v12, v[224:227] offset:0
    v_add_f32 v216, v96, v72
    v_add_f32 v217, v97, v73
    v_mfma_f32_32x32x16_bf16 v[160:175], a[196:199], v[176:179], v[160:175]
    v_add_f32 v218, v98, v74
    v_add_f32 v219, v99, v75
    v_add_f32 v220, v100, v76
    v_add_f32 v221, v101, v77
    v_add_f32 v222, v102, v78
    v_add_f32 v223, v103, v79
    v_mfma_f32_32x32x16_bf16 v[144:159], a[200:203], v[180:183], v[144:159]
    ds_read_b128 v[204:207], v23 offset:33536
    v_exp_f32 v216, v216
    v_exp_f32 v217, v217
    v_exp_f32 v218, v218
    v_mfma_f32_32x32x16_bf16 v[160:175], a[204:207], v[180:183], v[160:175]
    v_exp_f32 v219, v219
    v_exp_f32 v220, v220
    v_exp_f32 v221, v221
    v_exp_f32 v222, v222
    v_exp_f32 v223, v223
    v_sub_f32 v216, -0.5, v216
    v_sub_f32 v217, -0.5, v217
    v_sub_f32 v218, -0.5, v218
    v_sub_f32 v219, -0.5, v219
    v_sub_f32 v220, -0.5, v220
    v_sub_f32 v221, -0.5, v221
    v_sub_f32 v222, -0.5, v222
    v_sub_f32 v223, -0.5, v223
    v_rcp_f32 v216, v216
    v_rcp_f32 v217, v217
    v_rcp_f32 v218, v218
    v_rcp_f32 v219, v219
    v_rcp_f32 v220, v220
    v_rcp_f32 v221, v221
    v_rcp_f32 v222, v222
    v_rcp_f32 v223, v223
    v_cvt_pk_bf16_f32 v228, v216, v217
    v_cvt_pk_bf16_f32 v229, v218, v219
    v_cvt_pk_bf16_f32 v230, v220, v221
    v_cvt_pk_bf16_f32 v231, v222, v223
    ds_write_b128 v13, v[228:231] offset:0
    v_add_f32 v208, v96, v80
    v_add_f32 v209, v97, v81
    v_add_f32 v210, v98, v82
    v_add_f32 v211, v99, v83
    v_add_f32 v212, v100, v84
    v_add_f32 v213, v101, v85
    v_add_f32 v214, v102, v86
    v_add_f32 v215, v103, v87
    v_exp_f32 v208, v208
    v_exp_f32 v209, v209
    v_exp_f32 v210, v210
    v_exp_f32 v211, v211
    v_exp_f32 v212, v212
    v_exp_f32 v213, v213
    v_exp_f32 v214, v214
    v_exp_f32 v215, v215
    v_sub_f32 v208, -0.5, v208
    v_sub_f32 v209, -0.5, v209
    v_sub_f32 v210, -0.5, v210
    v_sub_f32 v211, -0.5, v211
    v_sub_f32 v212, -0.5, v212
    v_sub_f32 v213, -0.5, v213
    v_sub_f32 v214, -0.5, v214
    v_sub_f32 v215, -0.5, v215
    v_rcp_f32 v208, v208
    v_rcp_f32 v209, v209
    v_rcp_f32 v210, v210
    v_rcp_f32 v211, v211
    v_rcp_f32 v212, v212
    v_rcp_f32 v213, v213
    v_rcp_f32 v214, v214
    v_rcp_f32 v215, v215
    v_cvt_pk_bf16_f32 v224, v208, v209
    v_cvt_pk_bf16_f32 v225, v210, v211
    v_cvt_pk_bf16_f32 v226, v212, v213
    v_cvt_pk_bf16_f32 v227, v214, v215
    ds_write_b128 v14, v[224:227] offset:0
    v_add_f32 v216, v96, v88
    v_add_f32 v217, v97, v89
    v_add_f32 v218, v98, v90
    v_add_f32 v219, v99, v91
    v_add_f32 v220, v100, v92
    v_add_f32 v221, v101, v93
    v_add_f32 v222, v102, v94
    v_add_f32 v223, v103, v95
    v_exp_f32 v216, v216
    v_exp_f32 v217, v217
    v_exp_f32 v218, v218
    v_exp_f32 v219, v219
    v_exp_f32 v220, v220
    v_exp_f32 v221, v221
    v_exp_f32 v222, v222
    v_exp_f32 v223, v223
    v_sub_f32 v216, -0.5, v216
    v_sub_f32 v217, -0.5, v217
    v_sub_f32 v218, -0.5, v218
    v_sub_f32 v219, -0.5, v219
    v_sub_f32 v220, -0.5, v220
    v_sub_f32 v221, -0.5, v221
    v_sub_f32 v222, -0.5, v222
    v_sub_f32 v223, -0.5, v223
    v_rcp_f32 v216, v216
    v_rcp_f32 v217, v217
    v_rcp_f32 v218, v218
    v_rcp_f32 v219, v219
    v_rcp_f32 v220, v220
    v_rcp_f32 v221, v221
    v_rcp_f32 v222, v222
    v_rcp_f32 v223, v223
    v_cvt_pk_bf16_f32 v228, v216, v217
    v_cvt_pk_bf16_f32 v229, v218, v219
    v_cvt_pk_bf16_f32 v230, v220, v221
    v_cvt_pk_bf16_f32 v231, v222, v223
    ds_write_b128 v15, v[228:231] offset:0
    s_waitcnt lgkmcnt(0)
    s_barrier
    v_mfma_f32_32x32x16_bf16 v[144:159], a[208:211], v[184:187], v[144:159]
    ds_read_b128 v[176:179], v16 offset:0
    s_waitcnt vmcnt(4)
    v_add_f32 v208, v104, v32
    v_add_f32 v209, v105, v33
    v_add_f32 v210, v106, v34
    v_add_f32 v211, v107, v35
    v_add_f32 v212, v108, v36
    v_mfma_f32_32x32x16_bf16 v[160:175], a[212:215], v[184:187], v[160:175]
    v_add_f32 v213, v109, v37
    v_add_f32 v214, v110, v38
    v_add_f32 v215, v111, v39
    v_exp_f32 v208, v208
    v_exp_f32 v209, v209
    v_mfma_f32_32x32x16_bf16 v[144:159], a[216:219], v[188:191], v[144:159]
    ds_read_b128 v[180:183], v17 offset:0
    v_exp_f32 v210, v210
    v_exp_f32 v211, v211
    v_mfma_f32_32x32x16_bf16 v[160:175], a[220:223], v[188:191], v[160:175]
    v_exp_f32 v212, v212
    v_exp_f32 v213, v213
    v_exp_f32 v214, v214
    v_mfma_f32_32x32x16_bf16 v[144:159], a[224:227], v[192:195], v[144:159]
    ds_read_b128 v[184:187], v18 offset:0
    v_exp_f32 v215, v215
    v_sub_f32 v208, -0.5, v208
    v_sub_f32 v209, -0.5, v209
    v_sub_f32 v210, -0.5, v210
    v_mfma_f32_32x32x16_bf16 v[160:175], a[228:231], v[192:195], v[160:175]
    v_sub_f32 v211, -0.5, v211
    v_sub_f32 v212, -0.5, v212
    v_sub_f32 v213, -0.5, v213
    v_sub_f32 v214, -0.5, v214
    v_sub_f32 v215, -0.5, v215
    v_rcp_f32 v208, v208
    v_mfma_f32_32x32x16_bf16 v[144:159], a[232:235], v[196:199], v[144:159]
    ds_read_b128 v[188:191], v19 offset:0
    v_rcp_f32 v209, v209
    v_rcp_f32 v210, v210
    v_mfma_f32_32x32x16_bf16 v[160:175], a[236:239], v[196:199], v[160:175]
    v_rcp_f32 v211, v211
    v_rcp_f32 v212, v212
    v_rcp_f32 v213, v213
    v_mfma_f32_32x32x16_bf16 v[144:159], a[240:243], v[200:203], v[144:159]
    ds_read_b128 v[192:195], v20 offset:0
    v_rcp_f32 v214, v214
    v_rcp_f32 v215, v215
    v_cvt_pk_bf16_f32 v224, v208, v209
    v_mfma_f32_32x32x16_bf16 v[160:175], a[244:247], v[200:203], v[160:175]
    v_cvt_pk_bf16_f32 v225, v210, v211
    v_cvt_pk_bf16_f32 v226, v212, v213
    v_cvt_pk_bf16_f32 v227, v214, v215
    ds_write_b128 v8, v[224:227] offset:32768
    v_mfma_f32_32x32x16_bf16 v[144:159], a[248:251], v[204:207], v[144:159]
    ds_read_b128 v[196:199], v21 offset:0
    v_add_f32 v216, v104, v40
    v_add_f32 v217, v105, v41
    v_add_f32 v218, v106, v42
    v_add_f32 v219, v107, v43
    v_add_f32 v220, v108, v44
    v_mfma_f32_32x32x16_bf16 v[160:175], a[252:255], v[204:207], v[160:175]
    v_add_f32 v221, v109, v45
    v_add_f32 v222, v110, v46
    v_add_f32 v223, v111, v47
    v_exp_f32 v216, v216
    v_exp_f32 v217, v217
    s_waitcnt lgkmcnt(5)
    v_mfma_f32_32x32x16_bf16 v[112:127], a[0:3], v[176:179], v[112:127]
    ds_read_b128 v[200:203], v22 offset:0
    v_exp_f32 v218, v218
    v_exp_f32 v219, v219
    v_mfma_f32_32x32x16_bf16 v[128:143], a[4:7], v[176:179], v[128:143]
    v_exp_f32 v220, v220
    v_exp_f32 v221, v221
    v_exp_f32 v222, v222
    v_mfma_f32_32x32x16_bf16 v[112:127], a[8:11], v[180:183], v[112:127]
    ds_read_b128 v[204:207], v23 offset:0
    v_exp_f32 v223, v223
    v_sub_f32 v216, -0.5, v216
    v_sub_f32 v217, -0.5, v217
    v_sub_f32 v218, -0.5, v218
    v_mfma_f32_32x32x16_bf16 v[128:143], a[12:15], v[180:183], v[128:143]
    v_sub_f32 v219, -0.5, v219
    v_sub_f32 v220, -0.5, v220
    v_sub_f32 v221, -0.5, v221
    v_sub_f32 v222, -0.5, v222
    v_sub_f32 v223, -0.5, v223
    v_rcp_f32 v216, v216
    s_waitcnt lgkmcnt(5)
    v_mfma_f32_32x32x16_bf16 v[112:127], a[16:19], v[184:187], v[112:127]
    ds_read_b128 v[176:179], v16 offset:256
    v_rcp_f32 v217, v217
    v_rcp_f32 v218, v218
    v_mfma_f32_32x32x16_bf16 v[128:143], a[20:23], v[184:187], v[128:143]
    v_rcp_f32 v219, v219
    v_rcp_f32 v220, v220
    v_rcp_f32 v221, v221
    v_mfma_f32_32x32x16_bf16 v[112:127], a[24:27], v[188:191], v[112:127]
    ds_read_b128 v[180:183], v17 offset:256
    v_rcp_f32 v222, v222
    v_rcp_f32 v223, v223
    v_cvt_pk_bf16_f32 v228, v216, v217
    v_mfma_f32_32x32x16_bf16 v[128:143], a[28:31], v[188:191], v[128:143]
    v_cvt_pk_bf16_f32 v229, v218, v219
    v_cvt_pk_bf16_f32 v230, v220, v221
    v_cvt_pk_bf16_f32 v231, v222, v223
    ds_write_b128 v9, v[228:231] offset:32768
    s_waitcnt lgkmcnt(5)
    v_mfma_f32_32x32x16_bf16 v[112:127], a[32:35], v[192:195], v[112:127]
    ds_read_b128 v[184:187], v18 offset:256
    v_cvt_pk_bf16_f32 v232, v144, v145
    v_cvt_pk_bf16_f32 v233, v146, v147
    v_cvt_pk_bf16_f32 v234, v148, v149
    v_cvt_pk_bf16_f32 v235, v150, v151
    v_cvt_pk_bf16_f32 v236, v152, v153
    v_mfma_f32_32x32x16_bf16 v[128:143], a[36:39], v[192:195], v[128:143]
    v_cvt_pk_bf16_f32 v237, v154, v155
    v_cvt_pk_bf16_f32 v238, v156, v157
    v_cvt_pk_bf16_f32 v239, v158, v159
    v_cvt_pk_bf16_f32 v240, v160, v161
    v_cvt_pk_bf16_f32 v241, v162, v163
    v_cvt_pk_bf16_f32 v242, v164, v165
    v_mfma_f32_32x32x16_bf16 v[112:127], a[40:43], v[196:199], v[112:127]
    ds_read_b128 v[188:191], v19 offset:256
    v_cvt_pk_bf16_f32 v243, v166, v167
    v_cvt_pk_bf16_f32 v244, v168, v169
    v_cvt_pk_bf16_f32 v245, v170, v171
    v_cvt_pk_bf16_f32 v246, v172, v173
    v_cvt_pk_bf16_f32 v247, v174, v175
    v_mfma_f32_32x32x16_bf16 v[128:143], a[44:47], v[196:199], v[128:143]
    s_nop 1
    ds_read_b128 v[144:147], v250 offset:0
    ds_read_b128 v[148:151], v250 offset:32
    ds_read_b128 v[152:155], v250 offset:64
    ds_read_b128 v[156:159], v250 offset:96
    ds_read_b128 v[160:163], v250 offset:128
    s_waitcnt lgkmcnt(10)
    v_mfma_f32_32x32x16_bf16 v[112:127], a[48:51], v[200:203], v[112:127]
    ds_read_b128 v[192:195], v20 offset:256
    ds_read_b128 v[164:167], v250 offset:160
    ds_read_b128 v[168:171], v250 offset:192
    ds_read_b128 v[172:175], v250 offset:224
    v_permlane32_swap_b32 v232, v234
    v_permlane32_swap_b32 v233, v235
    v_mfma_f32_32x32x16_bf16 v[128:143], a[52:55], v[200:203], v[128:143]
    v_permlane32_swap_b32 v236, v238
    v_permlane32_swap_b32 v237, v239
    v_permlane32_swap_b32 v240, v242
    v_permlane32_swap_b32 v241, v243
    v_permlane32_swap_b32 v244, v246
    v_permlane32_swap_b32 v245, v247
    v_mfma_f32_32x32x16_bf16 v[112:127], a[56:59], v[204:207], v[112:127]
    ds_read_b128 v[196:199], v21 offset:256
    v_add_f32 v208, v104, v48
    v_add_f32 v209, v105, v49
    v_add_f32 v210, v106, v50
    v_add_f32 v211, v107, v51
    v_add_f32 v212, v108, v52
    v_mfma_f32_32x32x16_bf16 v[128:143], a[60:63], v[204:207], v[128:143]
    v_add_f32 v213, v109, v53
    v_add_f32 v214, v110, v54
    v_add_f32 v215, v111, v55
    v_exp_f32 v208, v208
    v_exp_f32 v209, v209
    s_waitcnt lgkmcnt(13)
    v_mfma_f32_32x32x16_bf16 v[112:127], a[64:67], v[176:179], v[112:127]
    ds_read_b128 v[200:203], v22 offset:256
    ds_write_b128 v24, v[232:235]
    v_exp_f32 v210, v210
    v_mfma_f32_32x32x16_bf16 v[128:143], a[68:71], v[176:179], v[128:143]
    v_exp_f32 v211, v211
    v_exp_f32 v212, v212
    v_exp_f32 v213, v213
    v_mfma_f32_32x32x16_bf16 v[112:127], a[72:75], v[180:183], v[112:127]
    ds_read_b128 v[204:207], v23 offset:256
    ds_write_b128 v25, v[236:239]
    v_exp_f32 v214, v214
    v_mfma_f32_32x32x16_bf16 v[128:143], a[76:79], v[180:183], v[128:143]
    v_exp_f32 v215, v215
    v_sub_f32 v208, -0.5, v208
    v_sub_f32 v209, -0.5, v209
    v_sub_f32 v210, -0.5, v210
    s_waitcnt lgkmcnt(14)
    v_mfma_f32_32x32x16_bf16 v[112:127], a[80:83], v[184:187], v[112:127]
    ds_read_b128 v[176:179], v16 offset:512
    ds_write_b128 v26, v[240:243]
    v_sub_f32 v211, -0.5, v211
    v_sub_f32 v212, -0.5, v212
    v_mfma_f32_32x32x16_bf16 v[128:143], a[84:87], v[184:187], v[128:143]
    v_sub_f32 v213, -0.5, v213
    v_sub_f32 v214, -0.5, v214
    v_sub_f32 v215, -0.5, v215
    v_rcp_f32 v208, v208
    v_rcp_f32 v209, v209
    v_mfma_f32_32x32x16_bf16 v[112:127], a[88:91], v[188:191], v[112:127]
    ds_read_b128 v[180:183], v17 offset:512
    ds_write_b128 v27, v[244:247]
    v_rcp_f32 v210, v210
    v_mfma_f32_32x32x16_bf16 v[128:143], a[92:95], v[188:191], v[128:143]
    v_rcp_f32 v211, v211
    v_rcp_f32 v212, v212
    v_rcp_f32 v213, v213
    s_waitcnt lgkmcnt(8)
    v_mfma_f32_32x32x16_bf16 v[112:127], a[96:99], v[192:195], v[112:127]
    ds_read_b128 v[184:187], v18 offset:512
    v_rcp_f32 v214, v214
    v_rcp_f32 v215, v215
    v_mfma_f32_32x32x16_bf16 v[128:143], a[100:103], v[192:195], v[128:143]
    v_cvt_pk_bf16_f32 v224, v208, v209
    v_cvt_pk_bf16_f32 v225, v210, v211
    v_cvt_pk_bf16_f32 v226, v212, v213
    v_cvt_pk_bf16_f32 v227, v214, v215
    ds_write_b128 v10, v[224:227] offset:32768
    v_mfma_f32_32x32x16_bf16 v[112:127], a[104:107], v[196:199], v[112:127]
    ds_read_b128 v[188:191], v19 offset:512
    v_add_f32 v216, v104, v56
    v_add_f32 v217, v105, v57
    v_add_f32 v218, v106, v58
    v_add_f32 v219, v107, v59
    v_mfma_f32_32x32x16_bf16 v[128:143], a[108:111], v[196:199], v[128:143]
    v_add_f32 v220, v108, v60
    v_add_f32 v221, v109, v61
    v_add_f32 v222, v110, v62
    v_add_f32 v223, v111, v63
    v_exp_f32 v216, v216
    s_waitcnt lgkmcnt(8)
    v_mfma_f32_32x32x16_bf16 v[112:127], a[112:115], v[200:203], v[112:127]
    ds_read_b128 v[192:195], v20 offset:512
    v_exp_f32 v217, v217
    v_exp_f32 v218, v218
    v_exp_f32 v219, v219
    v_mfma_f32_32x32x16_bf16 v[128:143], a[116:119], v[200:203], v[128:143]
    v_exp_f32 v220, v220
    v_exp_f32 v221, v221
    v_exp_f32 v222, v222
    v_mfma_f32_32x32x16_bf16 v[112:127], a[120:123], v[204:207], v[112:127]
    ds_read_b128 v[196:199], v21 offset:512
    s_waitcnt lgkmcnt(5)
    ds_read_b128 v[232:235], v28 offset:0
    ds_read_b128 v[236:239], v28 offset:1024
    ds_read_b128 v[240:243], v28 offset:2048
    ds_read_b128 v[244:247], v28 offset:3072
    v_mfma_f32_32x32x16_bf16 v[128:143], a[124:127], v[204:207], v[128:143]
    v_exp_f32 v223, v223
    v_sub_f32 v216, -0.5, v216
    v_sub_f32 v217, -0.5, v217
    v_sub_f32 v218, -0.5, v218
    v_sub_f32 v219, -0.5, v219
    v_mfma_f32_32x32x16_bf16 v[112:127], a[128:131], v[176:179], v[112:127]
    ds_read_b128 v[200:203], v22 offset:512
    v_sub_f32 v220, -0.5, v220
    v_sub_f32 v221, -0.5, v221
    v_sub_f32 v222, -0.5, v222
    v_sub_f32 v223, -0.5, v223
    v_rcp_f32 v216, v216
    v_mfma_f32_32x32x16_bf16 v[128:143], a[132:135], v[176:179], v[128:143]
    v_rcp_f32 v217, v217
    v_rcp_f32 v218, v218
    v_rcp_f32 v219, v219
    v_mfma_f32_32x32x16_bf16 v[112:127], a[136:139], v[180:183], v[112:127]
    ds_read_b128 v[204:207], v23 offset:512
    v_rcp_f32 v220, v220
    v_rcp_f32 v221, v221
    v_mfma_f32_32x32x16_bf16 v[128:143], a[140:143], v[180:183], v[128:143]
    v_rcp_f32 v222, v222
    v_rcp_f32 v223, v223
    v_cvt_pk_bf16_f32 v228, v216, v217
    v_cvt_pk_bf16_f32 v229, v218, v219
    s_waitcnt lgkmcnt(8)
    v_mfma_f32_32x32x16_bf16 v[112:127], a[144:147], v[184:187], v[112:127]
    ds_read_b128 v[176:179], v16 offset:768
    v_cvt_pk_bf16_f32 v230, v220, v221
    v_cvt_pk_bf16_f32 v231, v222, v223
    ds_write_b128 v11, v[228:231] offset:32768
    v_mfma_f32_32x32x16_bf16 v[128:143], a[148:151], v[184:187], v[128:143]
    v_add_f32 v208, v104, v64
    v_add_f32 v209, v105, v65
    v_add_f32 v210, v106, v66
    v_add_f32 v211, v107, v67
    v_add_f32 v212, v108, v68
    v_add_f32 v213, v109, v69
    v_mfma_f32_32x32x16_bf16 v[112:127], a[152:155], v[188:191], v[112:127]
    ds_read_b128 v[180:183], v17 offset:768
    s_waitcnt lgkmcnt(8)
    s_add_u32 s36, s31, 32768
    buffer_store_dwordx4 v[232:235], v29, s[24:27], s36 offen sc1
    v_add_f32 v214, v110, v70
    v_add_f32 v215, v111, v71
    v_exp_f32 v208, v208
    v_mfma_f32_32x32x16_bf16 v[128:143], a[156:159], v[188:191], v[128:143]
    v_exp_f32 v209, v209
    v_exp_f32 v210, v210
    v_exp_f32 v211, v211
    v_mfma_f32_32x32x16_bf16 v[112:127], a[160:163], v[192:195], v[112:127]
    ds_read_b128 v[184:187], v18 offset:768
    s_waitcnt lgkmcnt(8)
    s_add_u32 s36, s31, 40960
    buffer_store_dwordx4 v[236:239], v29, s[24:27], s36 offen sc1
    v_exp_f32 v212, v212
    v_mfma_f32_32x32x16_bf16 v[128:143], a[164:167], v[192:195], v[128:143]
    v_exp_f32 v213, v213
    v_exp_f32 v214, v214
    v_exp_f32 v215, v215
    v_mfma_f32_32x32x16_bf16 v[112:127], a[168:171], v[196:199], v[112:127]
    ds_read_b128 v[188:191], v19 offset:768
    s_waitcnt lgkmcnt(8)
    s_add_u32 s36, s31, 49152
    buffer_store_dwordx4 v[240:243], v29, s[24:27], s36 offen sc1
    v_sub_f32 v208, -0.5, v208
    v_sub_f32 v209, -0.5, v209
    v_sub_f32 v210, -0.5, v210
    v_mfma_f32_32x32x16_bf16 v[128:143], a[172:175], v[196:199], v[128:143]
    v_sub_f32 v211, -0.5, v211
    v_sub_f32 v212, -0.5, v212
    v_sub_f32 v213, -0.5, v213
    v_sub_f32 v214, -0.5, v214
    v_sub_f32 v215, -0.5, v215
    v_rcp_f32 v208, v208
    s_waitcnt lgkmcnt(5)
    v_mfma_f32_32x32x16_bf16 v[112:127], a[176:179], v[200:203], v[112:127]
    ds_read_b128 v[192:195], v20 offset:768
    s_add_u32 s36, s31, 57344
    buffer_store_dwordx4 v[244:247], v29, s[24:27], s36 offen sc1
    v_rcp_f32 v209, v209
    v_mfma_f32_32x32x16_bf16 v[128:143], a[180:183], v[200:203], v[128:143]
    v_rcp_f32 v210, v210
    v_rcp_f32 v211, v211
    v_rcp_f32 v212, v212
    v_mfma_f32_32x32x16_bf16 v[112:127], a[184:187], v[204:207], v[112:127]
    ds_read_b128 v[196:199], v21 offset:768
    v_rcp_f32 v213, v213
    v_rcp_f32 v214, v214
    v_rcp_f32 v215, v215
    v_mfma_f32_32x32x16_bf16 v[128:143], a[188:191], v[204:207], v[128:143]
    v_cvt_pk_bf16_f32 v224, v208, v209
    v_cvt_pk_bf16_f32 v225, v210, v211
    v_cvt_pk_bf16_f32 v226, v212, v213
    v_cvt_pk_bf16_f32 v227, v214, v215
    ds_write_b128 v12, v[224:227] offset:32768
    s_waitcnt lgkmcnt(5)
    v_mfma_f32_32x32x16_bf16 v[112:127], a[192:195], v[176:179], v[112:127]
    ds_read_b128 v[200:203], v22 offset:768
    v_add_f32 v216, v104, v72
    v_add_f32 v217, v105, v73
    v_add_f32 v218, v106, v74
    v_mfma_f32_32x32x16_bf16 v[128:143], a[196:199], v[176:179], v[128:143]
    v_add_f32 v219, v107, v75
    v_add_f32 v220, v108, v76
    v_add_f32 v221, v109, v77
    v_add_f32 v222, v110, v78
    v_add_f32 v223, v111, v79
    v_exp_f32 v216, v216
    v_mfma_f32_32x32x16_bf16 v[112:127], a[200:203], v[180:183], v[112:127]
    ds_read_b128 v[204:207], v23 offset:768
    v_exp_f32 v217, v217
    v_exp_f32 v218, v218
    v_mfma_f32_32x32x16_bf16 v[128:143], a[204:207], v[180:183], v[128:143]
    v_exp_f32 v219, v219
    v_exp_f32 v220, v220
    v_exp_f32 v221, v221
    v_exp_f32 v222, v222
    v_exp_f32 v223, v223
    v_sub_f32 v216, -0.5, v216
    v_sub_f32 v217, -0.5, v217
    v_sub_f32 v218, -0.5, v218
    v_sub_f32 v219, -0.5, v219
    v_sub_f32 v220, -0.5, v220
    v_sub_f32 v221, -0.5, v221
    v_sub_f32 v222, -0.5, v222
    v_sub_f32 v223, -0.5, v223
    v_rcp_f32 v216, v216
    v_rcp_f32 v217, v217
    v_rcp_f32 v218, v218
    v_rcp_f32 v219, v219
    v_rcp_f32 v220, v220
    v_rcp_f32 v221, v221
    v_rcp_f32 v222, v222
    v_rcp_f32 v223, v223
    v_cvt_pk_bf16_f32 v228, v216, v217
    v_cvt_pk_bf16_f32 v229, v218, v219
    v_cvt_pk_bf16_f32 v230, v220, v221
    v_cvt_pk_bf16_f32 v231, v222, v223
    ds_write_b128 v13, v[228:231] offset:32768
    v_add_f32 v208, v104, v80
    v_add_f32 v209, v105, v81
    v_add_f32 v210, v106, v82
    v_add_f32 v211, v107, v83
    v_add_f32 v212, v108, v84
    v_add_f32 v213, v109, v85
    v_add_f32 v214, v110, v86
    v_add_f32 v215, v111, v87
    v_exp_f32 v208, v208
    v_exp_f32 v209, v209
    v_exp_f32 v210, v210
    v_exp_f32 v211, v211
    v_exp_f32 v212, v212
    v_exp_f32 v213, v213
    v_exp_f32 v214, v214
    v_exp_f32 v215, v215
    v_sub_f32 v208, -0.5, v208
    v_sub_f32 v209, -0.5, v209
    v_sub_f32 v210, -0.5, v210
    v_sub_f32 v211, -0.5, v211
    v_sub_f32 v212, -0.5, v212
    v_sub_f32 v213, -0.5, v213
    v_sub_f32 v214, -0.5, v214
    v_sub_f32 v215, -0.5, v215
    v_rcp_f32 v208, v208
    v_rcp_f32 v209, v209
    v_rcp_f32 v210, v210
    v_rcp_f32 v211, v211
    v_rcp_f32 v212, v212
    v_rcp_f32 v213, v213
    v_rcp_f32 v214, v214
    v_rcp_f32 v215, v215
    v_cvt_pk_bf16_f32 v224, v208, v209
    v_cvt_pk_bf16_f32 v225, v210, v211
    v_cvt_pk_bf16_f32 v226, v212, v213
    v_cvt_pk_bf16_f32 v227, v214, v215
    ds_write_b128 v14, v[224:227] offset:32768
    v_add_f32 v216, v104, v88
    v_add_f32 v217, v105, v89
    v_add_f32 v218, v106, v90
    v_add_f32 v219, v107, v91
    v_add_f32 v220, v108, v92
    v_add_f32 v221, v109, v93
    v_add_f32 v222, v110, v94
    v_add_f32 v223, v111, v95
    v_exp_f32 v216, v216
    v_exp_f32 v217, v217
    v_exp_f32 v218, v218
    v_exp_f32 v219, v219
    v_exp_f32 v220, v220
    v_exp_f32 v221, v221
    v_exp_f32 v222, v222
    v_exp_f32 v223, v223
    v_sub_f32 v216, -0.5, v216
    v_sub_f32 v217, -0.5, v217
    v_sub_f32 v218, -0.5, v218
    v_sub_f32 v219, -0.5, v219
    v_sub_f32 v220, -0.5, v220
    v_sub_f32 v221, -0.5, v221
    v_sub_f32 v222, -0.5, v222
    v_sub_f32 v223, -0.5, v223
    v_rcp_f32 v216, v216
    v_rcp_f32 v217, v217
    v_rcp_f32 v218, v218
    v_rcp_f32 v219, v219
    v_rcp_f32 v220, v220
    v_rcp_f32 v221, v221
    v_rcp_f32 v222, v222
    v_rcp_f32 v223, v223
    v_cvt_pk_bf16_f32 v228, v216, v217
    v_cvt_pk_bf16_f32 v229, v218, v219
    v_cvt_pk_bf16_f32 v230, v220, v221
    v_cvt_pk_bf16_f32 v231, v222, v223
    ds_write_b128 v15, v[228:231] offset:32768
    s_waitcnt lgkmcnt(0)
    s_barrier
    v_mfma_f32_32x32x16_bf16 v[112:127], a[208:211], v[184:187], v[112:127]
    ds_read_b128 v[176:179], v16 offset:32768
    v_mfma_f32_32x32x16_bf16 v[128:143], a[212:215], v[184:187], v[128:143]
    v_mfma_f32_32x32x16_bf16 v[112:127], a[216:219], v[188:191], v[112:127]
    ds_read_b128 v[180:183], v17 offset:32768
    v_mfma_f32_32x32x16_bf16 v[128:143], a[220:223], v[188:191], v[128:143]
    v_mfma_f32_32x32x16_bf16 v[112:127], a[224:227], v[192:195], v[112:127]
    ds_read_b128 v[184:187], v18 offset:32768
    v_mfma_f32_32x32x16_bf16 v[128:143], a[228:231], v[192:195], v[128:143]
    v_mfma_f32_32x32x16_bf16 v[112:127], a[232:235], v[196:199], v[112:127]
    ds_read_b128 v[188:191], v19 offset:32768
    v_mfma_f32_32x32x16_bf16 v[128:143], a[236:239], v[196:199], v[128:143]
    v_mfma_f32_32x32x16_bf16 v[112:127], a[240:243], v[200:203], v[112:127]
    ds_read_b128 v[192:195], v20 offset:32768
    v_mfma_f32_32x32x16_bf16 v[128:143], a[244:247], v[200:203], v[128:143]
    v_mfma_f32_32x32x16_bf16 v[112:127], a[248:251], v[204:207], v[112:127]
    ds_read_b128 v[196:199], v21 offset:32768
    v_mfma_f32_32x32x16_bf16 v[128:143], a[252:255], v[204:207], v[128:143]
    s_waitcnt lgkmcnt(4)
    v_mfma_f32_32x32x16_bf16 v[144:159], a[0:3], v[176:179], v[144:159]
    ds_read_b128 v[200:203], v22 offset:32768
    v_mfma_f32_32x32x16_bf16 v[160:175], a[4:7], v[176:179], v[160:175]
    v_mfma_f32_32x32x16_bf16 v[144:159], a[8:11], v[180:183], v[144:159]
    ds_read_b128 v[204:207], v23 offset:32768
    v_mfma_f32_32x32x16_bf16 v[160:175], a[12:15], v[180:183], v[160:175]
    s_waitcnt lgkmcnt(4)
    v_mfma_f32_32x32x16_bf16 v[144:159], a[16:19], v[184:187], v[144:159]
    ds_read_b128 v[176:179], v16 offset:33024
    v_mfma_f32_32x32x16_bf16 v[160:175], a[20:23], v[184:187], v[160:175]
    v_mfma_f32_32x32x16_bf16 v[144:159], a[24:27], v[188:191], v[144:159]
    ds_read_b128 v[180:183], v17 offset:33024
    v_mfma_f32_32x32x16_bf16 v[160:175], a[28:31], v[188:191], v[160:175]
    s_waitcnt lgkmcnt(4)
    v_mfma_f32_32x32x16_bf16 v[144:159], a[32:35], v[192:195], v[144:159]
    ds_read_b128 v[184:187], v18 offset:33024
    v_cvt_pk_bf16_f32 v232, v112, v113
    v_cvt_pk_bf16_f32 v233, v114, v115
    v_cvt_pk_bf16_f32 v234, v116, v117
    v_cvt_pk_bf16_f32 v235, v118, v119
    v_cvt_pk_bf16_f32 v236, v120, v121
    v_cvt_pk_bf16_f32 v237, v122, v123
    v_cvt_pk_bf16_f32 v238, v124, v125
    v_cvt_pk_bf16_f32 v239, v126, v127
    v_cvt_pk_bf16_f32 v240, v128, v129
    v_cvt_pk_bf16_f32 v241, v130, v131
    v_cvt_pk_bf16_f32 v242, v132, v133
    v_mfma_f32_32x32x16_bf16 v[160:175], a[36:39], v[192:195], v[160:175]
    v_cvt_pk_bf16_f32 v243, v134, v135
    v_cvt_pk_bf16_f32 v244, v136, v137
    v_cvt_pk_bf16_f32 v245, v138, v139
    v_cvt_pk_bf16_f32 v246, v140, v141
    v_cvt_pk_bf16_f32 v247, v142, v143
    s_nop 1
    v_mfma_f32_32x32x16_bf16 v[144:159], a[40:43], v[196:199], v[144:159]
    ds_read_b128 v[188:191], v19 offset:33024
    v_permlane32_swap_b32 v232, v234
    v_permlane32_swap_b32 v233, v235
    v_permlane32_swap_b32 v236, v238
    v_permlane32_swap_b32 v237, v239
    v_permlane32_swap_b32 v240, v242
    v_mfma_f32_32x32x16_bf16 v[160:175], a[44:47], v[196:199], v[160:175]
    v_permlane32_swap_b32 v241, v243
    v_permlane32_swap_b32 v244, v246
    v_permlane32_swap_b32 v245, v247
    s_waitcnt lgkmcnt(4)
    v_mfma_f32_32x32x16_bf16 v[144:159], a[48:51], v[200:203], v[144:159]
    ds_read_b128 v[192:195], v20 offset:33024
    v_mfma_f32_32x32x16_bf16 v[160:175], a[52:55], v[200:203], v[160:175]
    v_mfma_f32_32x32x16_bf16 v[144:159], a[56:59], v[204:207], v[144:159]
    ds_read_b128 v[196:199], v21 offset:33024
    v_mfma_f32_32x32x16_bf16 v[160:175], a[60:63], v[204:207], v[160:175]
    s_waitcnt lgkmcnt(4)
    v_mfma_f32_32x32x16_bf16 v[144:159], a[64:67], v[176:179], v[144:159]
    ds_read_b128 v[200:203], v22 offset:33024
    ds_write_b128 v24, v[232:235]
    v_mfma_f32_32x32x16_bf16 v[160:175], a[68:71], v[176:179], v[160:175]
    v_mfma_f32_32x32x16_bf16 v[144:159], a[72:75], v[180:183], v[144:159]
    ds_read_b128 v[204:207], v23 offset:33024
    ds_write_b128 v25, v[236:239]
    v_mfma_f32_32x32x16_bf16 v[160:175], a[76:79], v[180:183], v[160:175]
    s_waitcnt lgkmcnt(6)
    v_mfma_f32_32x32x16_bf16 v[144:159], a[80:83], v[184:187], v[144:159]
    ds_read_b128 v[176:179], v16 offset:33280
    ds_write_b128 v26, v[240:243]
    v_mfma_f32_32x32x16_bf16 v[160:175], a[84:87], v[184:187], v[160:175]
    v_mfma_f32_32x32x16_bf16 v[144:159], a[88:91], v[188:191], v[144:159]
    ds_read_b128 v[180:183], v17 offset:33280
    ds_write_b128 v27, v[244:247]
    v_mfma_f32_32x32x16_bf16 v[160:175], a[92:95], v[188:191], v[160:175]
    s_waitcnt lgkmcnt(8)
    v_mfma_f32_32x32x16_bf16 v[144:159], a[96:99], v[192:195], v[144:159]
    ds_read_b128 v[184:187], v18 offset:33280
    v_mfma_f32_32x32x16_bf16 v[160:175], a[100:103], v[192:195], v[160:175]
    v_mfma_f32_32x32x16_bf16 v[144:159], a[104:107], v[196:199], v[144:159]
    ds_read_b128 v[188:191], v19 offset:33280
    v_mfma_f32_32x32x16_bf16 v[160:175], a[108:111], v[196:199], v[160:175]
    s_waitcnt lgkmcnt(7)
    v_mfma_f32_32x32x16_bf16 v[144:159], a[112:115], v[200:203], v[144:159]
    ds_read_b128 v[192:195], v20 offset:33280
    v_mfma_f32_32x32x16_bf16 v[160:175], a[116:119], v[200:203], v[160:175]
    v_mfma_f32_32x32x16_bf16 v[144:159], a[120:123], v[204:207], v[144:159]
    ds_read_b128 v[196:199], v21 offset:33280
    s_waitcnt lgkmcnt(4)
    ds_read_b128 v[232:235], v28 offset:0
    ds_read_b128 v[236:239], v28 offset:1024
    ds_read_b128 v[240:243], v28 offset:2048
    ds_read_b128 v[244:247], v28 offset:3072
    v_mfma_f32_32x32x16_bf16 v[160:175], a[124:127], v[204:207], v[160:175]
    v_mfma_f32_32x32x16_bf16 v[144:159], a[128:131], v[176:179], v[144:159]
    ds_read_b128 v[200:203], v22 offset:33280
    v_mfma_f32_32x32x16_bf16 v[160:175], a[132:135], v[176:179], v[160:175]
    v_mfma_f32_32x32x16_bf16 v[144:159], a[136:139], v[180:183], v[144:159]
    ds_read_b128 v[204:207], v23 offset:33280
    v_mfma_f32_32x32x16_bf16 v[160:175], a[140:143], v[180:183], v[160:175]
    s_waitcnt lgkmcnt(8)
    v_mfma_f32_32x32x16_bf16 v[144:159], a[144:147], v[184:187], v[144:159]
    ds_read_b128 v[176:179], v16 offset:33536
    v_mfma_f32_32x32x16_bf16 v[160:175], a[148:151], v[184:187], v[160:175]
    v_mfma_f32_32x32x16_bf16 v[144:159], a[152:155], v[188:191], v[144:159]
    ds_read_b128 v[180:183], v17 offset:33536
    s_waitcnt lgkmcnt(7)
    s_add_u32 s36, s31, 65536
    buffer_store_dwordx4 v[232:235], v29, s[24:27], s36 offen sc1
    v_mfma_f32_32x32x16_bf16 v[160:175], a[156:159], v[188:191], v[160:175]
    v_mfma_f32_32x32x16_bf16 v[144:159], a[160:163], v[192:195], v[144:159]
    ds_read_b128 v[184:187], v18 offset:33536
    s_waitcnt lgkmcnt(7)
    s_add_u32 s36, s31, 73728
    buffer_store_dwordx4 v[236:239], v29, s[24:27], s36 offen sc1
    v_mfma_f32_32x32x16_bf16 v[160:175], a[164:167], v[192:195], v[160:175]
    v_mfma_f32_32x32x16_bf16 v[144:159], a[168:171], v[196:199], v[144:159]
    ds_read_b128 v[188:191], v19 offset:33536
    s_waitcnt lgkmcnt(7)
    s_add_u32 s36, s31, 81920
    buffer_store_dwordx4 v[240:243], v29, s[24:27], s36 offen sc1
    v_mfma_f32_32x32x16_bf16 v[160:175], a[172:175], v[196:199], v[160:175]
    s_waitcnt lgkmcnt(4)
    v_mfma_f32_32x32x16_bf16 v[144:159], a[176:179], v[200:203], v[144:159]
    ds_read_b128 v[192:195], v20 offset:33536
    s_add_u32 s36, s31, 90112
    buffer_store_dwordx4 v[244:247], v29, s[24:27], s36 offen sc1
    v_mfma_f32_32x32x16_bf16 v[160:175], a[180:183], v[200:203], v[160:175]
    v_mfma_f32_32x32x16_bf16 v[144:159], a[184:187], v[204:207], v[144:159]
    ds_read_b128 v[196:199], v21 offset:33536
    v_mfma_f32_32x32x16_bf16 v[160:175], a[188:191], v[204:207], v[160:175]
    s_waitcnt lgkmcnt(4)
    v_mfma_f32_32x32x16_bf16 v[144:159], a[192:195], v[176:179], v[144:159]
    ds_read_b128 v[200:203], v22 offset:33536
    v_mfma_f32_32x32x16_bf16 v[160:175], a[196:199], v[176:179], v[160:175]
    v_mfma_f32_32x32x16_bf16 v[144:159], a[200:203], v[180:183], v[144:159]
    ds_read_b128 v[204:207], v23 offset:33536
    v_mfma_f32_32x32x16_bf16 v[160:175], a[204:207], v[180:183], v[160:175]
    s_waitcnt lgkmcnt(4)
    v_mfma_f32_32x32x16_bf16 v[144:159], a[208:211], v[184:187], v[144:159]
    v_mfma_f32_32x32x16_bf16 v[160:175], a[212:215], v[184:187], v[160:175]
    v_mfma_f32_32x32x16_bf16 v[144:159], a[216:219], v[188:191], v[144:159]
    v_mfma_f32_32x32x16_bf16 v[160:175], a[220:223], v[188:191], v[160:175]
    s_waitcnt lgkmcnt(2)
    v_mfma_f32_32x32x16_bf16 v[144:159], a[224:227], v[192:195], v[144:159]
    v_mfma_f32_32x32x16_bf16 v[160:175], a[228:231], v[192:195], v[160:175]
    v_mfma_f32_32x32x16_bf16 v[144:159], a[232:235], v[196:199], v[144:159]
    v_mfma_f32_32x32x16_bf16 v[160:175], a[236:239], v[196:199], v[160:175]
    s_waitcnt lgkmcnt(0)
    v_mfma_f32_32x32x16_bf16 v[144:159], a[240:243], v[200:203], v[144:159]
    v_mfma_f32_32x32x16_bf16 v[160:175], a[244:247], v[200:203], v[160:175]
    v_mfma_f32_32x32x16_bf16 v[144:159], a[248:251], v[204:207], v[144:159]
    v_mfma_f32_32x32x16_bf16 v[160:175], a[252:255], v[204:207], v[160:175]
    s_nop 7
    s_nop 7
    v_cvt_pk_bf16_f32 v232, v144, v145
    v_cvt_pk_bf16_f32 v233, v146, v147
    v_cvt_pk_bf16_f32 v234, v148, v149
    v_cvt_pk_bf16_f32 v235, v150, v151
    v_cvt_pk_bf16_f32 v236, v152, v153
    v_cvt_pk_bf16_f32 v237, v154, v155
    v_cvt_pk_bf16_f32 v238, v156, v157
    v_cvt_pk_bf16_f32 v239, v158, v159
    v_cvt_pk_bf16_f32 v240, v160, v161
    v_cvt_pk_bf16_f32 v241, v162, v163
    v_cvt_pk_bf16_f32 v242, v164, v165
    v_cvt_pk_bf16_f32 v243, v166, v167
    v_cvt_pk_bf16_f32 v244, v168, v169
    v_cvt_pk_bf16_f32 v245, v170, v171
    v_cvt_pk_bf16_f32 v246, v172, v173
    v_cvt_pk_bf16_f32 v247, v174, v175
    s_nop 1
    v_permlane32_swap_b32 v232, v234
    v_permlane32_swap_b32 v233, v235
    v_permlane32_swap_b32 v236, v238
    v_permlane32_swap_b32 v237, v239
    v_permlane32_swap_b32 v240, v242
    v_permlane32_swap_b32 v241, v243
    v_permlane32_swap_b32 v244, v246
    v_permlane32_swap_b32 v245, v247
    ds_write_b128 v24, v[232:235]
    ds_write_b128 v25, v[236:239]
    ds_write_b128 v26, v[240:243]
    ds_write_b128 v27, v[244:247]
    s_waitcnt lgkmcnt(0)
    ds_read_b128 v[232:235], v28 offset:0
    ds_read_b128 v[236:239], v28 offset:1024
    ds_read_b128 v[240:243], v28 offset:2048
    ds_read_b128 v[244:247], v28 offset:3072
    s_waitcnt lgkmcnt(3)
    s_add_u32 s36, s31, 98304
    buffer_store_dwordx4 v[232:235], v29, s[24:27], s36 offen sc1
    s_waitcnt lgkmcnt(2)
    s_add_u32 s36, s31, 106496
    buffer_store_dwordx4 v[236:239], v29, s[24:27], s36 offen sc1
    s_waitcnt lgkmcnt(1)
    s_add_u32 s36, s31, 114688
    buffer_store_dwordx4 v[240:243], v29, s[24:27], s36 offen sc1
    s_waitcnt lgkmcnt(0)
    s_add_u32 s36, s31, 122880
    buffer_store_dwordx4 v[244:247], v29, s[24:27], s36 offen sc1
    s_waitcnt vmcnt(0)
    s_endpgm
joint_kernel_done:
    s_waitcnt vmcnt(0)
joint_kernel_end:
    s_endpgm
.section .rodata,"a"
.p2align 6
.amdhsa_kernel conv1_kernel
  .amdhsa_next_free_vgpr 256
  .amdhsa_next_free_sgpr 102
  .amdhsa_accum_offset 168
  .amdhsa_group_segment_fixed_size 0
  .amdhsa_kernarg_size 80
  .amdhsa_user_sgpr_count 2
  .amdhsa_user_sgpr_kernarg_segment_ptr 1
  .amdhsa_system_sgpr_workgroup_id_x 1
  .amdhsa_float_denorm_mode_32 3
.end_amdhsa_kernel

.p2align 6
.amdhsa_kernel conv2_kernel
  .amdhsa_next_free_vgpr 256
  .amdhsa_next_free_sgpr 102
  .amdhsa_accum_offset 144
  .amdhsa_group_segment_fixed_size 0
  .amdhsa_kernarg_size 80
  .amdhsa_user_sgpr_count 2
  .amdhsa_user_sgpr_kernarg_segment_ptr 1
  .amdhsa_system_sgpr_workgroup_id_x 1
  .amdhsa_float_denorm_mode_32 3
.end_amdhsa_kernel

.p2align 6
.amdhsa_kernel joint_kernel
  .amdhsa_next_free_vgpr 512
  .amdhsa_next_free_sgpr 102
  .amdhsa_accum_offset 256
  .amdhsa_group_segment_fixed_size 0
  .amdhsa_kernarg_size 80
  .amdhsa_user_sgpr_count 2
  .amdhsa_user_sgpr_kernarg_segment_ptr 1
  .amdhsa_system_sgpr_workgroup_id_x 1
  .amdhsa_float_denorm_mode_32 3
.end_amdhsa_kernel
```
